```python
import torch

def _softmax(x, axis=-1):
    return torch.softmax(x, dim=axis)
def _gelu(x):
    return torch.nn.functional.gelu(x, approximate="tanh")
def _silu(x):
    return torch.nn.functional.silu(x)
def _sigmoid(x):
    return torch.sigmoid(x)
def _layernorm(x, axis=-1, eps=1e-5):
    m = x.mean(dim=axis, keepdim=True)
    v = x.var(dim=axis, keepdim=True, unbiased=False)
    return (x - m) / torch.sqrt(v + eps)
def _scatter_add(tgt, idx, src, axis=0):
    return tgt.clone().index_add_(axis, idx, src)
def _segment_sum(src, seg, n):
    out = torch.zeros((n,) + src.shape[1:], dtype=src.dtype)
    return out.index_add_(0, seg, src)
def _pad(x, pw):
    flat = tuple(v for pair in reversed(pw) for v in pair)
    return torch.nn.functional.pad(x, flat)

kernel_name = 'concat_heads__mha_block_cached__mha_block_cached__near_ridge'

def setup_inputs():

    _w = (lambda a: (lambda t: t.to(torch.bfloat16) if t.is_floating_point() else t)(torch.as_tensor(a)))
    def _A_setup():
        B, Sq, D = 8, 128, 640
        H, Sk, Dh = 32, 1024, 192
        return {
            "x": _w((lambda *s: torch.randn(*s, dtype=torch.bfloat16) * 0.8)(B, Sq, D)),
            "k_cache": _w((lambda *s: torch.randn(*s, dtype=torch.bfloat16) * 0.8)(B, H, Sk, Dh)),
            "v_cache": _w((lambda *s: torch.randn(*s, dtype=torch.bfloat16) * 0.05)(B, H, Sk, Dh)),
            "wq": _w((lambda *s: torch.randn(*s, dtype=torch.bfloat16) * 0.8)(D, H * Dh) * (D ** -0.5)),
            "wo": _w((lambda *s: torch.randn(*s, dtype=torch.bfloat16) * 0.05)(H * Dh, D) * ((H * Dh) ** -0.5)),
        }
    _A_in = _A_setup()

    def _B_setup():
        B, Sq, D = 8, 128, 640
        H, Sk, Dh = 32, 1024, 192
        return {
            "x": _w((lambda *s: torch.randn(*s, dtype=torch.bfloat16) * 0.8)(B, Sq, D)),
            "k_cache": _w((lambda *s: torch.randn(*s, dtype=torch.bfloat16) * 0.8)(B, H, Sk, Dh)),
            "v_cache": _w((lambda *s: torch.randn(*s, dtype=torch.bfloat16) * 0.05)(B, H, Sk, Dh)),
            "wq": _w((lambda *s: torch.randn(*s, dtype=torch.bfloat16) * 0.8)(D, H * Dh) * (D ** -0.5)),
            "wo": _w((lambda *s: torch.randn(*s, dtype=torch.bfloat16) * 0.05)(H * Dh, D) * ((H * Dh) ** -0.5)),
        }
    _B_in = _B_setup()

    return {
        "A_x": _A_in["x"],
        "A_k_cache": _A_in["k_cache"],
        "A_v_cache": _A_in["v_cache"],
        "A_wq": _A_in["wq"],
        "A_wo": _A_in["wo"],
        "B_x": _B_in["x"],
        "B_k_cache": _B_in["k_cache"],
        "B_v_cache": _B_in["v_cache"],
        "B_wq": _B_in["wq"],
        "B_wo": _B_in["wo"],
    }

def reference(A_x, A_k_cache, A_v_cache, A_wq, A_wo, B_x, B_k_cache, B_v_cache, B_wq, B_wo):
    def _A_ref(x, k_cache, v_cache, wq, wo):
        B, Sq, D = x.shape
        H, Dh = 32, 192
        q = (lambda x, *d: x.permute(*d))((x @ wq).reshape(B, Sq, H, Dh), 0, 2, 1, 3)
        scores = torch.einsum("bhqd,bhkd->bhqk", q, k_cache) * (Dh ** -0.5)
        p = _softmax(scores, axis=-1)
        o = torch.einsum("bhqk,bhkd->bhqd", p, v_cache)
        return (lambda x, *d: x.permute(*d))(o, 0, 2, 1, 3).reshape(B, Sq, H * Dh) @ wo

    def _B_ref(x, k_cache, v_cache, wq, wo):
        B, Sq, D = x.shape
        H, Dh = 32, 192
        q = (lambda x, *d: x.permute(*d))((x @ wq).reshape(B, Sq, H, Dh), 0, 2, 1, 3)
        scores = torch.einsum("bhqd,bhkd->bhqk", q, k_cache) * (Dh ** -0.5)
        p = _softmax(scores, axis=-1)
        o = torch.einsum("bhqk,bhkd->bhqd", p, v_cache)
        return (lambda x, *d: x.permute(*d))(o, 0, 2, 1, 3).reshape(B, Sq, H * Dh) @ wo

    a = _A_ref(A_x, A_k_cache, A_v_cache, A_wq, A_wo)
    b = _B_ref(B_x, B_k_cache, B_v_cache, B_wq, B_wo)
    return torch.concatenate([a, b], axis=-1)
```

```asm
; @launch kernel=mha_attn_kernel grid=(256,1,1) block=(256,1,1) lds=163840
; @launch kernel=mha_reduce_kernel grid=(640,1,1) block=(256,1,1) lds=0
.amdgcn_target "amdgcn-amd-amdhsa--gfx950"
.text
.globl mha_attn_kernel
.p2align 8
.type mha_attn_kernel,@function
mha_attn_kernel:
 s_cmp_ge_u32 s2, 256
 s_cbranch_scc1 L_k1_end
 s_load_dwordx16 s[64:79], s[0:1], 0
 s_load_dwordx8 s[80:87], s[0:1], 64
 s_load_dwordx2 s[100:101], s[0:1], 96
 s_and_b32 s3, s2, 7
 s_lshr_b32 s4, s2, 3
 s_lshr_b32 s5, s3, 2
 s_and_b32 s45, s3, 3
 s_and_b32 s46, s4, 3
 s_lshl_b32 s3, s45, 2
 s_add_u32 s3, s3, s46
 s_lshl_b32 s3, s3, 1
 s_lshr_b32 s4, s4, 2
 v_lshrrev_b32 v1, 6, v0
 v_and_b32 v2, 63, v0
 s_nop 0
 v_readfirstlane_b32 s7, v1
 v_lshrrev_b32 v3, 4, v2
 v_and_b32 v4, 15, v2
 v_add_u32 v5, 0, v3
 v_xor_b32 v6, v5, v4
 v_lshl_add_u32 v5, v1, 5, v5
 v_mul_u32_u24 v5, 1280, v5
 v_lshl_add_u32 v8, v6, 4, v5
 v_add_u32 v5, 4, v3
 v_xor_b32 v6, v5, v4
 v_lshl_add_u32 v5, v1, 5, v5
 v_mul_u32_u24 v5, 1280, v5
 v_lshl_add_u32 v9, v6, 4, v5
 v_add_u32 v5, 8, v3
 v_xor_b32 v6, v5, v4
 v_lshl_add_u32 v5, v1, 5, v5
 v_mul_u32_u24 v5, 1280, v5
 v_lshl_add_u32 v10, v6, 4, v5
 v_add_u32 v5, 12, v3
 v_xor_b32 v6, v5, v4
 v_lshl_add_u32 v5, v1, 5, v5
 v_mul_u32_u24 v5, 1280, v5
 v_lshl_add_u32 v11, v6, 4, v5
 s_waitcnt lgkmcnt(0)
 s_cmp_eq_u32 s5, 0
 s_cselect_b64 s[64:65], s[64:65], s[74:75]
 s_cselect_b64 s[66:67], s[66:67], s[76:77]
 s_cselect_b64 s[68:69], s[68:69], s[78:79]
 s_cselect_b64 s[70:71], s[70:71], s[80:81]
 s_cselect_b64 s[72:73], s[72:73], s[82:83]
 s_mul_i32 s37, s4, 163840
 s_add_u32 s76, s64, s37
 s_addc_u32 s77, s65, 0
 s_mov_b32 s78, 163840
 s_mov_b32 s79, 0x20000
 s_mul_i32 s37, s3, 384
 s_sub_u32 s39, 7864320, s37
 s_add_u32 s16, s70, s37
 s_addc_u32 s17, s71, 0
 s_mov_b32 s18, s39
 s_mov_b32 s19, 0x20000
 s_mul_i32 s38, s7, 8192
 s_add_u32 m0, s38, 0
 s_mov_b32 s39, 0
 buffer_load_dwordx4 v8, s[76:79], s39 offen nt lds
 s_add_u32 m0, s38, 1024
 s_mov_b32 s39, 0
 buffer_load_dwordx4 v9, s[76:79], s39 offen nt lds
 s_add_u32 m0, s38, 2048
 s_mov_b32 s39, 0
 buffer_load_dwordx4 v10, s[76:79], s39 offen nt lds
 s_add_u32 m0, s38, 3072
 s_mov_b32 s39, 0
 buffer_load_dwordx4 v11, s[76:79], s39 offen nt lds
 s_add_u32 m0, s38, 4096
 s_mov_b32 s39, 20480
 buffer_load_dwordx4 v8, s[76:79], s39 offen nt lds
 s_add_u32 m0, s38, 5120
 s_mov_b32 s39, 20480
 buffer_load_dwordx4 v9, s[76:79], s39 offen nt lds
 s_add_u32 m0, s38, 6144
 s_mov_b32 s39, 20480
 buffer_load_dwordx4 v10, s[76:79], s39 offen nt lds
 s_add_u32 m0, s38, 7168
 s_mov_b32 s39, 20480
 buffer_load_dwordx4 v11, s[76:79], s39 offen nt lds
 s_add_u32 m0, s38, 32768
 s_mov_b32 s39, 256
 buffer_load_dwordx4 v8, s[76:79], s39 offen nt lds
 s_add_u32 m0, s38, 33792
 s_mov_b32 s39, 256
 buffer_load_dwordx4 v9, s[76:79], s39 offen nt lds
 s_add_u32 m0, s38, 34816
 s_mov_b32 s39, 256
 buffer_load_dwordx4 v10, s[76:79], s39 offen nt lds
 s_add_u32 m0, s38, 35840
 s_mov_b32 s39, 256
 buffer_load_dwordx4 v11, s[76:79], s39 offen nt lds
 s_add_u32 m0, s38, 36864
 s_mov_b32 s39, 20736
 buffer_load_dwordx4 v8, s[76:79], s39 offen nt lds
 s_add_u32 m0, s38, 37888
 s_mov_b32 s39, 20736
 buffer_load_dwordx4 v9, s[76:79], s39 offen nt lds
 s_add_u32 m0, s38, 38912
 s_mov_b32 s39, 20736
 buffer_load_dwordx4 v10, s[76:79], s39 offen nt lds
 s_add_u32 m0, s38, 39936
 s_mov_b32 s39, 20736
 buffer_load_dwordx4 v11, s[76:79], s39 offen nt lds
 s_add_u32 m0, s38, 65536
 s_mov_b32 s39, 512
 buffer_load_dwordx4 v8, s[76:79], s39 offen nt lds
 s_add_u32 m0, s38, 66560
 s_mov_b32 s39, 512
 buffer_load_dwordx4 v9, s[76:79], s39 offen nt lds
 s_add_u32 m0, s38, 67584
 s_mov_b32 s39, 512
 buffer_load_dwordx4 v10, s[76:79], s39 offen nt lds
 s_add_u32 m0, s38, 68608
 s_mov_b32 s39, 512
 buffer_load_dwordx4 v11, s[76:79], s39 offen nt lds
 s_add_u32 m0, s38, 69632
 s_mov_b32 s39, 20992
 buffer_load_dwordx4 v8, s[76:79], s39 offen nt lds
 s_add_u32 m0, s38, 70656
 s_mov_b32 s39, 20992
 buffer_load_dwordx4 v9, s[76:79], s39 offen nt lds
 s_add_u32 m0, s38, 71680
 s_mov_b32 s39, 20992
 buffer_load_dwordx4 v10, s[76:79], s39 offen nt lds
 s_add_u32 m0, s38, 72704
 s_mov_b32 s39, 20992
 buffer_load_dwordx4 v11, s[76:79], s39 offen nt lds
 s_add_u32 m0, s38, 98304
 s_mov_b32 s39, 768
 buffer_load_dwordx4 v8, s[76:79], s39 offen nt lds
 s_add_u32 m0, s38, 99328
 s_mov_b32 s39, 768
 buffer_load_dwordx4 v9, s[76:79], s39 offen nt lds
 s_add_u32 m0, s38, 100352
 s_mov_b32 s39, 768
 buffer_load_dwordx4 v10, s[76:79], s39 offen nt lds
 s_add_u32 m0, s38, 101376
 s_mov_b32 s39, 768
 buffer_load_dwordx4 v11, s[76:79], s39 offen nt lds
 s_add_u32 m0, s38, 102400
 s_mov_b32 s39, 21248
 buffer_load_dwordx4 v8, s[76:79], s39 offen nt lds
 s_add_u32 m0, s38, 103424
 s_mov_b32 s39, 21248
 buffer_load_dwordx4 v9, s[76:79], s39 offen nt lds
 s_add_u32 m0, s38, 104448
 s_mov_b32 s39, 21248
 buffer_load_dwordx4 v10, s[76:79], s39 offen nt lds
 s_add_u32 m0, s38, 105472
 s_mov_b32 s39, 21248
 buffer_load_dwordx4 v11, s[76:79], s39 offen nt lds
 s_add_u32 m0, s38, 131072
 s_mov_b32 s39, 1024
 buffer_load_dwordx4 v8, s[76:79], s39 offen nt lds
 s_add_u32 m0, s38, 132096
 s_mov_b32 s39, 1024
 buffer_load_dwordx4 v9, s[76:79], s39 offen nt lds
 s_add_u32 m0, s38, 133120
 s_mov_b32 s39, 1024
 buffer_load_dwordx4 v10, s[76:79], s39 offen nt lds
 s_add_u32 m0, s38, 134144
 s_mov_b32 s39, 1024
 buffer_load_dwordx4 v11, s[76:79], s39 offen nt lds
 s_add_u32 m0, s38, 135168
 s_mov_b32 s39, 21504
 buffer_load_dwordx4 v8, s[76:79], s39 offen nt lds
 s_add_u32 m0, s38, 136192
 s_mov_b32 s39, 21504
 buffer_load_dwordx4 v9, s[76:79], s39 offen nt lds
 s_add_u32 m0, s38, 137216
 s_mov_b32 s39, 21504
 buffer_load_dwordx4 v10, s[76:79], s39 offen nt lds
 s_add_u32 m0, s38, 138240
 s_mov_b32 s39, 21504
 buffer_load_dwordx4 v11, s[76:79], s39 offen nt lds
 s_lshl_b32 s6, s4, 5
 s_add_u32 s6, s6, s3
 s_mul_i32 s37, s6, 393216
 s_add_u32 s8, s66, s37
 s_addc_u32 s9, s67, 0
 s_mov_b32 s10, 786432
 s_mov_b32 s11, 0x20000
 s_add_u32 s12, s68, s37
 s_addc_u32 s13, s69, 0
 s_mov_b32 s14, 786432
 s_mov_b32 s15, 0x20000
 s_mul_i32 s37, s3, 245760
 s_add_u32 s48, s72, s37
 s_addc_u32 s49, s73, 0
 s_mov_b32 s50, 491520
 s_mov_b32 s51, 0x20000
 s_add_u32 s37, s3, s5
 s_lshl_b32 s37, s37, 3
 s_add_u32 s37, s37, s4
 s_mul_i32 s37, s37, 163840
 s_add_u32 s60, s100, s37
 s_addc_u32 s61, s101, 0
 s_mov_b32 s62, 163840
 s_mov_b32 s63, 0x20000
 s_add_u32 s20, s84, 0
 s_addc_u32 s21, s85, 0
 s_mov_b32 s22, 2621440
 s_mov_b32 s23, 0x20000
 s_add_u32 s52, s100, 0
 s_addc_u32 s53, s101, 0
 s_mov_b32 s54, 41943040
 s_mov_b32 s55, 0x20000
 s_add_u32 s56, s86, 0
 s_addc_u32 s57, s87, 0
 s_mov_b32 s58, 256
 s_mov_b32 s59, 0x20000
 s_lshl_b32 s47, s5, 3
 s_add_u32 s47, s47, s4
 s_mul_i32 s40, s7, 3072
 s_add_u32 s41, s40, 12288
 s_mul_i32 s42, s7, 5120
 v_lshrrev_b32 v3, 3, v2
 v_and_b32 v4, 7, v2
 v_add_u32 v5, 0, v3
 v_mul_u32_u24 v6, 43, v5
 v_lshrrev_b32 v6, 7, v6
 v_mul_u32_u24 v7, 3, v6
 v_sub_u32 v7, v5, v7
 v_lshl_add_u32 v6, v1, 3, v6
 v_lshlrev_b32 v8, 7, v3
 v_add_u32 v8, s40, v8
 v_bfe_u32 v9, v6, 1, 3
 v_xor_b32 v9, v9, v4
 v_lshl_add_u32 v214, v9, 4, v8
 v_bfe_u32 v9, v6, 1, 1
 v_lshlrev_b32 v9, 2, v9
 v_xor_b32 v9, v9, v4
 v_lshl_add_u32 v217, v9, 4, v8
 v_mul_u32_u24 v10, 12288, v6
 v_lshl_add_u32 v10, v7, 7, v10
 v_lshl_add_u32 v10, v9, 4, v10
 v_subrev_u32 v220, 0, v10
 v_add_u32 v5, 8, v3
 v_mul_u32_u24 v6, 43, v5
 v_lshrrev_b32 v6, 7, v6
 v_mul_u32_u24 v7, 3, v6
 v_sub_u32 v7, v5, v7
 v_lshl_add_u32 v6, v1, 3, v6
 v_lshlrev_b32 v8, 7, v3
 v_add_u32 v8, s40, v8
 v_bfe_u32 v9, v6, 1, 3
 v_xor_b32 v9, v9, v4
 v_lshl_add_u32 v215, v9, 4, v8
 v_bfe_u32 v9, v6, 1, 1
 v_lshlrev_b32 v9, 2, v9
 v_xor_b32 v9, v9, v4
 v_lshl_add_u32 v218, v9, 4, v8
 v_mul_u32_u24 v10, 12288, v6
 v_lshl_add_u32 v10, v7, 7, v10
 v_lshl_add_u32 v10, v9, 4, v10
 v_subrev_u32 v221, 1024, v10
 v_add_u32 v5, 16, v3
 v_mul_u32_u24 v6, 43, v5
 v_lshrrev_b32 v6, 7, v6
 v_mul_u32_u24 v7, 3, v6
 v_sub_u32 v7, v5, v7
 v_lshl_add_u32 v6, v1, 3, v6
 v_lshlrev_b32 v8, 7, v3
 v_add_u32 v8, s40, v8
 v_bfe_u32 v9, v6, 1, 3
 v_xor_b32 v9, v9, v4
 v_lshl_add_u32 v216, v9, 4, v8
 v_bfe_u32 v9, v6, 1, 1
 v_lshlrev_b32 v9, 2, v9
 v_xor_b32 v9, v9, v4
 v_lshl_add_u32 v219, v9, 4, v8
 v_mul_u32_u24 v10, 12288, v6
 v_lshl_add_u32 v10, v7, 7, v10
 v_lshl_add_u32 v10, v9, 4, v10
 v_subrev_u32 v222, 2048, v10
 s_mov_b32 s29, 0
 s_mov_b32 s27, 0
 s_mov_b32 s28, 0
 s_mov_b32 s43, 0
 s_mov_b32 s44, 0
 s_mov_b32 s33, 0
 v_and_b32 v5, 31, v2
 v_lshrrev_b32 v6, 5, v2
 v_mul_u32_u24 v8, 384, v5
 v_bfe_u32 v9, v5, 1, 3
 v_xor_b32 v9, v9, v6
 v_lshl_add_u32 v200, v9, 4, v8
 v_bfe_u32 v8, v2, 2, 2
 v_bfe_u32 v9, v2, 4, 1
 v_lshlrev_b32 v9, 5, v9
 v_and_b32 v10, 1, v2
 v_lshl_add_u32 v9, v10, 4, v9
 v_bfe_u32 v10, v2, 1, 1
 v_lshl_add_u32 v9, v10, 3, v9
 v_lshrrev_b32 v10, 1, v8
 v_lshl_add_u32 v9, v10, 6, v9
 v_lshl_add_u32 v10, v6, 2, v8
 v_mul_u32_u24 v10, 384, v10
 v_add_u32 v204, v10, v9
 v_lshl_add_u32 v10, v6, 4, v8
 v_mul_u32_u24 v10, 384, v10
 v_add_u32 v206, v10, v9
 s_mov_b32 s32, 0x3dd53b95
 s_mov_b32 s36, 0x4299ac27
 v_lshl_add_u32 v10, v6, 4, v8
 v_lshl_add_u32 v14, v10, 7, v9
 v_lshrrev_b32 v3, 3, v2
 v_and_b32 v4, 7, v2
 v_bfe_u32 v9, v3, 1, 1
 v_lshlrev_b32 v9, 2, v9
 v_xor_b32 v9, v9, v4
 v_mul_u32_u24 v10, 40, v1
 v_add_u32 v10, v10, v3
 v_mul_u32_u24 v10, 12288, v10
 v_lshl_add_u32 v13, v9, 4, v10
 v_and_b32 v7, 15, v5
 v_lshlrev_b32 v8, 1, v6
 v_xor_b32 v7, v7, v8
 v_lshlrev_b32 v7, 4, v7
 v_lshl_add_u32 v7, v5, 8, v7
 v_add_u32 v7, s38, v7
 v_xor_b32 v16, 0, v7
 v_xor_b32 v17, 16, v7
 v_xor_b32 v18, 64, v7
 v_xor_b32 v19, 80, v7
 v_xor_b32 v20, 128, v7
 v_xor_b32 v21, 144, v7
 v_xor_b32 v22, 192, v7
 v_xor_b32 v23, 208, v7
 s_waitcnt vmcnt(32)
 ds_read_b128 a[0:3], v16 offset:0
 ds_read_b128 a[4:7], v17 offset:0
 ds_read_b128 a[8:11], v18 offset:0
 ds_read_b128 a[12:15], v19 offset:0
 ds_read_b128 a[16:19], v20 offset:0
 ds_read_b128 a[20:23], v21 offset:0
 ds_read_b128 a[24:27], v22 offset:0
 ds_read_b128 a[28:31], v23 offset:0
 s_waitcnt lgkmcnt(0)
 s_barrier
 s_mov_b32 s25, 0
 s_add_u32 m0, s25, s40
 s_nop 0
 buffer_load_dwordx4 v220, s[16:19], s29 offen offset:0 nt lds
 buffer_load_dwordx4 v221, s[16:19], s29 offen offset:1024 nt lds
 buffer_load_dwordx4 v222, s[16:19], s29 offen offset:2048 nt lds
 s_add_u32 s29, s29, 393216
 s_add_u32 m0, s25, s41
 s_nop 0
 buffer_load_dwordx4 v220, s[16:19], s29 offen offset:0 nt lds
 buffer_load_dwordx4 v221, s[16:19], s29 offen offset:1024 nt lds
 buffer_load_dwordx4 v222, s[16:19], s29 offen offset:2048 nt lds
 s_add_u32 s29, s29, 393216
 s_waitcnt vmcnt(30)
 ds_read_b128 a[32:35], v16 offset:32768
 ds_read_b128 a[36:39], v17 offset:32768
 ds_read_b128 a[40:43], v18 offset:32768
 ds_read_b128 a[44:47], v19 offset:32768
 ds_read_b128 a[48:51], v20 offset:32768
 ds_read_b128 a[52:55], v21 offset:32768
 ds_read_b128 a[56:59], v22 offset:32768
 ds_read_b128 a[60:63], v23 offset:32768
 v_add_u32 v16, 0x10000, v16
 v_add_u32 v17, 0x10000, v17
 v_add_u32 v18, 0x10000, v18
 v_add_u32 v19, 0x10000, v19
 v_add_u32 v20, 0x10000, v20
 v_add_u32 v21, 0x10000, v21
 v_add_u32 v22, 0x10000, v22
 v_add_u32 v23, 0x10000, v23
 s_waitcnt lgkmcnt(0)
 s_barrier
 s_mov_b32 s25, 24576
 s_add_u32 m0, s25, s40
 s_nop 0
 buffer_load_dwordx4 v220, s[16:19], s29 offen offset:0 nt lds
 buffer_load_dwordx4 v221, s[16:19], s29 offen offset:1024 nt lds
 buffer_load_dwordx4 v222, s[16:19], s29 offen offset:2048 nt lds
 s_add_u32 s29, s29, 393216
 s_add_u32 m0, s25, s41
 s_nop 0
 buffer_load_dwordx4 v220, s[16:19], s29 offen offset:0 nt lds
 buffer_load_dwordx4 v221, s[16:19], s29 offen offset:1024 nt lds
 buffer_load_dwordx4 v222, s[16:19], s29 offen offset:2048 nt lds
 s_add_u32 s29, s29, 393216
 s_waitcnt vmcnt(28)
 ds_read_b128 a[64:67], v16 offset:0
 ds_read_b128 a[68:71], v17 offset:0
 ds_read_b128 a[72:75], v18 offset:0
 ds_read_b128 a[76:79], v19 offset:0
 ds_read_b128 a[80:83], v20 offset:0
 ds_read_b128 a[84:87], v21 offset:0
 ds_read_b128 a[88:91], v22 offset:0
 ds_read_b128 a[92:95], v23 offset:0
 s_waitcnt lgkmcnt(0)
 s_barrier
 s_mov_b32 s25, 49152
 s_add_u32 m0, s25, s40
 s_nop 0
 buffer_load_dwordx4 v220, s[16:19], s29 offen offset:0 nt lds
 buffer_load_dwordx4 v221, s[16:19], s29 offen offset:1024 nt lds
 buffer_load_dwordx4 v222, s[16:19], s29 offen offset:2048 nt lds
 s_add_u32 s29, s29, 393216
 s_add_u32 m0, s25, s41
 s_nop 0
 buffer_load_dwordx4 v220, s[16:19], s29 offen offset:0 nt lds
 buffer_load_dwordx4 v221, s[16:19], s29 offen offset:1024 nt lds
 buffer_load_dwordx4 v222, s[16:19], s29 offen offset:2048 nt lds
 s_add_u32 s29, s29, 393216
 s_mov_b32 s25, 73728
 s_add_u32 m0, s25, s40
 s_nop 0
 buffer_load_dwordx4 v220, s[16:19], s29 offen offset:0 nt lds
 buffer_load_dwordx4 v221, s[16:19], s29 offen offset:1024 nt lds
 buffer_load_dwordx4 v222, s[16:19], s29 offen offset:2048 nt lds
 s_add_u32 s29, s29, 393216
 s_add_u32 m0, s25, s41
 s_nop 0
 buffer_load_dwordx4 v220, s[16:19], s29 offen offset:0 nt lds
 buffer_load_dwordx4 v221, s[16:19], s29 offen offset:1024 nt lds
 buffer_load_dwordx4 v222, s[16:19], s29 offen offset:2048 nt lds
 s_add_u32 s29, s29, 393216
 s_waitcnt vmcnt(32)
 ds_read_b128 a[96:99], v16 offset:32768
 ds_read_b128 a[100:103], v17 offset:32768
 ds_read_b128 a[104:107], v18 offset:32768
 ds_read_b128 a[108:111], v19 offset:32768
 ds_read_b128 a[112:115], v20 offset:32768
 ds_read_b128 a[116:119], v21 offset:32768
 ds_read_b128 a[120:123], v22 offset:32768
 ds_read_b128 a[124:127], v23 offset:32768
 v_add_u32 v16, 0x10000, v16
 v_add_u32 v17, 0x10000, v17
 v_add_u32 v18, 0x10000, v18
 v_add_u32 v19, 0x10000, v19
 v_add_u32 v20, 0x10000, v20
 v_add_u32 v21, 0x10000, v21
 v_add_u32 v22, 0x10000, v22
 v_add_u32 v23, 0x10000, v23
 s_waitcnt lgkmcnt(0)
 s_barrier
 s_mov_b32 s25, 98304
 s_add_u32 m0, s25, s40
 s_nop 0
 buffer_load_dwordx4 v220, s[16:19], s29 offen offset:0 nt lds
 buffer_load_dwordx4 v221, s[16:19], s29 offen offset:1024 nt lds
 buffer_load_dwordx4 v222, s[16:19], s29 offen offset:2048 nt lds
 s_add_u32 s29, s29, 393216
 s_add_u32 m0, s25, s41
 s_nop 0
 buffer_load_dwordx4 v220, s[16:19], s29 offen offset:0 nt lds
 buffer_load_dwordx4 v221, s[16:19], s29 offen offset:1024 nt lds
 buffer_load_dwordx4 v222, s[16:19], s29 offen offset:2048 nt lds
 s_add_u32 s29, s29, 393216
 s_waitcnt vmcnt(30)
 ds_read_b128 a[128:131], v16 offset:0
 ds_read_b128 a[132:135], v17 offset:0
 ds_read_b128 a[136:139], v18 offset:0
 ds_read_b128 a[140:143], v19 offset:0
 ds_read_b128 a[144:147], v20 offset:0
 ds_read_b128 a[148:151], v21 offset:0
 ds_read_b128 a[152:155], v22 offset:0
 ds_read_b128 a[156:159], v23 offset:0
 s_mov_b32 s24, 122880
 s_mov_b32 s25, s24
 s_add_u32 s24, s24, 24576
 s_cmp_eq_u32 s24, 147456
 s_cselect_b32 s24, 0, s24
 v_add_u32 v212, s24, v206
 v_xor_b32 v213, 64, v212
 s_waitcnt vmcnt(24) lgkmcnt(0)
 s_barrier
 ds_read_b64_tr_b16 v[112:113], v212 offset:0
 ds_read_b64_tr_b16 v[114:115], v212 offset:1536
 ds_read_b64_tr_b16 v[116:117], v213 offset:0
 ds_read_b64_tr_b16 v[118:119], v213 offset:1536
 ds_read_b64_tr_b16 v[120:121], v212 offset:128
 ds_read_b64_tr_b16 v[122:123], v212 offset:1664
 ds_read_b64_tr_b16 v[124:125], v213 offset:128
 ds_read_b64_tr_b16 v[126:127], v213 offset:1664
 ds_read_b64_tr_b16 v[128:129], v212 offset:256
 ds_read_b64_tr_b16 v[130:131], v212 offset:1792
 ds_read_b64_tr_b16 v[132:133], v213 offset:256
 ds_read_b64_tr_b16 v[134:135], v213 offset:1792
 ds_read_b64_tr_b16 v[136:137], v212 offset:3072
 ds_read_b64_tr_b16 v[138:139], v212 offset:4608
 ds_read_b64_tr_b16 v[140:141], v213 offset:3072
 ds_read_b64_tr_b16 v[142:143], v213 offset:4608
 ds_read_b64_tr_b16 v[144:145], v212 offset:3200
 ds_read_b64_tr_b16 v[146:147], v212 offset:4736
 ds_read_b64_tr_b16 v[148:149], v213 offset:3200
 ds_read_b64_tr_b16 v[150:151], v213 offset:4736
 ds_read_b64_tr_b16 v[152:153], v212 offset:3328
 ds_read_b64_tr_b16 v[154:155], v212 offset:4864
 ds_read_b64_tr_b16 v[156:157], v213 offset:3328
 ds_read_b64_tr_b16 v[158:159], v213 offset:4864
 s_add_u32 m0, s25, s40
 s_nop 0
 buffer_load_dwordx4 v220, s[16:19], s29 offen offset:0 nt lds
 buffer_load_dwordx4 v221, s[16:19], s29 offen offset:1024 nt lds
 buffer_load_dwordx4 v222, s[16:19], s29 offen offset:2048 nt lds
 s_add_u32 s29, s29, 393216
 s_waitcnt lgkmcnt(0)
 v_mfma_f32_32x32x16_bf16 a[160:175], v[112:115], a[0:3], 0
 ds_read_b64_tr_b16 v[64:65], v212 offset:12288
 ds_read_b64_tr_b16 v[66:67], v212 offset:13824
 ds_read_b64_tr_b16 v[68:69], v213 offset:12288
 v_mfma_f32_32x32x16_bf16 a[176:191], v[116:119], a[0:3], 0
 ds_read_b64_tr_b16 v[70:71], v213 offset:13824
 ds_read_b64_tr_b16 v[72:73], v212 offset:12416
 ds_read_b64_tr_b16 v[74:75], v212 offset:13952
 v_mfma_f32_32x32x16_bf16 a[192:207], v[120:123], a[0:3], 0
 ds_read_b64_tr_b16 v[76:77], v213 offset:12416
 ds_read_b64_tr_b16 v[78:79], v213 offset:13952
 ds_read_b64_tr_b16 v[80:81], v212 offset:12544
 s_add_u32 m0, s25, s41
 s_nop 0
 buffer_load_dwordx4 v220, s[16:19], s29 offen offset:0 nt lds
 v_mfma_f32_32x32x16_bf16 a[208:223], v[124:127], a[0:3], 0
 ds_read_b64_tr_b16 v[82:83], v212 offset:14080
 ds_read_b64_tr_b16 v[84:85], v213 offset:12544
 ds_read_b64_tr_b16 v[86:87], v213 offset:14080
 v_mfma_f32_32x32x16_bf16 a[224:239], v[128:131], a[0:3], 0
 ds_read_b64_tr_b16 v[88:89], v212 offset:15360
 ds_read_b64_tr_b16 v[90:91], v212 offset:16896
 ds_read_b64_tr_b16 v[92:93], v213 offset:15360
 v_mfma_f32_32x32x16_bf16 a[240:255], v[132:135], a[0:3], 0
 ds_read_b64_tr_b16 v[94:95], v213 offset:16896
 ds_read_b64_tr_b16 v[96:97], v212 offset:15488
 ds_read_b64_tr_b16 v[98:99], v212 offset:17024
 buffer_load_dwordx4 v221, s[16:19], s29 offen offset:1024 nt lds
 v_mfma_f32_32x32x16_bf16 a[160:175], v[136:139], a[4:7], a[160:175]
 ds_read_b64_tr_b16 v[100:101], v213 offset:15488
 ds_read_b64_tr_b16 v[102:103], v213 offset:17024
 ds_read_b64_tr_b16 v[104:105], v212 offset:15616
 v_mfma_f32_32x32x16_bf16 a[176:191], v[140:143], a[4:7], a[176:191]
 ds_read_b64_tr_b16 v[106:107], v212 offset:17152
 ds_read_b64_tr_b16 v[108:109], v213 offset:15616
 ds_read_b64_tr_b16 v[110:111], v213 offset:17152
 v_mfma_f32_32x32x16_bf16 a[192:207], v[144:147], a[4:7], a[192:207]
 buffer_load_dwordx4 v222, s[16:19], s29 offen offset:2048 nt lds
 s_add_u32 s29, s29, 393216
 v_mfma_f32_32x32x16_bf16 a[208:223], v[148:151], a[4:7], a[208:223]
 v_mfma_f32_32x32x16_bf16 a[224:239], v[152:155], a[4:7], a[224:239]
 v_mfma_f32_32x32x16_bf16 a[240:255], v[156:159], a[4:7], a[240:255]
 s_mov_b32 s25, s24
 s_add_u32 s24, s24, 24576
 s_cmp_eq_u32 s24, 147456
 s_cselect_b32 s24, 0, s24
 v_add_u32 v212, s24, v206
 v_xor_b32 v213, 64, v212
 s_waitcnt vmcnt(24) lgkmcnt(0)
 s_barrier
 v_mfma_f32_32x32x16_bf16 a[160:175], v[64:67], a[8:11], a[160:175]
 ds_read_b64_tr_b16 v[112:113], v212 offset:0
 ds_read_b64_tr_b16 v[114:115], v212 offset:1536
 ds_read_b64_tr_b16 v[116:117], v213 offset:0
 v_mfma_f32_32x32x16_bf16 a[176:191], v[68:71], a[8:11], a[176:191]
 ds_read_b64_tr_b16 v[118:119], v213 offset:1536
 ds_read_b64_tr_b16 v[120:121], v212 offset:128
 ds_read_b64_tr_b16 v[122:123], v212 offset:1664
 v_mfma_f32_32x32x16_bf16 a[192:207], v[72:75], a[8:11], a[192:207]
 ds_read_b64_tr_b16 v[124:125], v213 offset:128
 ds_read_b64_tr_b16 v[126:127], v213 offset:1664
 ds_read_b64_tr_b16 v[128:129], v212 offset:256
 s_add_u32 m0, s25, s40
 s_nop 0
 buffer_load_dwordx4 v220, s[16:19], s29 offen offset:0 nt lds
 v_mfma_f32_32x32x16_bf16 a[208:223], v[76:79], a[8:11], a[208:223]
 ds_read_b64_tr_b16 v[130:131], v212 offset:1792
 ds_read_b64_tr_b16 v[132:133], v213 offset:256
 ds_read_b64_tr_b16 v[134:135], v213 offset:1792
 v_mfma_f32_32x32x16_bf16 a[224:239], v[80:83], a[8:11], a[224:239]
 ds_read_b64_tr_b16 v[136:137], v212 offset:3072
 ds_read_b64_tr_b16 v[138:139], v212 offset:4608
 ds_read_b64_tr_b16 v[140:141], v213 offset:3072
 v_mfma_f32_32x32x16_bf16 a[240:255], v[84:87], a[8:11], a[240:255]
 ds_read_b64_tr_b16 v[142:143], v213 offset:4608
 ds_read_b64_tr_b16 v[144:145], v212 offset:3200
 ds_read_b64_tr_b16 v[146:147], v212 offset:4736
 buffer_load_dwordx4 v221, s[16:19], s29 offen offset:1024 nt lds
 v_mfma_f32_32x32x16_bf16 a[160:175], v[88:91], a[12:15], a[160:175]
 ds_read_b64_tr_b16 v[148:149], v213 offset:3200
 ds_read_b64_tr_b16 v[150:151], v213 offset:4736
 ds_read_b64_tr_b16 v[152:153], v212 offset:3328
 v_mfma_f32_32x32x16_bf16 a[176:191], v[92:95], a[12:15], a[176:191]
 ds_read_b64_tr_b16 v[154:155], v212 offset:4864
 ds_read_b64_tr_b16 v[156:157], v213 offset:3328
 ds_read_b64_tr_b16 v[158:159], v213 offset:4864
 v_mfma_f32_32x32x16_bf16 a[192:207], v[96:99], a[12:15], a[192:207]
 buffer_load_dwordx4 v222, s[16:19], s29 offen offset:2048 nt lds
 s_add_u32 s29, s29, 393216
 v_mfma_f32_32x32x16_bf16 a[208:223], v[100:103], a[12:15], a[208:223]
 v_mfma_f32_32x32x16_bf16 a[224:239], v[104:107], a[12:15], a[224:239]
 v_mfma_f32_32x32x16_bf16 a[240:255], v[108:111], a[12:15], a[240:255]
 s_waitcnt lgkmcnt(0)
 v_mfma_f32_32x32x16_bf16 a[160:175], v[112:115], a[16:19], a[160:175]
 ds_read_b64_tr_b16 v[64:65], v212 offset:12288
 ds_read_b64_tr_b16 v[66:67], v212 offset:13824
 ds_read_b64_tr_b16 v[68:69], v213 offset:12288
 v_mfma_f32_32x32x16_bf16 a[176:191], v[116:119], a[16:19], a[176:191]
 ds_read_b64_tr_b16 v[70:71], v213 offset:13824
 ds_read_b64_tr_b16 v[72:73], v212 offset:12416
 ds_read_b64_tr_b16 v[74:75], v212 offset:13952
 v_mfma_f32_32x32x16_bf16 a[192:207], v[120:123], a[16:19], a[192:207]
 ds_read_b64_tr_b16 v[76:77], v213 offset:12416
 ds_read_b64_tr_b16 v[78:79], v213 offset:13952
 ds_read_b64_tr_b16 v[80:81], v212 offset:12544
 s_add_u32 m0, s25, s41
 s_nop 0
 buffer_load_dwordx4 v220, s[16:19], s29 offen offset:0 nt lds
 v_mfma_f32_32x32x16_bf16 a[208:223], v[124:127], a[16:19], a[208:223]
 ds_read_b64_tr_b16 v[82:83], v212 offset:14080
 ds_read_b64_tr_b16 v[84:85], v213 offset:12544
 ds_read_b64_tr_b16 v[86:87], v213 offset:14080
 v_mfma_f32_32x32x16_bf16 a[224:239], v[128:131], a[16:19], a[224:239]
 ds_read_b64_tr_b16 v[88:89], v212 offset:15360
 ds_read_b64_tr_b16 v[90:91], v212 offset:16896
 ds_read_b64_tr_b16 v[92:93], v213 offset:15360
 v_mfma_f32_32x32x16_bf16 a[240:255], v[132:135], a[16:19], a[240:255]
 ds_read_b64_tr_b16 v[94:95], v213 offset:16896
 ds_read_b64_tr_b16 v[96:97], v212 offset:15488
 ds_read_b64_tr_b16 v[98:99], v212 offset:17024
 buffer_load_dwordx4 v221, s[16:19], s29 offen offset:1024 nt lds
 v_mfma_f32_32x32x16_bf16 a[160:175], v[136:139], a[20:23], a[160:175]
 ds_read_b64_tr_b16 v[100:101], v213 offset:15488
 ds_read_b64_tr_b16 v[102:103], v213 offset:17024
 ds_read_b64_tr_b16 v[104:105], v212 offset:15616
 v_mfma_f32_32x32x16_bf16 a[176:191], v[140:143], a[20:23], a[176:191]
 ds_read_b64_tr_b16 v[106:107], v212 offset:17152
 ds_read_b64_tr_b16 v[108:109], v213 offset:15616
 ds_read_b64_tr_b16 v[110:111], v213 offset:17152
 v_mfma_f32_32x32x16_bf16 a[192:207], v[144:147], a[20:23], a[192:207]
 buffer_load_dwordx4 v222, s[16:19], s29 offen offset:2048 nt lds
 s_add_u32 s29, s29, 393216
 v_mfma_f32_32x32x16_bf16 a[208:223], v[148:151], a[20:23], a[208:223]
 v_mfma_f32_32x32x16_bf16 a[224:239], v[152:155], a[20:23], a[224:239]
 v_mfma_f32_32x32x16_bf16 a[240:255], v[156:159], a[20:23], a[240:255]
 s_mov_b32 s25, s24
 s_add_u32 s24, s24, 24576
 s_cmp_eq_u32 s24, 147456
 s_cselect_b32 s24, 0, s24
 v_add_u32 v212, s24, v206
 v_xor_b32 v213, 64, v212
 s_waitcnt vmcnt(24) lgkmcnt(0)
 s_barrier
 v_mfma_f32_32x32x16_bf16 a[160:175], v[64:67], a[24:27], a[160:175]
 ds_read_b64_tr_b16 v[112:113], v212 offset:0
 ds_read_b64_tr_b16 v[114:115], v212 offset:1536
 ds_read_b64_tr_b16 v[116:117], v213 offset:0
 v_mfma_f32_32x32x16_bf16 a[176:191], v[68:71], a[24:27], a[176:191]
 ds_read_b64_tr_b16 v[118:119], v213 offset:1536
 ds_read_b64_tr_b16 v[120:121], v212 offset:128
 ds_read_b64_tr_b16 v[122:123], v212 offset:1664
 v_mfma_f32_32x32x16_bf16 a[192:207], v[72:75], a[24:27], a[192:207]
 ds_read_b64_tr_b16 v[124:125], v213 offset:128
 ds_read_b64_tr_b16 v[126:127], v213 offset:1664
 ds_read_b64_tr_b16 v[128:129], v212 offset:256
 s_add_u32 m0, s25, s40
 s_nop 0
 buffer_load_dwordx4 v220, s[16:19], s29 offen offset:0 nt lds
 v_mfma_f32_32x32x16_bf16 a[208:223], v[76:79], a[24:27], a[208:223]
 ds_read_b64_tr_b16 v[130:131], v212 offset:1792
 ds_read_b64_tr_b16 v[132:133], v213 offset:256
 ds_read_b64_tr_b16 v[134:135], v213 offset:1792
 v_mfma_f32_32x32x16_bf16 a[224:239], v[80:83], a[24:27], a[224:239]
 ds_read_b64_tr_b16 v[136:137], v212 offset:3072
 ds_read_b64_tr_b16 v[138:139], v212 offset:4608
 ds_read_b64_tr_b16 v[140:141], v213 offset:3072
 v_mfma_f32_32x32x16_bf16 a[240:255], v[84:87], a[24:27], a[240:255]
 ds_read_b64_tr_b16 v[142:143], v213 offset:4608
 ds_read_b64_tr_b16 v[144:145], v212 offset:3200
 ds_read_b64_tr_b16 v[146:147], v212 offset:4736
 buffer_load_dwordx4 v221, s[16:19], s29 offen offset:1024 nt lds
 v_mfma_f32_32x32x16_bf16 a[160:175], v[88:91], a[28:31], a[160:175]
 ds_read_b64_tr_b16 v[148:149], v213 offset:3200
 ds_read_b64_tr_b16 v[150:151], v213 offset:4736
 ds_read_b64_tr_b16 v[152:153], v212 offset:3328
 v_mfma_f32_32x32x16_bf16 a[176:191], v[92:95], a[28:31], a[176:191]
 ds_read_b64_tr_b16 v[154:155], v212 offset:4864
 ds_read_b64_tr_b16 v[156:157], v213 offset:3328
 ds_read_b64_tr_b16 v[158:159], v213 offset:4864
 v_mfma_f32_32x32x16_bf16 a[192:207], v[96:99], a[28:31], a[192:207]
 buffer_load_dwordx4 v222, s[16:19], s29 offen offset:2048 nt lds
 s_add_u32 s29, s29, 393216
 v_mfma_f32_32x32x16_bf16 a[208:223], v[100:103], a[28:31], a[208:223]
 v_mfma_f32_32x32x16_bf16 a[224:239], v[104:107], a[28:31], a[224:239]
 v_mfma_f32_32x32x16_bf16 a[240:255], v[108:111], a[28:31], a[240:255]
 s_waitcnt lgkmcnt(0)
 v_mfma_f32_32x32x16_bf16 a[160:175], v[112:115], a[32:35], a[160:175]
 ds_read_b64_tr_b16 v[64:65], v212 offset:12288
 ds_read_b64_tr_b16 v[66:67], v212 offset:13824
 ds_read_b64_tr_b16 v[68:69], v213 offset:12288
 v_mfma_f32_32x32x16_bf16 a[176:191], v[116:119], a[32:35], a[176:191]
 ds_read_b64_tr_b16 v[70:71], v213 offset:13824
 ds_read_b64_tr_b16 v[72:73], v212 offset:12416
 ds_read_b64_tr_b16 v[74:75], v212 offset:13952
 v_mfma_f32_32x32x16_bf16 a[192:207], v[120:123], a[32:35], a[192:207]
 ds_read_b64_tr_b16 v[76:77], v213 offset:12416
 ds_read_b64_tr_b16 v[78:79], v213 offset:13952
 ds_read_b64_tr_b16 v[80:81], v212 offset:12544
 s_add_u32 m0, s25, s41
 s_nop 0
 buffer_load_dwordx4 v220, s[16:19], s29 offen offset:0 nt lds
 v_mfma_f32_32x32x16_bf16 a[208:223], v[124:127], a[32:35], a[208:223]
 ds_read_b64_tr_b16 v[82:83], v212 offset:14080
 ds_read_b64_tr_b16 v[84:85], v213 offset:12544
 ds_read_b64_tr_b16 v[86:87], v213 offset:14080
 v_mfma_f32_32x32x16_bf16 a[224:239], v[128:131], a[32:35], a[224:239]
 ds_read_b64_tr_b16 v[88:89], v212 offset:15360
 ds_read_b64_tr_b16 v[90:91], v212 offset:16896
 ds_read_b64_tr_b16 v[92:93], v213 offset:15360
 v_mfma_f32_32x32x16_bf16 a[240:255], v[132:135], a[32:35], a[240:255]
 ds_read_b64_tr_b16 v[94:95], v213 offset:16896
 ds_read_b64_tr_b16 v[96:97], v212 offset:15488
 ds_read_b64_tr_b16 v[98:99], v212 offset:17024
 buffer_load_dwordx4 v221, s[16:19], s29 offen offset:1024 nt lds
 v_mfma_f32_32x32x16_bf16 a[160:175], v[136:139], a[36:39], a[160:175]
 ds_read_b64_tr_b16 v[100:101], v213 offset:15488
 ds_read_b64_tr_b16 v[102:103], v213 offset:17024
 ds_read_b64_tr_b16 v[104:105], v212 offset:15616
 v_mfma_f32_32x32x16_bf16 a[176:191], v[140:143], a[36:39], a[176:191]
 ds_read_b64_tr_b16 v[106:107], v212 offset:17152
 ds_read_b64_tr_b16 v[108:109], v213 offset:15616
 ds_read_b64_tr_b16 v[110:111], v213 offset:17152
 v_mfma_f32_32x32x16_bf16 a[192:207], v[144:147], a[36:39], a[192:207]
 buffer_load_dwordx4 v222, s[16:19], s29 offen offset:2048 nt lds
 s_add_u32 s29, s29, 393216
 v_mfma_f32_32x32x16_bf16 a[208:223], v[148:151], a[36:39], a[208:223]
 v_mfma_f32_32x32x16_bf16 a[224:239], v[152:155], a[36:39], a[224:239]
 v_mfma_f32_32x32x16_bf16 a[240:255], v[156:159], a[36:39], a[240:255]
 s_mov_b32 s25, s24
 s_add_u32 s24, s24, 24576
 s_cmp_eq_u32 s24, 147456
 s_cselect_b32 s24, 0, s24
 v_add_u32 v212, s24, v206
 v_xor_b32 v213, 64, v212
 s_waitcnt vmcnt(24) lgkmcnt(0)
 s_barrier
 v_mfma_f32_32x32x16_bf16 a[160:175], v[64:67], a[40:43], a[160:175]
 ds_read_b64_tr_b16 v[112:113], v212 offset:0
 ds_read_b64_tr_b16 v[114:115], v212 offset:1536
 ds_read_b64_tr_b16 v[116:117], v213 offset:0
 v_mfma_f32_32x32x16_bf16 a[176:191], v[68:71], a[40:43], a[176:191]
 ds_read_b64_tr_b16 v[118:119], v213 offset:1536
 ds_read_b64_tr_b16 v[120:121], v212 offset:128
 ds_read_b64_tr_b16 v[122:123], v212 offset:1664
 v_mfma_f32_32x32x16_bf16 a[192:207], v[72:75], a[40:43], a[192:207]
 ds_read_b64_tr_b16 v[124:125], v213 offset:128
 ds_read_b64_tr_b16 v[126:127], v213 offset:1664
 ds_read_b64_tr_b16 v[128:129], v212 offset:256
 s_add_u32 m0, s25, s40
 s_nop 0
 buffer_load_dwordx4 v220, s[16:19], s29 offen offset:0 nt lds
 v_mfma_f32_32x32x16_bf16 a[208:223], v[76:79], a[40:43], a[208:223]
 ds_read_b64_tr_b16 v[130:131], v212 offset:1792
 ds_read_b64_tr_b16 v[132:133], v213 offset:256
 ds_read_b64_tr_b16 v[134:135], v213 offset:1792
 v_mfma_f32_32x32x16_bf16 a[224:239], v[80:83], a[40:43], a[224:239]
 ds_read_b64_tr_b16 v[136:137], v212 offset:3072
 ds_read_b64_tr_b16 v[138:139], v212 offset:4608
 ds_read_b64_tr_b16 v[140:141], v213 offset:3072
 v_mfma_f32_32x32x16_bf16 a[240:255], v[84:87], a[40:43], a[240:255]
 ds_read_b64_tr_b16 v[142:143], v213 offset:4608
 ds_read_b64_tr_b16 v[144:145], v212 offset:3200
 ds_read_b64_tr_b16 v[146:147], v212 offset:4736
 buffer_load_dwordx4 v221, s[16:19], s29 offen offset:1024 nt lds
 v_mfma_f32_32x32x16_bf16 a[160:175], v[88:91], a[44:47], a[160:175]
 ds_read_b64_tr_b16 v[148:149], v213 offset:3200
 ds_read_b64_tr_b16 v[150:151], v213 offset:4736
 ds_read_b64_tr_b16 v[152:153], v212 offset:3328
 v_mfma_f32_32x32x16_bf16 a[176:191], v[92:95], a[44:47], a[176:191]
 ds_read_b64_tr_b16 v[154:155], v212 offset:4864
 ds_read_b64_tr_b16 v[156:157], v213 offset:3328
 ds_read_b64_tr_b16 v[158:159], v213 offset:4864
 v_mfma_f32_32x32x16_bf16 a[192:207], v[96:99], a[44:47], a[192:207]
 buffer_load_dwordx4 v222, s[16:19], s29 offen offset:2048 nt lds
 s_add_u32 s29, s29, 393216
 v_mfma_f32_32x32x16_bf16 a[208:223], v[100:103], a[44:47], a[208:223]
 v_mfma_f32_32x32x16_bf16 a[224:239], v[104:107], a[44:47], a[224:239]
 v_mfma_f32_32x32x16_bf16 a[240:255], v[108:111], a[44:47], a[240:255]
 s_waitcnt lgkmcnt(0)
 v_mfma_f32_32x32x16_bf16 a[160:175], v[112:115], a[48:51], a[160:175]
 ds_read_b64_tr_b16 v[64:65], v212 offset:12288
 ds_read_b64_tr_b16 v[66:67], v212 offset:13824
 ds_read_b64_tr_b16 v[68:69], v213 offset:12288
 v_mfma_f32_32x32x16_bf16 a[176:191], v[116:119], a[48:51], a[176:191]
 ds_read_b64_tr_b16 v[70:71], v213 offset:13824
 ds_read_b64_tr_b16 v[72:73], v212 offset:12416
 ds_read_b64_tr_b16 v[74:75], v212 offset:13952
 v_mfma_f32_32x32x16_bf16 a[192:207], v[120:123], a[48:51], a[192:207]
 ds_read_b64_tr_b16 v[76:77], v213 offset:12416
 ds_read_b64_tr_b16 v[78:79], v213 offset:13952
 ds_read_b64_tr_b16 v[80:81], v212 offset:12544
 s_add_u32 m0, s25, s41
 s_nop 0
 buffer_load_dwordx4 v220, s[16:19], s29 offen offset:0 nt lds
 v_mfma_f32_32x32x16_bf16 a[208:223], v[124:127], a[48:51], a[208:223]
 ds_read_b64_tr_b16 v[82:83], v212 offset:14080
 ds_read_b64_tr_b16 v[84:85], v213 offset:12544
 ds_read_b64_tr_b16 v[86:87], v213 offset:14080
 v_mfma_f32_32x32x16_bf16 a[224:239], v[128:131], a[48:51], a[224:239]
 ds_read_b64_tr_b16 v[88:89], v212 offset:15360
 ds_read_b64_tr_b16 v[90:91], v212 offset:16896
 ds_read_b64_tr_b16 v[92:93], v213 offset:15360
 v_mfma_f32_32x32x16_bf16 a[240:255], v[132:135], a[48:51], a[240:255]
 ds_read_b64_tr_b16 v[94:95], v213 offset:16896
 ds_read_b64_tr_b16 v[96:97], v212 offset:15488
 ds_read_b64_tr_b16 v[98:99], v212 offset:17024
 buffer_load_dwordx4 v221, s[16:19], s29 offen offset:1024 nt lds
 v_mfma_f32_32x32x16_bf16 a[160:175], v[136:139], a[52:55], a[160:175]
 ds_read_b64_tr_b16 v[100:101], v213 offset:15488
 ds_read_b64_tr_b16 v[102:103], v213 offset:17024
 ds_read_b64_tr_b16 v[104:105], v212 offset:15616
 v_mfma_f32_32x32x16_bf16 a[176:191], v[140:143], a[52:55], a[176:191]
 ds_read_b64_tr_b16 v[106:107], v212 offset:17152
 ds_read_b64_tr_b16 v[108:109], v213 offset:15616
 ds_read_b64_tr_b16 v[110:111], v213 offset:17152
 v_mfma_f32_32x32x16_bf16 a[192:207], v[144:147], a[52:55], a[192:207]
 buffer_load_dwordx4 v222, s[16:19], s29 offen offset:2048 nt lds
 s_add_u32 s29, s29, 393216
 v_mfma_f32_32x32x16_bf16 a[208:223], v[148:151], a[52:55], a[208:223]
 v_mfma_f32_32x32x16_bf16 a[224:239], v[152:155], a[52:55], a[224:239]
 v_mfma_f32_32x32x16_bf16 a[240:255], v[156:159], a[52:55], a[240:255]
 s_mov_b32 s25, s24
 s_add_u32 s24, s24, 24576
 s_cmp_eq_u32 s24, 147456
 s_cselect_b32 s24, 0, s24
 v_add_u32 v212, s24, v206
 v_xor_b32 v213, 64, v212
 s_waitcnt vmcnt(24) lgkmcnt(0)
 s_barrier
 v_mfma_f32_32x32x16_bf16 a[160:175], v[64:67], a[56:59], a[160:175]
 ds_read_b64_tr_b16 v[112:113], v212 offset:0
 ds_read_b64_tr_b16 v[114:115], v212 offset:1536
 ds_read_b64_tr_b16 v[116:117], v213 offset:0
 v_mfma_f32_32x32x16_bf16 a[176:191], v[68:71], a[56:59], a[176:191]
 ds_read_b64_tr_b16 v[118:119], v213 offset:1536
 ds_read_b64_tr_b16 v[120:121], v212 offset:128
 ds_read_b64_tr_b16 v[122:123], v212 offset:1664
 v_mfma_f32_32x32x16_bf16 a[192:207], v[72:75], a[56:59], a[192:207]
 ds_read_b64_tr_b16 v[124:125], v213 offset:128
 ds_read_b64_tr_b16 v[126:127], v213 offset:1664
 ds_read_b64_tr_b16 v[128:129], v212 offset:256
 s_add_u32 m0, s25, s40
 s_nop 0
 buffer_load_dwordx4 v220, s[16:19], s29 offen offset:0 nt lds
 v_mfma_f32_32x32x16_bf16 a[208:223], v[76:79], a[56:59], a[208:223]
 ds_read_b64_tr_b16 v[130:131], v212 offset:1792
 ds_read_b64_tr_b16 v[132:133], v213 offset:256
 ds_read_b64_tr_b16 v[134:135], v213 offset:1792
 v_mfma_f32_32x32x16_bf16 a[224:239], v[80:83], a[56:59], a[224:239]
 ds_read_b64_tr_b16 v[136:137], v212 offset:3072
 ds_read_b64_tr_b16 v[138:139], v212 offset:4608
 ds_read_b64_tr_b16 v[140:141], v213 offset:3072
 v_mfma_f32_32x32x16_bf16 a[240:255], v[84:87], a[56:59], a[240:255]
 ds_read_b64_tr_b16 v[142:143], v213 offset:4608
 ds_read_b64_tr_b16 v[144:145], v212 offset:3200
 ds_read_b64_tr_b16 v[146:147], v212 offset:4736
 buffer_load_dwordx4 v221, s[16:19], s29 offen offset:1024 nt lds
 v_mfma_f32_32x32x16_bf16 a[160:175], v[88:91], a[60:63], a[160:175]
 ds_read_b64_tr_b16 v[148:149], v213 offset:3200
 ds_read_b64_tr_b16 v[150:151], v213 offset:4736
 ds_read_b64_tr_b16 v[152:153], v212 offset:3328
 v_mfma_f32_32x32x16_bf16 a[176:191], v[92:95], a[60:63], a[176:191]
 ds_read_b64_tr_b16 v[154:155], v212 offset:4864
 ds_read_b64_tr_b16 v[156:157], v213 offset:3328
 ds_read_b64_tr_b16 v[158:159], v213 offset:4864
 v_mfma_f32_32x32x16_bf16 a[192:207], v[96:99], a[60:63], a[192:207]
 buffer_load_dwordx4 v222, s[16:19], s29 offen offset:2048 nt lds
 s_add_u32 s29, s29, 393216
 v_mfma_f32_32x32x16_bf16 a[208:223], v[100:103], a[60:63], a[208:223]
 v_mfma_f32_32x32x16_bf16 a[224:239], v[104:107], a[60:63], a[224:239]
 v_mfma_f32_32x32x16_bf16 a[240:255], v[108:111], a[60:63], a[240:255]
 s_waitcnt lgkmcnt(0)
 v_mfma_f32_32x32x16_bf16 a[160:175], v[112:115], a[64:67], a[160:175]
 ds_read_b64_tr_b16 v[64:65], v212 offset:12288
 ds_read_b64_tr_b16 v[66:67], v212 offset:13824
 ds_read_b64_tr_b16 v[68:69], v213 offset:12288
 v_mfma_f32_32x32x16_bf16 a[176:191], v[116:119], a[64:67], a[176:191]
 ds_read_b64_tr_b16 v[70:71], v213 offset:13824
 ds_read_b64_tr_b16 v[72:73], v212 offset:12416
 ds_read_b64_tr_b16 v[74:75], v212 offset:13952
 v_mfma_f32_32x32x16_bf16 a[192:207], v[120:123], a[64:67], a[192:207]
 ds_read_b64_tr_b16 v[76:77], v213 offset:12416
 ds_read_b64_tr_b16 v[78:79], v213 offset:13952
 ds_read_b64_tr_b16 v[80:81], v212 offset:12544
 s_add_u32 m0, s25, s41
 s_nop 0
 buffer_load_dwordx4 v220, s[16:19], s29 offen offset:0 nt lds
 v_mfma_f32_32x32x16_bf16 a[208:223], v[124:127], a[64:67], a[208:223]
 ds_read_b64_tr_b16 v[82:83], v212 offset:14080
 ds_read_b64_tr_b16 v[84:85], v213 offset:12544
 ds_read_b64_tr_b16 v[86:87], v213 offset:14080
 v_mfma_f32_32x32x16_bf16 a[224:239], v[128:131], a[64:67], a[224:239]
 ds_read_b64_tr_b16 v[88:89], v212 offset:15360
 ds_read_b64_tr_b16 v[90:91], v212 offset:16896
 ds_read_b64_tr_b16 v[92:93], v213 offset:15360
 v_mfma_f32_32x32x16_bf16 a[240:255], v[132:135], a[64:67], a[240:255]
 ds_read_b64_tr_b16 v[94:95], v213 offset:16896
 ds_read_b64_tr_b16 v[96:97], v212 offset:15488
 ds_read_b64_tr_b16 v[98:99], v212 offset:17024
 buffer_load_dwordx4 v221, s[16:19], s29 offen offset:1024 nt lds
 v_mfma_f32_32x32x16_bf16 a[160:175], v[136:139], a[68:71], a[160:175]
 ds_read_b64_tr_b16 v[100:101], v213 offset:15488
 ds_read_b64_tr_b16 v[102:103], v213 offset:17024
 ds_read_b64_tr_b16 v[104:105], v212 offset:15616
 v_mfma_f32_32x32x16_bf16 a[176:191], v[140:143], a[68:71], a[176:191]
 ds_read_b64_tr_b16 v[106:107], v212 offset:17152
 ds_read_b64_tr_b16 v[108:109], v213 offset:15616
 ds_read_b64_tr_b16 v[110:111], v213 offset:17152
 v_mfma_f32_32x32x16_bf16 a[192:207], v[144:147], a[68:71], a[192:207]
 buffer_load_dwordx4 v222, s[16:19], s29 offen offset:2048 nt lds
 s_add_u32 s29, s29, 393216
 v_mfma_f32_32x32x16_bf16 a[208:223], v[148:151], a[68:71], a[208:223]
 v_mfma_f32_32x32x16_bf16 a[224:239], v[152:155], a[68:71], a[224:239]
 v_mfma_f32_32x32x16_bf16 a[240:255], v[156:159], a[68:71], a[240:255]
 s_mov_b32 s25, s24
 s_add_u32 s24, s24, 24576
 s_cmp_eq_u32 s24, 147456
 s_cselect_b32 s24, 0, s24
 v_add_u32 v212, s24, v206
 v_xor_b32 v213, 64, v212
 v_mov_b32 v220, v13
 s_waitcnt vmcnt(24) lgkmcnt(0)
 s_barrier
 v_mfma_f32_32x32x16_bf16 a[160:175], v[64:67], a[72:75], a[160:175]
 ds_read_b64_tr_b16 v[112:113], v212 offset:0
 ds_read_b64_tr_b16 v[114:115], v212 offset:1536
 ds_read_b64_tr_b16 v[116:117], v213 offset:0
 v_mfma_f32_32x32x16_bf16 a[176:191], v[68:71], a[72:75], a[176:191]
 ds_read_b64_tr_b16 v[118:119], v213 offset:1536
 ds_read_b64_tr_b16 v[120:121], v212 offset:128
 ds_read_b64_tr_b16 v[122:123], v212 offset:1664
 v_mfma_f32_32x32x16_bf16 a[192:207], v[72:75], a[72:75], a[192:207]
 ds_read_b64_tr_b16 v[124:125], v213 offset:128
 ds_read_b64_tr_b16 v[126:127], v213 offset:1664
 ds_read_b64_tr_b16 v[128:129], v212 offset:256
 s_add_u32 m0, s25, s40
 s_nop 0
 buffer_load_dwordx4 v214, s[8:11], s27 offen offset:0 nt lds
 v_mfma_f32_32x32x16_bf16 a[208:223], v[76:79], a[72:75], a[208:223]
 ds_read_b64_tr_b16 v[130:131], v212 offset:1792
 ds_read_b64_tr_b16 v[132:133], v213 offset:256
 ds_read_b64_tr_b16 v[134:135], v213 offset:1792
 v_mfma_f32_32x32x16_bf16 a[224:239], v[80:83], a[72:75], a[224:239]
 ds_read_b64_tr_b16 v[136:137], v212 offset:3072
 ds_read_b64_tr_b16 v[138:139], v212 offset:4608
 ds_read_b64_tr_b16 v[140:141], v213 offset:3072
 v_mfma_f32_32x32x16_bf16 a[240:255], v[84:87], a[72:75], a[240:255]
 ds_read_b64_tr_b16 v[142:143], v213 offset:4608
 ds_read_b64_tr_b16 v[144:145], v212 offset:3200
 ds_read_b64_tr_b16 v[146:147], v212 offset:4736
 buffer_load_dwordx4 v215, s[8:11], s27 offen offset:1024 nt lds
 v_mfma_f32_32x32x16_bf16 a[160:175], v[88:91], a[76:79], a[160:175]
 ds_read_b64_tr_b16 v[148:149], v213 offset:3200
 ds_read_b64_tr_b16 v[150:151], v213 offset:4736
 ds_read_b64_tr_b16 v[152:153], v212 offset:3328
 v_mfma_f32_32x32x16_bf16 a[176:191], v[92:95], a[76:79], a[176:191]
 ds_read_b64_tr_b16 v[154:155], v212 offset:4864
 ds_read_b64_tr_b16 v[156:157], v213 offset:3328
 ds_read_b64_tr_b16 v[158:159], v213 offset:4864
 v_mfma_f32_32x32x16_bf16 a[192:207], v[96:99], a[76:79], a[192:207]
 buffer_load_dwordx4 v216, s[8:11], s27 offen offset:2048 nt lds
 s_add_u32 s27, s27, 12288
 v_mfma_f32_32x32x16_bf16 a[208:223], v[100:103], a[76:79], a[208:223]
 v_mfma_f32_32x32x16_bf16 a[224:239], v[104:107], a[76:79], a[224:239]
 v_mfma_f32_32x32x16_bf16 a[240:255], v[108:111], a[76:79], a[240:255]
 s_waitcnt lgkmcnt(0)
 v_mfma_f32_32x32x16_bf16 a[160:175], v[112:115], a[80:83], a[160:175]
 ds_read_b64_tr_b16 v[64:65], v212 offset:12288
 ds_read_b64_tr_b16 v[66:67], v212 offset:13824
 ds_read_b64_tr_b16 v[68:69], v213 offset:12288
 v_mfma_f32_32x32x16_bf16 a[176:191], v[116:119], a[80:83], a[176:191]
 ds_read_b64_tr_b16 v[70:71], v213 offset:13824
 ds_read_b64_tr_b16 v[72:73], v212 offset:12416
 ds_read_b64_tr_b16 v[74:75], v212 offset:13952
 v_mfma_f32_32x32x16_bf16 a[192:207], v[120:123], a[80:83], a[192:207]
 ds_read_b64_tr_b16 v[76:77], v213 offset:12416
 ds_read_b64_tr_b16 v[78:79], v213 offset:13952
 ds_read_b64_tr_b16 v[80:81], v212 offset:12544
 s_add_u32 m0, s25, s41
 s_nop 0
 buffer_load_dwordx4 v214, s[8:11], s27 offen offset:0 nt lds
 v_mfma_f32_32x32x16_bf16 a[208:223], v[124:127], a[80:83], a[208:223]
 ds_read_b64_tr_b16 v[82:83], v212 offset:14080
 ds_read_b64_tr_b16 v[84:85], v213 offset:12544
 ds_read_b64_tr_b16 v[86:87], v213 offset:14080
 v_mfma_f32_32x32x16_bf16 a[224:239], v[128:131], a[80:83], a[224:239]
 ds_read_b64_tr_b16 v[88:89], v212 offset:15360
 ds_read_b64_tr_b16 v[90:91], v212 offset:16896
 ds_read_b64_tr_b16 v[92:93], v213 offset:15360
 v_mfma_f32_32x32x16_bf16 a[240:255], v[132:135], a[80:83], a[240:255]
 ds_read_b64_tr_b16 v[94:95], v213 offset:16896
 ds_read_b64_tr_b16 v[96:97], v212 offset:15488
 ds_read_b64_tr_b16 v[98:99], v212 offset:17024
 buffer_load_dwordx4 v215, s[8:11], s27 offen offset:1024 nt lds
 v_mfma_f32_32x32x16_bf16 a[160:175], v[136:139], a[84:87], a[160:175]
 ds_read_b64_tr_b16 v[100:101], v213 offset:15488
 ds_read_b64_tr_b16 v[102:103], v213 offset:17024
 ds_read_b64_tr_b16 v[104:105], v212 offset:15616
 v_mfma_f32_32x32x16_bf16 a[176:191], v[140:143], a[84:87], a[176:191]
 ds_read_b64_tr_b16 v[106:107], v212 offset:17152
 ds_read_b64_tr_b16 v[108:109], v213 offset:15616
 ds_read_b64_tr_b16 v[110:111], v213 offset:17152
 v_mfma_f32_32x32x16_bf16 a[192:207], v[144:147], a[84:87], a[192:207]
 buffer_load_dwordx4 v216, s[8:11], s27 offen offset:2048 nt lds
 s_add_u32 s27, s27, 12288
 v_mfma_f32_32x32x16_bf16 a[208:223], v[148:151], a[84:87], a[208:223]
 v_mfma_f32_32x32x16_bf16 a[224:239], v[152:155], a[84:87], a[224:239]
 v_mfma_f32_32x32x16_bf16 a[240:255], v[156:159], a[84:87], a[240:255]
 s_mov_b32 s25, s24
 s_add_u32 s24, s24, 24576
 s_cmp_eq_u32 s24, 147456
 s_cselect_b32 s24, 0, s24
 v_add_u32 v212, s24, v206
 v_xor_b32 v213, 64, v212
 s_waitcnt vmcnt(24) lgkmcnt(0)
 s_barrier
 v_mfma_f32_32x32x16_bf16 a[160:175], v[64:67], a[88:91], a[160:175]
 ds_read_b64_tr_b16 v[112:113], v212 offset:0
 ds_read_b64_tr_b16 v[114:115], v212 offset:1536
 ds_read_b64_tr_b16 v[116:117], v213 offset:0
 v_mfma_f32_32x32x16_bf16 a[176:191], v[68:71], a[88:91], a[176:191]
 ds_read_b64_tr_b16 v[118:119], v213 offset:1536
 ds_read_b64_tr_b16 v[120:121], v212 offset:128
 ds_read_b64_tr_b16 v[122:123], v212 offset:1664
 v_mfma_f32_32x32x16_bf16 a[192:207], v[72:75], a[88:91], a[192:207]
 ds_read_b64_tr_b16 v[124:125], v213 offset:128
 ds_read_b64_tr_b16 v[126:127], v213 offset:1664
 ds_read_b64_tr_b16 v[128:129], v212 offset:256
 s_add_u32 m0, s25, s40
 s_nop 0
 buffer_load_dwordx4 v217, s[12:15], s28 offen offset:0 nt lds
 v_mfma_f32_32x32x16_bf16 a[208:223], v[76:79], a[88:91], a[208:223]
 ds_read_b64_tr_b16 v[130:131], v212 offset:1792
 ds_read_b64_tr_b16 v[132:133], v213 offset:256
 ds_read_b64_tr_b16 v[134:135], v213 offset:1792
 v_mfma_f32_32x32x16_bf16 a[224:239], v[80:83], a[88:91], a[224:239]
 ds_read_b64_tr_b16 v[136:137], v212 offset:3072
 ds_read_b64_tr_b16 v[138:139], v212 offset:4608
 ds_read_b64_tr_b16 v[140:141], v213 offset:3072
 v_mfma_f32_32x32x16_bf16 a[240:255], v[84:87], a[88:91], a[240:255]
 ds_read_b64_tr_b16 v[142:143], v213 offset:4608
 ds_read_b64_tr_b16 v[144:145], v212 offset:3200
 ds_read_b64_tr_b16 v[146:147], v212 offset:4736
 buffer_load_dwordx4 v218, s[12:15], s28 offen offset:1024 nt lds
 v_mfma_f32_32x32x16_bf16 a[160:175], v[88:91], a[92:95], a[160:175]
 ds_read_b64_tr_b16 v[148:149], v213 offset:3200
 ds_read_b64_tr_b16 v[150:151], v213 offset:4736
 ds_read_b64_tr_b16 v[152:153], v212 offset:3328
 v_mfma_f32_32x32x16_bf16 a[176:191], v[92:95], a[92:95], a[176:191]
 ds_read_b64_tr_b16 v[154:155], v212 offset:4864
 ds_read_b64_tr_b16 v[156:157], v213 offset:3328
 ds_read_b64_tr_b16 v[158:159], v213 offset:4864
 v_mfma_f32_32x32x16_bf16 a[192:207], v[96:99], a[92:95], a[192:207]
 buffer_load_dwordx4 v219, s[12:15], s28 offen offset:2048 nt lds
 s_add_u32 s28, s28, 12288
 v_mfma_f32_32x32x16_bf16 a[208:223], v[100:103], a[92:95], a[208:223]
 v_mfma_f32_32x32x16_bf16 a[224:239], v[104:107], a[92:95], a[224:239]
 v_mfma_f32_32x32x16_bf16 a[240:255], v[108:111], a[92:95], a[240:255]
 s_waitcnt lgkmcnt(0)
 v_mfma_f32_32x32x16_bf16 a[160:175], v[112:115], a[96:99], a[160:175]
 ds_read_b64_tr_b16 v[64:65], v212 offset:12288
 ds_read_b64_tr_b16 v[66:67], v212 offset:13824
 ds_read_b64_tr_b16 v[68:69], v213 offset:12288
 v_mfma_f32_32x32x16_bf16 a[176:191], v[116:119], a[96:99], a[176:191]
 ds_read_b64_tr_b16 v[70:71], v213 offset:13824
 ds_read_b64_tr_b16 v[72:73], v212 offset:12416
 ds_read_b64_tr_b16 v[74:75], v212 offset:13952
 v_mfma_f32_32x32x16_bf16 a[192:207], v[120:123], a[96:99], a[192:207]
 ds_read_b64_tr_b16 v[76:77], v213 offset:12416
 ds_read_b64_tr_b16 v[78:79], v213 offset:13952
 ds_read_b64_tr_b16 v[80:81], v212 offset:12544
 s_add_u32 m0, s25, s41
 s_nop 0
 buffer_load_dwordx4 v214, s[8:11], s27 offen offset:0 nt lds
 v_mfma_f32_32x32x16_bf16 a[208:223], v[124:127], a[96:99], a[208:223]
 ds_read_b64_tr_b16 v[82:83], v212 offset:14080
 ds_read_b64_tr_b16 v[84:85], v213 offset:12544
 ds_read_b64_tr_b16 v[86:87], v213 offset:14080
 v_mfma_f32_32x32x16_bf16 a[224:239], v[128:131], a[96:99], a[224:239]
 ds_read_b64_tr_b16 v[88:89], v212 offset:15360
 ds_read_b64_tr_b16 v[90:91], v212 offset:16896
 ds_read_b64_tr_b16 v[92:93], v213 offset:15360
 v_mfma_f32_32x32x16_bf16 a[240:255], v[132:135], a[96:99], a[240:255]
 ds_read_b64_tr_b16 v[94:95], v213 offset:16896
 ds_read_b64_tr_b16 v[96:97], v212 offset:15488
 ds_read_b64_tr_b16 v[98:99], v212 offset:17024
 buffer_load_dwordx4 v215, s[8:11], s27 offen offset:1024 nt lds
 v_mfma_f32_32x32x16_bf16 a[160:175], v[136:139], a[100:103], a[160:175]
 ds_read_b64_tr_b16 v[100:101], v213 offset:15488
 ds_read_b64_tr_b16 v[102:103], v213 offset:17024
 ds_read_b64_tr_b16 v[104:105], v212 offset:15616
 v_mfma_f32_32x32x16_bf16 a[176:191], v[140:143], a[100:103], a[176:191]
 ds_read_b64_tr_b16 v[106:107], v212 offset:17152
 ds_read_b64_tr_b16 v[108:109], v213 offset:15616
 ds_read_b64_tr_b16 v[110:111], v213 offset:17152
 v_mfma_f32_32x32x16_bf16 a[192:207], v[144:147], a[100:103], a[192:207]
 buffer_load_dwordx4 v216, s[8:11], s27 offen offset:2048 nt lds
 s_add_u32 s27, s27, 12288
 v_mfma_f32_32x32x16_bf16 a[208:223], v[148:151], a[100:103], a[208:223]
 v_mfma_f32_32x32x16_bf16 a[224:239], v[152:155], a[100:103], a[224:239]
 v_mfma_f32_32x32x16_bf16 a[240:255], v[156:159], a[100:103], a[240:255]
 s_mov_b32 s25, s24
 s_add_u32 s24, s24, 24576
 s_cmp_eq_u32 s24, 147456
 s_cselect_b32 s24, 0, s24
 v_add_u32 v212, s24, v206
 v_xor_b32 v213, 64, v212
 s_waitcnt vmcnt(24) lgkmcnt(0)
 s_barrier
 v_mfma_f32_32x32x16_bf16 a[160:175], v[64:67], a[104:107], a[160:175]
 ds_read_b64_tr_b16 v[112:113], v212 offset:0
 ds_read_b64_tr_b16 v[114:115], v212 offset:1536
 ds_read_b64_tr_b16 v[116:117], v213 offset:0
 v_mfma_f32_32x32x16_bf16 a[176:191], v[68:71], a[104:107], a[176:191]
 ds_read_b64_tr_b16 v[118:119], v213 offset:1536
 ds_read_b64_tr_b16 v[120:121], v212 offset:128
 ds_read_b64_tr_b16 v[122:123], v212 offset:1664
 v_mfma_f32_32x32x16_bf16 a[192:207], v[72:75], a[104:107], a[192:207]
 ds_read_b64_tr_b16 v[124:125], v213 offset:128
 ds_read_b64_tr_b16 v[126:127], v213 offset:1664
 ds_read_b64_tr_b16 v[128:129], v212 offset:256
 s_add_u32 m0, s25, s40
 s_nop 0
 buffer_load_dwordx4 v217, s[12:15], s28 offen offset:0 nt lds
 v_mfma_f32_32x32x16_bf16 a[208:223], v[76:79], a[104:107], a[208:223]
 ds_read_b64_tr_b16 v[130:131], v212 offset:1792
 ds_read_b64_tr_b16 v[132:133], v213 offset:256
 ds_read_b64_tr_b16 v[134:135], v213 offset:1792
 v_mfma_f32_32x32x16_bf16 a[224:239], v[80:83], a[104:107], a[224:239]
 ds_read_b64_tr_b16 v[136:137], v212 offset:3072
 ds_read_b64_tr_b16 v[138:139], v212 offset:4608
 ds_read_b64_tr_b16 v[140:141], v213 offset:3072
 v_mfma_f32_32x32x16_bf16 a[240:255], v[84:87], a[104:107], a[240:255]
 ds_read_b64_tr_b16 v[142:143], v213 offset:4608
 ds_read_b64_tr_b16 v[144:145], v212 offset:3200
 ds_read_b64_tr_b16 v[146:147], v212 offset:4736
 buffer_load_dwordx4 v218, s[12:15], s28 offen offset:1024 nt lds
 v_mfma_f32_32x32x16_bf16 a[160:175], v[88:91], a[108:111], a[160:175]
 ds_read_b64_tr_b16 v[148:149], v213 offset:3200
 ds_read_b64_tr_b16 v[150:151], v213 offset:4736
 ds_read_b64_tr_b16 v[152:153], v212 offset:3328
 v_mfma_f32_32x32x16_bf16 a[176:191], v[92:95], a[108:111], a[176:191]
 ds_read_b64_tr_b16 v[154:155], v212 offset:4864
 ds_read_b64_tr_b16 v[156:157], v213 offset:3328
 ds_read_b64_tr_b16 v[158:159], v213 offset:4864
 v_mfma_f32_32x32x16_bf16 a[192:207], v[96:99], a[108:111], a[192:207]
 buffer_load_dwordx4 v219, s[12:15], s28 offen offset:2048 nt lds
 s_add_u32 s28, s28, 12288
 v_mfma_f32_32x32x16_bf16 a[208:223], v[100:103], a[108:111], a[208:223]
 v_mfma_f32_32x32x16_bf16 a[224:239], v[104:107], a[108:111], a[224:239]
 v_mfma_f32_32x32x16_bf16 a[240:255], v[108:111], a[108:111], a[240:255]
 s_waitcnt lgkmcnt(0)
 v_mfma_f32_32x32x16_bf16 a[160:175], v[112:115], a[112:115], a[160:175]
 ds_read_b64_tr_b16 v[64:65], v212 offset:12288
 ds_read_b64_tr_b16 v[66:67], v212 offset:13824
 ds_read_b64_tr_b16 v[68:69], v213 offset:12288
 v_mfma_f32_32x32x16_bf16 a[176:191], v[116:119], a[112:115], a[176:191]
 ds_read_b64_tr_b16 v[70:71], v213 offset:13824
 ds_read_b64_tr_b16 v[72:73], v212 offset:12416
 ds_read_b64_tr_b16 v[74:75], v212 offset:13952
 v_mfma_f32_32x32x16_bf16 a[192:207], v[120:123], a[112:115], a[192:207]
 ds_read_b64_tr_b16 v[76:77], v213 offset:12416
 ds_read_b64_tr_b16 v[78:79], v213 offset:13952
 ds_read_b64_tr_b16 v[80:81], v212 offset:12544
 s_add_u32 m0, s25, s41
 s_nop 0
 buffer_load_dwordx4 v214, s[8:11], s27 offen offset:0 nt lds
 v_mfma_f32_32x32x16_bf16 a[208:223], v[124:127], a[112:115], a[208:223]
 ds_read_b64_tr_b16 v[82:83], v212 offset:14080
 ds_read_b64_tr_b16 v[84:85], v213 offset:12544
 ds_read_b64_tr_b16 v[86:87], v213 offset:14080
 v_mfma_f32_32x32x16_bf16 a[224:239], v[128:131], a[112:115], a[224:239]
 ds_read_b64_tr_b16 v[88:89], v212 offset:15360
 ds_read_b64_tr_b16 v[90:91], v212 offset:16896
 ds_read_b64_tr_b16 v[92:93], v213 offset:15360
 v_mfma_f32_32x32x16_bf16 a[240:255], v[132:135], a[112:115], a[240:255]
 ds_read_b64_tr_b16 v[94:95], v213 offset:16896
 ds_read_b64_tr_b16 v[96:97], v212 offset:15488
 ds_read_b64_tr_b16 v[98:99], v212 offset:17024
 buffer_load_dwordx4 v215, s[8:11], s27 offen offset:1024 nt lds
 v_mfma_f32_32x32x16_bf16 a[160:175], v[136:139], a[116:119], a[160:175]
 ds_read_b64_tr_b16 v[100:101], v213 offset:15488
 ds_read_b64_tr_b16 v[102:103], v213 offset:17024
 ds_read_b64_tr_b16 v[104:105], v212 offset:15616
 v_mfma_f32_32x32x16_bf16 a[176:191], v[140:143], a[116:119], a[176:191]
 ds_read_b64_tr_b16 v[106:107], v212 offset:17152
 ds_read_b64_tr_b16 v[108:109], v213 offset:15616
 ds_read_b64_tr_b16 v[110:111], v213 offset:17152
 v_mfma_f32_32x32x16_bf16 a[192:207], v[144:147], a[116:119], a[192:207]
 buffer_load_dwordx4 v216, s[8:11], s27 offen offset:2048 nt lds
 s_add_u32 s27, s27, 12288
 v_mfma_f32_32x32x16_bf16 a[208:223], v[148:151], a[116:119], a[208:223]
 v_mfma_f32_32x32x16_bf16 a[224:239], v[152:155], a[116:119], a[224:239]
 v_mfma_f32_32x32x16_bf16 a[240:255], v[156:159], a[116:119], a[240:255]
 s_mov_b32 s25, s24
 s_add_u32 s24, s24, 24576
 s_cmp_eq_u32 s24, 147456
 s_cselect_b32 s24, 0, s24
 v_add_u32 v212, s24, v206
 v_xor_b32 v213, 64, v212
 s_mov_b32 s29, 384
 s_waitcnt vmcnt(24) lgkmcnt(0)
 s_barrier
 v_mfma_f32_32x32x16_bf16 a[160:175], v[64:67], a[120:123], a[160:175]
 ds_read_b64_tr_b16 v[112:113], v212 offset:0
 ds_read_b64_tr_b16 v[114:115], v212 offset:1536
 ds_read_b64_tr_b16 v[116:117], v213 offset:0
 v_mfma_f32_32x32x16_bf16 a[176:191], v[68:71], a[120:123], a[176:191]
 ds_read_b64_tr_b16 v[118:119], v213 offset:1536
 ds_read_b64_tr_b16 v[120:121], v212 offset:128
 ds_read_b64_tr_b16 v[122:123], v212 offset:1664
 v_mfma_f32_32x32x16_bf16 a[192:207], v[72:75], a[120:123], a[192:207]
 ds_read_b64_tr_b16 v[124:125], v213 offset:128
 ds_read_b64_tr_b16 v[126:127], v213 offset:1664
 ds_read_b64_tr_b16 v[128:129], v212 offset:256
 s_add_u32 m0, s25, s42
 s_add_u32 s29, s29, 0
 buffer_load_dwordx4 v220, s[16:19], s29 offen offset:0 lds
 v_mfma_f32_32x32x16_bf16 a[208:223], v[76:79], a[120:123], a[208:223]
 ds_read_b64_tr_b16 v[130:131], v212 offset:1792
 ds_read_b64_tr_b16 v[132:133], v213 offset:256
 ds_read_b64_tr_b16 v[134:135], v213 offset:1792
 v_mfma_f32_32x32x16_bf16 a[224:239], v[80:83], a[120:123], a[224:239]
 ds_read_b64_tr_b16 v[136:137], v212 offset:3072
 ds_read_b64_tr_b16 v[138:139], v212 offset:4608
 ds_read_b64_tr_b16 v[140:141], v213 offset:3072
 v_mfma_f32_32x32x16_bf16 a[240:255], v[84:87], a[120:123], a[240:255]
 ds_read_b64_tr_b16 v[142:143], v213 offset:4608
 ds_read_b64_tr_b16 v[144:145], v212 offset:3200
 ds_read_b64_tr_b16 v[146:147], v212 offset:4736
 s_add_u32 s29, s29, 97280
 buffer_load_dwordx4 v220, s[16:19], s29 offen offset:1024 lds
 v_mfma_f32_32x32x16_bf16 a[160:175], v[88:91], a[124:127], a[160:175]
 ds_read_b64_tr_b16 v[148:149], v213 offset:3200
 ds_read_b64_tr_b16 v[150:151], v213 offset:4736
 ds_read_b64_tr_b16 v[152:153], v212 offset:3328
 v_mfma_f32_32x32x16_bf16 a[176:191], v[92:95], a[124:127], a[176:191]
 ds_read_b64_tr_b16 v[154:155], v212 offset:4864
 ds_read_b64_tr_b16 v[156:157], v213 offset:3328
 ds_read_b64_tr_b16 v[158:159], v213 offset:4864
 v_mfma_f32_32x32x16_bf16 a[192:207], v[96:99], a[124:127], a[192:207]
 s_add_u32 s29, s29, 97280
 buffer_load_dwordx4 v220, s[16:19], s29 offen offset:2048 lds
 v_mfma_f32_32x32x16_bf16 a[208:223], v[100:103], a[124:127], a[208:223]
 v_mfma_f32_32x32x16_bf16 a[224:239], v[104:107], a[124:127], a[224:239]
 v_mfma_f32_32x32x16_bf16 a[240:255], v[108:111], a[124:127], a[240:255]
 s_waitcnt lgkmcnt(0)
 v_mfma_f32_32x32x16_bf16 a[160:175], v[112:115], a[128:131], a[160:175]
 ds_read_b64_tr_b16 v[64:65], v212 offset:12288
 ds_read_b64_tr_b16 v[66:67], v212 offset:13824
 ds_read_b64_tr_b16 v[68:69], v213 offset:12288
 v_mfma_f32_32x32x16_bf16 a[176:191], v[116:119], a[128:131], a[176:191]
 ds_read_b64_tr_b16 v[70:71], v213 offset:13824
 ds_read_b64_tr_b16 v[72:73], v212 offset:12416
 ds_read_b64_tr_b16 v[74:75], v212 offset:13952
 v_mfma_f32_32x32x16_bf16 a[192:207], v[120:123], a[128:131], a[192:207]
 ds_read_b64_tr_b16 v[76:77], v213 offset:12416
 ds_read_b64_tr_b16 v[78:79], v213 offset:13952
 ds_read_b64_tr_b16 v[80:81], v212 offset:12544
 s_add_u32 s29, s29, 97280
 buffer_load_dwordx4 v220, s[16:19], s29 offen offset:3072 lds
 v_mfma_f32_32x32x16_bf16 a[208:223], v[124:127], a[128:131], a[208:223]
 ds_read_b64_tr_b16 v[82:83], v212 offset:14080
 ds_read_b64_tr_b16 v[84:85], v213 offset:12544
 ds_read_b64_tr_b16 v[86:87], v213 offset:14080
 v_mfma_f32_32x32x16_bf16 a[224:239], v[128:131], a[128:131], a[224:239]
 ds_read_b64_tr_b16 v[88:89], v212 offset:15360
 ds_read_b64_tr_b16 v[90:91], v212 offset:16896
 ds_read_b64_tr_b16 v[92:93], v213 offset:15360
 v_mfma_f32_32x32x16_bf16 a[240:255], v[132:135], a[128:131], a[240:255]
 ds_read_b64_tr_b16 v[94:95], v213 offset:16896
 ds_read_b64_tr_b16 v[96:97], v212 offset:15488
 ds_read_b64_tr_b16 v[98:99], v212 offset:17024
 v_mfma_f32_32x32x16_bf16 a[160:175], v[136:139], a[132:135], a[160:175]
 ds_read_b64_tr_b16 v[100:101], v213 offset:15488
 ds_read_b64_tr_b16 v[102:103], v213 offset:17024
 ds_read_b64_tr_b16 v[104:105], v212 offset:15616
 s_add_u32 m0, m0, 4096
 s_add_u32 s29, s29, 101376
 buffer_load_dwordx4 v220, s[16:19], s29 offen offset:0 lds
 v_mfma_f32_32x32x16_bf16 a[176:191], v[140:143], a[132:135], a[176:191]
 ds_read_b64_tr_b16 v[106:107], v212 offset:17152
 ds_read_b64_tr_b16 v[108:109], v213 offset:15616
 ds_read_b64_tr_b16 v[110:111], v213 offset:17152
 v_mfma_f32_32x32x16_bf16 a[192:207], v[144:147], a[132:135], a[192:207]
 v_mfma_f32_32x32x16_bf16 a[208:223], v[148:151], a[132:135], a[208:223]
 v_mfma_f32_32x32x16_bf16 a[224:239], v[152:155], a[132:135], a[224:239]
 v_mfma_f32_32x32x16_bf16 a[240:255], v[156:159], a[132:135], a[240:255]
 s_mov_b32 s25, s24
 s_add_u32 s24, s24, 24576
 s_cmp_eq_u32 s24, 147456
 s_cselect_b32 s24, 0, s24
 v_add_u32 v212, s24, v206
 v_xor_b32 v213, 64, v212
 s_waitcnt vmcnt(23) lgkmcnt(0)
 s_barrier
 v_mfma_f32_32x32x16_bf16 a[160:175], v[64:67], a[136:139], a[160:175]
 ds_read_b64_tr_b16 v[112:113], v212 offset:0
 ds_read_b64_tr_b16 v[114:115], v212 offset:1536
 ds_read_b64_tr_b16 v[116:117], v213 offset:0
 v_mfma_f32_32x32x16_bf16 a[176:191], v[68:71], a[136:139], a[176:191]
 ds_read_b64_tr_b16 v[118:119], v213 offset:1536
 ds_read_b64_tr_b16 v[120:121], v212 offset:128
 ds_read_b64_tr_b16 v[122:123], v212 offset:1664
 v_mfma_f32_32x32x16_bf16 a[192:207], v[72:75], a[136:139], a[192:207]
 ds_read_b64_tr_b16 v[124:125], v213 offset:128
 ds_read_b64_tr_b16 v[126:127], v213 offset:1664
 ds_read_b64_tr_b16 v[128:129], v212 offset:256
 s_add_u32 m0, s25, s40
 s_nop 0
 buffer_load_dwordx4 v217, s[12:15], s28 offen offset:0 nt lds
 v_mfma_f32_32x32x16_bf16 a[208:223], v[76:79], a[136:139], a[208:223]
 ds_read_b64_tr_b16 v[130:131], v212 offset:1792
 ds_read_b64_tr_b16 v[132:133], v213 offset:256
 ds_read_b64_tr_b16 v[134:135], v213 offset:1792
 v_mfma_f32_32x32x16_bf16 a[224:239], v[80:83], a[136:139], a[224:239]
 ds_read_b64_tr_b16 v[136:137], v212 offset:3072
 ds_read_b64_tr_b16 v[138:139], v212 offset:4608
 ds_read_b64_tr_b16 v[140:141], v213 offset:3072
 v_mfma_f32_32x32x16_bf16 a[240:255], v[84:87], a[136:139], a[240:255]
 ds_read_b64_tr_b16 v[142:143], v213 offset:4608
 ds_read_b64_tr_b16 v[144:145], v212 offset:3200
 ds_read_b64_tr_b16 v[146:147], v212 offset:4736
 buffer_load_dwordx4 v218, s[12:15], s28 offen offset:1024 nt lds
 v_mfma_f32_32x32x16_bf16 a[160:175], v[88:91], a[140:143], a[160:175]
 ds_read_b64_tr_b16 v[148:149], v213 offset:3200
 ds_read_b64_tr_b16 v[150:151], v213 offset:4736
 ds_read_b64_tr_b16 v[152:153], v212 offset:3328
 v_mfma_f32_32x32x16_bf16 a[176:191], v[92:95], a[140:143], a[176:191]
 ds_read_b64_tr_b16 v[154:155], v212 offset:4864
 ds_read_b64_tr_b16 v[156:157], v213 offset:3328
 ds_read_b64_tr_b16 v[158:159], v213 offset:4864
 v_mfma_f32_32x32x16_bf16 a[192:207], v[96:99], a[140:143], a[192:207]
 buffer_load_dwordx4 v219, s[12:15], s28 offen offset:2048 nt lds
 s_add_u32 s28, s28, 12288
 v_mfma_f32_32x32x16_bf16 a[208:223], v[100:103], a[140:143], a[208:223]
 v_mfma_f32_32x32x16_bf16 a[224:239], v[104:107], a[140:143], a[224:239]
 v_mfma_f32_32x32x16_bf16 a[240:255], v[108:111], a[140:143], a[240:255]
 s_waitcnt lgkmcnt(0)
 v_mfma_f32_32x32x16_bf16 a[160:175], v[112:115], a[144:147], a[160:175]
 ds_read_b64_tr_b16 v[64:65], v212 offset:12288
 ds_read_b64_tr_b16 v[66:67], v212 offset:13824
 ds_read_b64_tr_b16 v[68:69], v213 offset:12288
 v_mfma_f32_32x32x16_bf16 a[176:191], v[116:119], a[144:147], a[176:191]
 ds_read_b64_tr_b16 v[70:71], v213 offset:13824
 ds_read_b64_tr_b16 v[72:73], v212 offset:12416
 ds_read_b64_tr_b16 v[74:75], v212 offset:13952
 v_mfma_f32_32x32x16_bf16 a[192:207], v[120:123], a[144:147], a[192:207]
 ds_read_b64_tr_b16 v[76:77], v213 offset:12416
 ds_read_b64_tr_b16 v[78:79], v213 offset:13952
 ds_read_b64_tr_b16 v[80:81], v212 offset:12544
 s_add_u32 m0, s25, s41
 s_nop 0
 buffer_load_dwordx4 v214, s[8:11], s27 offen offset:0 nt lds
 v_mfma_f32_32x32x16_bf16 a[208:223], v[124:127], a[144:147], a[208:223]
 ds_read_b64_tr_b16 v[82:83], v212 offset:14080
 ds_read_b64_tr_b16 v[84:85], v213 offset:12544
 ds_read_b64_tr_b16 v[86:87], v213 offset:14080
 v_mfma_f32_32x32x16_bf16 a[224:239], v[128:131], a[144:147], a[224:239]
 ds_read_b64_tr_b16 v[88:89], v212 offset:15360
 ds_read_b64_tr_b16 v[90:91], v212 offset:16896
 ds_read_b64_tr_b16 v[92:93], v213 offset:15360
 v_mfma_f32_32x32x16_bf16 a[240:255], v[132:135], a[144:147], a[240:255]
 ds_read_b64_tr_b16 v[94:95], v213 offset:16896
 ds_read_b64_tr_b16 v[96:97], v212 offset:15488
 ds_read_b64_tr_b16 v[98:99], v212 offset:17024
 buffer_load_dwordx4 v215, s[8:11], s27 offen offset:1024 nt lds
 v_mfma_f32_32x32x16_bf16 a[160:175], v[136:139], a[148:151], a[160:175]
 ds_read_b64_tr_b16 v[100:101], v213 offset:15488
 ds_read_b64_tr_b16 v[102:103], v213 offset:17024
 ds_read_b64_tr_b16 v[104:105], v212 offset:15616
 v_mfma_f32_32x32x16_bf16 a[176:191], v[140:143], a[148:151], a[176:191]
 ds_read_b64_tr_b16 v[106:107], v212 offset:17152
 ds_read_b64_tr_b16 v[108:109], v213 offset:15616
 ds_read_b64_tr_b16 v[110:111], v213 offset:17152
 v_mfma_f32_32x32x16_bf16 a[192:207], v[144:147], a[148:151], a[192:207]
 buffer_load_dwordx4 v216, s[8:11], s27 offen offset:2048 nt lds
 s_add_u32 s27, s27, 12288
 v_mfma_f32_32x32x16_bf16 a[208:223], v[148:151], a[148:151], a[208:223]
 v_mfma_f32_32x32x16_bf16 a[224:239], v[152:155], a[148:151], a[224:239]
 v_mfma_f32_32x32x16_bf16 a[240:255], v[156:159], a[148:151], a[240:255]
 s_mov_b32 s25, s24
 s_add_u32 s24, s24, 24576
 s_cmp_eq_u32 s24, 147456
 s_cselect_b32 s24, 0, s24
 v_add_u32 v208, s24, v200
 v_xor_b32 v209, 32, v208
 v_xor_b32 v210, 64, v208
 v_xor_b32 v211, 96, v208
 s_waitcnt vmcnt(23) lgkmcnt(0)
 s_barrier
 v_mfma_f32_32x32x16_bf16 a[160:175], v[64:67], a[152:155], a[160:175]
 ds_read_b128 v[112:115], v208 offset:0
 ds_read_b128 v[116:119], v209 offset:0
 ds_read_b128 v[120:123], v210 offset:0
 s_add_u32 m0, s25, s40
 s_nop 0
 buffer_load_dwordx4 v217, s[12:15], s28 offen offset:0 nt lds
 buffer_load_dwordx4 v218, s[12:15], s28 offen offset:1024 nt lds
 v_mfma_f32_32x32x16_bf16 a[160:175], v[88:91], a[156:159], a[160:175]
 ds_read_b128 v[124:127], v211 offset:0
 ds_read_b128 v[128:131], v208 offset:128
 ds_read_b128 v[132:135], v209 offset:128
 buffer_load_dwordx4 v219, s[12:15], s28 offen offset:2048 nt lds
 s_add_u32 s28, s28, 12288
 v_mfma_f32_32x32x16_bf16 a[176:191], v[68:71], a[152:155], a[176:191]
 ds_read_b128 v[136:139], v210 offset:128
 ds_read_b128 v[140:143], v211 offset:128
 ds_read_b128 v[144:147], v208 offset:256
 s_add_u32 m0, s25, s41
 s_nop 0
 buffer_load_dwordx4 v214, s[8:11], s27 offen offset:0 nt lds
 buffer_load_dwordx4 v215, s[8:11], s27 offen offset:1024 nt lds
 v_mfma_f32_32x32x16_bf16 a[176:191], v[92:95], a[156:159], a[176:191]
 ds_read_b128 v[148:151], v209 offset:256
 ds_read_b128 v[152:155], v210 offset:256
 ds_read_b128 v[156:159], v211 offset:256
 buffer_load_dwordx4 v216, s[8:11], s27 offen offset:2048 nt lds
 s_add_u32 s27, s27, 12288
 v_mfma_f32_32x32x16_bf16 a[192:207], v[72:75], a[152:155], a[192:207]
 v_accvgpr_read_b32 v176, a160
 v_accvgpr_read_b32 v177, a161
 v_accvgpr_read_b32 v178, a162
 v_accvgpr_read_b32 v179, a163
 v_accvgpr_read_b32 v180, a164
 v_accvgpr_read_b32 v181, a165
 v_accvgpr_read_b32 v182, a166
 v_accvgpr_read_b32 v183, a167
 v_cvt_pk_bf16_f32 v16, v176, v177
 v_mfma_f32_32x32x16_bf16 a[192:207], v[96:99], a[156:159], a[192:207]
 v_cvt_pk_bf16_f32 v17, v178, v179
 v_cvt_pk_bf16_f32 v18, v180, v181
 v_cvt_pk_bf16_f32 v19, v182, v183
 v_accvgpr_read_b32 v176, a168
 v_accvgpr_read_b32 v177, a169
 v_accvgpr_read_b32 v178, a170
 v_accvgpr_read_b32 v179, a171
 v_accvgpr_read_b32 v180, a172
 v_accvgpr_read_b32 v181, a173
 v_mfma_f32_32x32x16_bf16 a[208:223], v[76:79], a[152:155], a[208:223]
 v_accvgpr_read_b32 v182, a174
 v_accvgpr_read_b32 v183, a175
 v_cvt_pk_bf16_f32 v20, v176, v177
 v_cvt_pk_bf16_f32 v21, v178, v179
 v_cvt_pk_bf16_f32 v22, v180, v181
 v_cvt_pk_bf16_f32 v23, v182, v183
 v_accvgpr_read_b32 v176, a176
 v_accvgpr_read_b32 v177, a177
 v_accvgpr_read_b32 v178, a178
 v_mfma_f32_32x32x16_bf16 a[208:223], v[100:103], a[156:159], a[208:223]
 v_accvgpr_read_b32 v179, a179
 v_accvgpr_read_b32 v180, a180
 v_accvgpr_read_b32 v181, a181
 v_accvgpr_read_b32 v182, a182
 v_accvgpr_read_b32 v183, a183
 v_cvt_pk_bf16_f32 v24, v176, v177
 v_cvt_pk_bf16_f32 v25, v178, v179
 v_cvt_pk_bf16_f32 v26, v180, v181
 v_cvt_pk_bf16_f32 v27, v182, v183
 v_mfma_f32_32x32x16_bf16 a[224:239], v[80:83], a[152:155], a[224:239]
 v_accvgpr_read_b32 v176, a184
 v_accvgpr_read_b32 v177, a185
 v_accvgpr_read_b32 v178, a186
 v_accvgpr_read_b32 v179, a187
 v_accvgpr_read_b32 v180, a188
 v_accvgpr_read_b32 v181, a189
 v_accvgpr_read_b32 v182, a190
 v_accvgpr_read_b32 v183, a191
 v_cvt_pk_bf16_f32 v28, v176, v177
 v_mfma_f32_32x32x16_bf16 a[224:239], v[104:107], a[156:159], a[224:239]
 v_cvt_pk_bf16_f32 v29, v178, v179
 v_cvt_pk_bf16_f32 v30, v180, v181
 v_cvt_pk_bf16_f32 v31, v182, v183
 v_accvgpr_read_b32 v176, a192
 v_accvgpr_read_b32 v177, a193
 v_accvgpr_read_b32 v178, a194
 v_accvgpr_read_b32 v179, a195
 v_accvgpr_read_b32 v180, a196
 v_accvgpr_read_b32 v181, a197
 v_mfma_f32_32x32x16_bf16 a[240:255], v[84:87], a[152:155], a[240:255]
 v_accvgpr_read_b32 v182, a198
 v_accvgpr_read_b32 v183, a199
 v_cvt_pk_bf16_f32 v32, v176, v177
 v_cvt_pk_bf16_f32 v33, v178, v179
 v_cvt_pk_bf16_f32 v34, v180, v181
 v_cvt_pk_bf16_f32 v35, v182, v183
 v_accvgpr_read_b32 v176, a200
 v_accvgpr_read_b32 v177, a201
 v_accvgpr_read_b32 v178, a202
 v_mfma_f32_32x32x16_bf16 a[240:255], v[108:111], a[156:159], a[240:255]
 v_accvgpr_read_b32 v179, a203
 v_accvgpr_read_b32 v180, a204
 v_accvgpr_read_b32 v181, a205
 v_accvgpr_read_b32 v182, a206
 v_accvgpr_read_b32 v183, a207
 v_cvt_pk_bf16_f32 v36, v176, v177
 v_cvt_pk_bf16_f32 v37, v178, v179
 v_cvt_pk_bf16_f32 v38, v180, v181
 v_cvt_pk_bf16_f32 v39, v182, v183
 ds_read_b128 v[64:67], v208 offset:12288
 ds_read_b128 v[68:71], v209 offset:12288
 ds_read_b128 v[72:75], v210 offset:12288
 ds_read_b128 v[76:79], v211 offset:12288
 ds_read_b128 v[80:83], v208 offset:12416
 ds_read_b128 v[84:87], v209 offset:12416
 ds_read_b128 v[88:91], v210 offset:12416
 ds_read_b128 v[92:95], v211 offset:12416
 ds_read_b128 v[96:99], v208 offset:12544
 ds_read_b128 v[100:103], v209 offset:12544
 ds_read_b128 v[104:107], v210 offset:12544
 ds_read_b128 v[108:111], v211 offset:12544
 s_waitcnt lgkmcnt(12)
 v_mfma_f32_32x32x16_bf16 v[160:175], v[112:115], v[16:19], 0
 v_accvgpr_read_b32 v176, a208
 v_accvgpr_read_b32 v177, a209
 v_accvgpr_read_b32 v178, a210
 v_accvgpr_read_b32 v179, a211
 v_accvgpr_read_b32 v180, a212
 v_accvgpr_read_b32 v181, a213
 v_accvgpr_read_b32 v182, a214
 v_accvgpr_read_b32 v183, a215
 v_cvt_pk_bf16_f32 v40, v176, v177
 v_cvt_pk_bf16_f32 v41, v178, v179
 v_cvt_pk_bf16_f32 v42, v180, v181
 v_cvt_pk_bf16_f32 v43, v182, v183
 v_mfma_f32_32x32x16_bf16 v[160:175], v[116:119], v[20:23], v[160:175]
 v_accvgpr_read_b32 v176, a216
 v_accvgpr_read_b32 v177, a217
 v_accvgpr_read_b32 v178, a218
 v_accvgpr_read_b32 v179, a219
 v_accvgpr_read_b32 v180, a220
 v_accvgpr_read_b32 v181, a221
 v_accvgpr_read_b32 v182, a222
 v_accvgpr_read_b32 v183, a223
 v_cvt_pk_bf16_f32 v44, v176, v177
 v_cvt_pk_bf16_f32 v45, v178, v179
 v_cvt_pk_bf16_f32 v46, v180, v181
 v_cvt_pk_bf16_f32 v47, v182, v183
 v_mfma_f32_32x32x16_bf16 v[160:175], v[120:123], v[24:27], v[160:175]
 v_accvgpr_read_b32 v176, a224
 v_accvgpr_read_b32 v177, a225
 v_accvgpr_read_b32 v178, a226
 v_accvgpr_read_b32 v179, a227
 v_accvgpr_read_b32 v180, a228
 v_accvgpr_read_b32 v181, a229
 v_accvgpr_read_b32 v182, a230
 v_accvgpr_read_b32 v183, a231
 v_cvt_pk_bf16_f32 v48, v176, v177
 v_cvt_pk_bf16_f32 v49, v178, v179
 v_cvt_pk_bf16_f32 v50, v180, v181
 v_cvt_pk_bf16_f32 v51, v182, v183
 v_mfma_f32_32x32x16_bf16 v[160:175], v[124:127], v[28:31], v[160:175]
 v_accvgpr_read_b32 v176, a232
 v_accvgpr_read_b32 v177, a233
 v_accvgpr_read_b32 v178, a234
 v_accvgpr_read_b32 v179, a235
 v_accvgpr_read_b32 v180, a236
 v_accvgpr_read_b32 v181, a237
 v_accvgpr_read_b32 v182, a238
 v_accvgpr_read_b32 v183, a239
 v_cvt_pk_bf16_f32 v52, v176, v177
 v_cvt_pk_bf16_f32 v53, v178, v179
 v_cvt_pk_bf16_f32 v54, v180, v181
 v_cvt_pk_bf16_f32 v55, v182, v183
 v_mfma_f32_32x32x16_bf16 v[160:175], v[128:131], v[32:35], v[160:175]
 v_accvgpr_read_b32 v176, a240
 v_accvgpr_read_b32 v177, a241
 v_accvgpr_read_b32 v178, a242
 v_accvgpr_read_b32 v179, a243
 v_accvgpr_read_b32 v180, a244
 v_accvgpr_read_b32 v181, a245
 v_accvgpr_read_b32 v182, a246
 v_accvgpr_read_b32 v183, a247
 v_cvt_pk_bf16_f32 v56, v176, v177
 v_cvt_pk_bf16_f32 v57, v178, v179
 v_cvt_pk_bf16_f32 v58, v180, v181
 v_cvt_pk_bf16_f32 v59, v182, v183
 v_mfma_f32_32x32x16_bf16 v[160:175], v[132:135], v[36:39], v[160:175]
 v_accvgpr_read_b32 v176, a248
 v_accvgpr_read_b32 v177, a249
 v_accvgpr_read_b32 v178, a250
 v_accvgpr_read_b32 v179, a251
 v_accvgpr_read_b32 v180, a252
 v_accvgpr_read_b32 v181, a253
 v_accvgpr_read_b32 v182, a254
 v_accvgpr_read_b32 v183, a255
 v_cvt_pk_bf16_f32 v60, v176, v177
 v_cvt_pk_bf16_f32 v61, v178, v179
 v_cvt_pk_bf16_f32 v62, v180, v181
 v_cvt_pk_bf16_f32 v63, v182, v183
 v_mfma_f32_32x32x16_bf16 v[160:175], v[136:139], v[40:43], v[160:175]
 v_mov_b32 v226, 0
 v_mov_b32 v227, 0
 v_mfma_f32_32x32x16_bf16 v[160:175], v[140:143], v[44:47], v[160:175]
 v_mov_b32 v206, v14
 v_mfma_f32_32x32x16_bf16 v[160:175], v[144:147], v[48:51], v[160:175]
 s_mov_b32 s25, s24
 s_add_u32 s24, s24, 24576
 v_mfma_f32_32x32x16_bf16 v[160:175], v[148:151], v[52:55], v[160:175]
 s_cmp_eq_u32 s24, 147456
 v_mfma_f32_32x32x16_bf16 v[160:175], v[152:155], v[56:59], v[160:175]
 s_cselect_b32 s24, 0, s24
 v_add_u32 v212, s24, v204
 v_mfma_f32_32x32x16_bf16 v[160:175], v[156:159], v[60:63], v[160:175]
 v_xor_b32 v213, 64, v212
 s_nop 7
 s_nop 7
 v_max3_f32 v228, v160, v161, v162
 v_max3_f32 v228, v228, v163, v164
 v_max3_f32 v228, v228, v165, v166
 v_max3_f32 v228, v228, v167, v168
 v_max3_f32 v228, v228, v169, v170
 v_max3_f32 v228, v228, v171, v172
 v_max3_f32 v228, v228, v173, v174
 v_max_f32 v228, v228, v175
 v_mov_b32 v229, v228
 s_nop 1
 v_permlane32_swap_b32 v229, v228
 s_nop 1
 v_max_f32 v223, v229, v228
 v_mul_f32 v224, s32, v223
 v_add_f32 v225, s36, v223
 v_fma_f32 v176, v160, s32, -v224
 v_fma_f32 v177, v161, s32, -v224
 v_fma_f32 v178, v162, s32, -v224
 v_fma_f32 v179, v163, s32, -v224
 v_fma_f32 v180, v164, s32, -v224
 v_fma_f32 v181, v165, s32, -v224
 v_fma_f32 v182, v166, s32, -v224
 v_fma_f32 v183, v167, s32, -v224
 v_fma_f32 v184, v168, s32, -v224
 v_fma_f32 v185, v169, s32, -v224
 v_fma_f32 v186, v170, s32, -v224
 v_fma_f32 v187, v171, s32, -v224
 v_fma_f32 v188, v172, s32, -v224
 v_fma_f32 v189, v173, s32, -v224
 v_fma_f32 v190, v174, s32, -v224
 v_fma_f32 v191, v175, s32, -v224
 s_mov_b32 s29, 1966464
 s_waitcnt vmcnt(23) lgkmcnt(0)
 s_barrier
 v_mfma_f32_32x32x16_bf16 v[160:175], v[64:67], v[16:19], 0
 ds_read_b64_tr_b16 v[112:113], v212 offset:0
 ds_read_b64_tr_b16 v[114:115], v212 offset:3072
 ds_read_b64_tr_b16 v[116:117], v213 offset:0
 v_exp_f32 v176, v176
 v_exp_f32 v177, v177
 v_exp_f32 v178, v178
 v_mfma_f32_32x32x16_bf16 v[160:175], v[68:71], v[20:23], v[160:175]
 ds_read_b64_tr_b16 v[118:119], v213 offset:3072
 ds_read_b64_tr_b16 v[120:121], v212 offset:128
 v_exp_f32 v179, v179
 v_add_f32 v226, v226, v176
 v_mfma_f32_32x32x16_bf16 v[160:175], v[72:75], v[24:27], v[160:175]
 ds_read_b64_tr_b16 v[122:123], v212 offset:3200
 ds_read_b64_tr_b16 v[124:125], v213 offset:128
 v_add_f32 v227, v227, v177
 v_cvt_pk_bf16_f32 v192, v176, v177
 v_exp_f32 v180, v180
 v_mfma_f32_32x32x16_bf16 v[160:175], v[76:79], v[28:31], v[160:175]
 ds_read_b64_tr_b16 v[126:127], v213 offset:3200
 ds_read_b64_tr_b16 v[128:129], v212 offset:256
 v_exp_f32 v181, v181
 v_add_f32 v226, v226, v178
 v_mfma_f32_32x32x16_bf16 v[160:175], v[80:83], v[32:35], v[160:175]
 ds_read_b64_tr_b16 v[130:131], v212 offset:3328
 ds_read_b64_tr_b16 v[132:133], v213 offset:256
 v_add_f32 v227, v227, v179
 v_cvt_pk_bf16_f32 v193, v178, v179
 v_exp_f32 v182, v182
 v_mfma_f32_32x32x16_bf16 v[160:175], v[84:87], v[36:39], v[160:175]
 ds_read_b64_tr_b16 v[134:135], v213 offset:3328
 ds_read_b64_tr_b16 v[136:137], v212 offset:6144
 ds_read_b64_tr_b16 v[138:139], v212 offset:9216
 v_exp_f32 v183, v183
 v_add_f32 v226, v226, v180
 v_mfma_f32_32x32x16_bf16 v[160:175], v[88:91], v[40:43], v[160:175]
 ds_read_b64_tr_b16 v[140:141], v213 offset:6144
 ds_read_b64_tr_b16 v[142:143], v213 offset:9216
 v_add_f32 v227, v227, v181
 v_cvt_pk_bf16_f32 v194, v180, v181
 v_exp_f32 v184, v184
 v_mfma_f32_32x32x16_bf16 v[160:175], v[92:95], v[44:47], v[160:175]
 ds_read_b64_tr_b16 v[144:145], v212 offset:6272
 ds_read_b64_tr_b16 v[146:147], v212 offset:9344
 v_exp_f32 v185, v185
 v_add_f32 v226, v226, v182
 v_mfma_f32_32x32x16_bf16 v[160:175], v[96:99], v[48:51], v[160:175]
 ds_read_b64_tr_b16 v[148:149], v213 offset:6272
 ds_read_b64_tr_b16 v[150:151], v213 offset:9344
 v_add_f32 v227, v227, v183
 v_cvt_pk_bf16_f32 v195, v182, v183
 v_exp_f32 v186, v186
 v_mfma_f32_32x32x16_bf16 v[160:175], v[100:103], v[52:55], v[160:175]
 ds_read_b64_tr_b16 v[152:153], v212 offset:6400
 ds_read_b64_tr_b16 v[154:155], v212 offset:9472
 v_exp_f32 v187, v187
 v_add_f32 v226, v226, v184
 v_mfma_f32_32x32x16_bf16 v[160:175], v[104:107], v[56:59], v[160:175]
 ds_read_b64_tr_b16 v[156:157], v213 offset:6400
 ds_read_b64_tr_b16 v[158:159], v213 offset:9472
 v_add_f32 v227, v227, v185
 v_cvt_pk_bf16_f32 v196, v184, v185
 v_exp_f32 v188, v188
 v_mfma_f32_32x32x16_bf16 v[160:175], v[108:111], v[60:63], v[160:175]
 v_exp_f32 v189, v189
 v_add_f32 v226, v226, v186
 v_add_u32 v208, s24, v200
 v_xor_b32 v209, 32, v208
 v_xor_b32 v210, 64, v208
 v_xor_b32 v211, 96, v208
 s_waitcnt lgkmcnt(6)
 v_mfma_f32_32x32x16_bf16 a[160:175], v[112:115], v[192:195], 0
 v_add_f32 v227, v227, v187
 v_cvt_pk_bf16_f32 v197, v186, v187
 v_exp_f32 v190, v190
 v_exp_f32 v191, v191
 ds_read_b128 v[64:67], v208 offset:12288
 ds_read_b128 v[68:71], v209 offset:12288
 s_add_u32 m0, s25, s42
 s_add_u32 s29, s29, 0
 buffer_load_dwordx4 v220, s[16:19], s29 offen offset:0 lds
 v_mfma_f32_32x32x16_bf16 a[176:191], v[116:119], v[192:195], 0
 v_add_f32 v226, v226, v188
 v_add_f32 v227, v227, v189
 v_cvt_pk_bf16_f32 v198, v188, v189
 ds_read_b128 v[72:75], v210 offset:12288
 v_mfma_f32_32x32x16_bf16 a[192:207], v[120:123], v[192:195], 0
 v_add_f32 v226, v226, v190
 v_add_f32 v227, v227, v191
 v_cvt_pk_bf16_f32 v199, v190, v191
 ds_read_b128 v[76:79], v211 offset:12288
 ds_read_b128 v[80:83], v208 offset:12416
 s_add_u32 s29, s29, 97280
 buffer_load_dwordx4 v220, s[16:19], s29 offen offset:1024 lds
 v_mfma_f32_32x32x16_bf16 a[208:223], v[124:127], v[192:195], 0
 ds_read_b128 v[84:87], v209 offset:12416
 v_max3_f32 v228, v160, v161, v162
 v_max3_f32 v228, v228, v163, v164
 v_max3_f32 v228, v228, v165, v166
 v_mfma_f32_32x32x16_bf16 a[224:239], v[128:131], v[192:195], 0
 ds_read_b128 v[88:91], v210 offset:12416
 ds_read_b128 v[92:95], v211 offset:12416
 v_max3_f32 v228, v228, v167, v168
 v_max3_f32 v228, v228, v169, v170
 v_max3_f32 v228, v228, v171, v172
 s_add_u32 s29, s29, 97280
 buffer_load_dwordx4 v220, s[16:19], s29 offen offset:2048 lds
 v_mfma_f32_32x32x16_bf16 a[240:255], v[132:135], v[192:195], 0
 ds_read_b128 v[96:99], v208 offset:12544
 v_max3_f32 v228, v228, v173, v174
 v_max_f32 v228, v228, v175
 v_cmp_gt_f32 vcc, v228, v225
 s_waitcnt lgkmcnt(9)
 v_mfma_f32_32x32x16_bf16 a[160:175], v[136:139], v[196:199], a[160:175]
 ds_read_b128 v[100:103], v209 offset:12544
 ds_read_b128 v[104:107], v210 offset:12544
 v_fma_f32 v176, v160, s32, -v224
 v_fma_f32 v177, v161, s32, -v224
 v_fma_f32 v178, v162, s32, -v224
 v_fma_f32 v179, v163, s32, -v224
 s_add_u32 s29, s29, 97280
 buffer_load_dwordx4 v220, s[16:19], s29 offen offset:3072 lds
 v_mfma_f32_32x32x16_bf16 a[176:191], v[140:143], v[196:199], a[176:191]
 ds_read_b128 v[108:111], v211 offset:12544
 v_fma_f32 v180, v164, s32, -v224
 v_fma_f32 v181, v165, s32, -v224
 v_fma_f32 v182, v166, s32, -v224
 v_mfma_f32_32x32x16_bf16 a[192:207], v[144:147], v[196:199], a[192:207]
 v_fma_f32 v183, v167, s32, -v224
 v_fma_f32 v184, v168, s32, -v224
 v_fma_f32 v185, v169, s32, -v224
 s_add_u32 m0, m0, 4096
 s_add_u32 s29, s29, 101376
 buffer_load_dwordx4 v220, s[16:19], s29 offen offset:0 lds
 v_mfma_f32_32x32x16_bf16 a[208:223], v[148:151], v[196:199], a[208:223]
 v_fma_f32 v186, v170, s32, -v224
 v_fma_f32 v187, v171, s32, -v224
 v_fma_f32 v188, v172, s32, -v224
 v_mfma_f32_32x32x16_bf16 a[224:239], v[152:155], v[196:199], a[224:239]
 v_fma_f32 v189, v173, s32, -v224
 v_fma_f32 v190, v174, s32, -v224
 v_fma_f32 v191, v175, s32, -v224
 v_mfma_f32_32x32x16_bf16 a[240:255], v[156:159], v[196:199], a[240:255]
 s_mov_b32 s25, s24
 s_add_u32 s24, s24, 24576
 s_cmp_eq_u32 s24, 147456
 s_cselect_b32 s24, 0, s24
 v_add_u32 v212, s24, v204
 v_xor_b32 v213, 64, v212
 s_cbranch_vccz L_skip1
 s_call_b64 s[30:31], L_rescale
L_skip1:
 s_waitcnt vmcnt(22)
 s_call_b64 s[72:73], L_sub0
 s_waitcnt vmcnt(23)
 s_call_b64 s[72:73], L_sub33
 s_mov_b32 s29, 3932544
 s_waitcnt vmcnt(23)
 s_call_b64 s[72:73], L_sub36
 s_waitcnt vmcnt(22)
 s_call_b64 s[72:73], L_sub0
 s_waitcnt vmcnt(23)
 s_call_b64 s[72:73], L_sub46
 s_mov_b32 s29, 5898624
 s_waitcnt vmcnt(23)
 s_call_b64 s[72:73], L_sub36
 s_waitcnt vmcnt(22)
 s_call_b64 s[72:73], L_sub0
 s_waitcnt vmcnt(23)
 s_call_b64 s[72:73], L_sub49
 s_mov_b32 s29, 512
 s_waitcnt vmcnt(23)
 s_call_b64 s[72:73], L_sub36
 s_waitcnt vmcnt(22)
 s_call_b64 s[72:73], L_sub0
 s_waitcnt vmcnt(23)
 s_call_b64 s[72:73], L_sub52
 s_mov_b32 s29, 1966592
 s_waitcnt vmcnt(23)
 s_call_b64 s[72:73], L_sub36
 v_mbcnt_lo_u32_b32 v229, -1, 0
 v_mbcnt_hi_u32_b32 v229, -1, v229
 s_lshl_b32 s37, s7, 12
 s_add_u32 s37, s37, 147456
 v_lshlrev_b32 v229, 4, v229
 v_add_u32 v229, s37, v229
 v_cvt_pk_bf16_f32 v0, v0, v1
 v_cvt_pk_bf16_f32 v1, v2, v3
 v_cvt_pk_bf16_f32 v2, v4, v5
 v_cvt_pk_bf16_f32 v3, v6, v7
 v_cvt_pk_bf16_f32 v4, v8, v9
 v_cvt_pk_bf16_f32 v5, v10, v11
 v_cvt_pk_bf16_f32 v6, v12, v13
 v_cvt_pk_bf16_f32 v7, v14, v15
 ds_write_b128 v229, v[0:3] offset:0
 ds_write_b128 v229, v[4:7] offset:1024
 v_cvt_pk_bf16_f32 v240, v240, v241
 v_cvt_pk_bf16_f32 v241, v242, v243
 v_cvt_pk_bf16_f32 v242, v244, v245
 v_cvt_pk_bf16_f32 v243, v246, v247
 v_cvt_pk_bf16_f32 v244, v248, v249
 v_cvt_pk_bf16_f32 v245, v250, v251
 v_cvt_pk_bf16_f32 v246, v252, v253
 v_cvt_pk_bf16_f32 v247, v254, v255
 ds_write_b128 v229, v[240:243] offset:2048
 ds_write_b128 v229, v[244:247] offset:3072
 s_waitcnt vmcnt(22)
 s_call_b64 s[72:73], L_sub0
 s_waitcnt vmcnt(23)
 s_call_b64 s[72:73], L_sub33
 s_mov_b32 s29, 3932672
 s_waitcnt vmcnt(23)
 s_call_b64 s[72:73], L_sub36
 s_waitcnt vmcnt(22)
 s_call_b64 s[72:73], L_sub0
 s_waitcnt vmcnt(23)
 s_call_b64 s[72:73], L_sub46
 s_mov_b32 s29, 5898752
 s_waitcnt vmcnt(23)
 s_call_b64 s[72:73], L_sub36
 s_waitcnt vmcnt(22)
 s_call_b64 s[72:73], L_sub0
 s_waitcnt vmcnt(23)
 s_call_b64 s[72:73], L_sub49
 s_mov_b32 s29, 640
 s_waitcnt vmcnt(23)
 s_call_b64 s[72:73], L_sub36
 s_waitcnt vmcnt(22)
 s_call_b64 s[72:73], L_sub0
 s_waitcnt vmcnt(23)
 s_call_b64 s[72:73], L_sub52
 s_mov_b32 s29, 1966720
 s_waitcnt vmcnt(23)
 s_call_b64 s[72:73], L_sub36
 v_cvt_pk_bf16_f32 v201, v0, v1
 v_cvt_pk_bf16_f32 v202, v2, v3
 v_cvt_pk_bf16_f32 v203, v4, v5
 v_cvt_pk_bf16_f32 v205, v6, v7
 v_cvt_pk_bf16_f32 v207, v8, v9
 v_cvt_pk_bf16_f32 v221, v10, v11
 v_cvt_pk_bf16_f32 v222, v12, v13
 v_cvt_pk_bf16_f32 v231, v14, v15
 v_cvt_pk_bf16_f32 v232, v240, v241
 v_cvt_pk_bf16_f32 v233, v242, v243
 v_cvt_pk_bf16_f32 v234, v244, v245
 v_cvt_pk_bf16_f32 v235, v246, v247
 v_cvt_pk_bf16_f32 v236, v248, v249
 v_cvt_pk_bf16_f32 v237, v250, v251
 v_cvt_pk_bf16_f32 v238, v252, v253
 v_cvt_pk_bf16_f32 v239, v254, v255
 s_waitcnt vmcnt(22)
 s_call_b64 s[72:73], L_sub0
 s_waitcnt vmcnt(23)
 s_call_b64 s[72:73], L_sub33
 s_mov_b32 s29, 3932800
 s_waitcnt vmcnt(23)
 s_call_b64 s[72:73], L_sub36
 s_waitcnt vmcnt(22)
 s_call_b64 s[72:73], L_sub0
 s_waitcnt vmcnt(23)
 s_call_b64 s[72:73], L_sub46
 s_mov_b32 s29, 5898880
 s_waitcnt vmcnt(23)
 s_call_b64 s[72:73], L_sub36
 s_waitcnt vmcnt(22)
 s_call_b64 s[72:73], L_sub0
 s_waitcnt vmcnt(23)
 s_call_b64 s[72:73], L_sub49
 s_waitcnt vmcnt(23)
 s_call_b64 s[72:73], L_sub55
 s_waitcnt vmcnt(23)
 s_call_b64 s[72:73], L_sub0
 s_waitcnt vmcnt(24)
 s_call_b64 s[72:73], L_sub52
 s_waitcnt vmcnt(24)
 s_call_b64 s[72:73], L_sub55
 v_cvt_pk_bf16_f32 v0, v0, v1
 v_cvt_pk_bf16_f32 v1, v2, v3
 v_cvt_pk_bf16_f32 v2, v4, v5
 v_cvt_pk_bf16_f32 v3, v6, v7
 v_cvt_pk_bf16_f32 v4, v8, v9
 v_cvt_pk_bf16_f32 v5, v10, v11
 v_cvt_pk_bf16_f32 v6, v12, v13
 v_cvt_pk_bf16_f32 v7, v14, v15
 v_cvt_pk_bf16_f32 v240, v240, v241
 v_cvt_pk_bf16_f32 v241, v242, v243
 v_cvt_pk_bf16_f32 v242, v244, v245
 v_cvt_pk_bf16_f32 v243, v246, v247
 v_cvt_pk_bf16_f32 v244, v248, v249
 v_cvt_pk_bf16_f32 v245, v250, v251
 v_cvt_pk_bf16_f32 v246, v252, v253
 v_cvt_pk_bf16_f32 v247, v254, v255
 s_waitcnt vmcnt(24)
 s_call_b64 s[72:73], L_sub60
 s_waitcnt vmcnt(24) lgkmcnt(0)
 s_barrier
 v_mfma_f32_32x32x16_bf16 v[160:175], v[64:67], v[16:19], 0
 ds_read_b64_tr_b16 v[112:113], v212 offset:0
 ds_read_b64_tr_b16 v[114:115], v212 offset:3072
 ds_read_b64_tr_b16 v[116:117], v213 offset:0
 v_exp_f32 v176, v176
 v_exp_f32 v177, v177
 v_exp_f32 v178, v178
 v_mfma_f32_32x32x16_bf16 v[160:175], v[68:71], v[20:23], v[160:175]
 ds_read_b64_tr_b16 v[118:119], v213 offset:3072
 ds_read_b64_tr_b16 v[120:121], v212 offset:128
 v_exp_f32 v179, v179
 v_add_f32 v226, v226, v176
 v_mfma_f32_32x32x16_bf16 v[160:175], v[72:75], v[24:27], v[160:175]
 ds_read_b64_tr_b16 v[122:123], v212 offset:3200
 ds_read_b64_tr_b16 v[124:125], v213 offset:128
 v_add_f32 v227, v227, v177
 v_cvt_pk_bf16_f32 v192, v176, v177
 v_exp_f32 v180, v180
 v_mfma_f32_32x32x16_bf16 v[160:175], v[76:79], v[28:31], v[160:175]
 ds_read_b64_tr_b16 v[126:127], v213 offset:3200
 ds_read_b64_tr_b16 v[128:129], v212 offset:256
 v_exp_f32 v181, v181
 v_add_f32 v226, v226, v178
 v_mfma_f32_32x32x16_bf16 v[160:175], v[80:83], v[32:35], v[160:175]
 ds_read_b64_tr_b16 v[130:131], v212 offset:3328
 ds_read_b64_tr_b16 v[132:133], v213 offset:256
 v_add_f32 v227, v227, v179
 v_cvt_pk_bf16_f32 v193, v178, v179
 v_exp_f32 v182, v182
 v_mfma_f32_32x32x16_bf16 v[160:175], v[84:87], v[36:39], v[160:175]
 ds_read_b64_tr_b16 v[134:135], v213 offset:3328
 ds_read_b64_tr_b16 v[136:137], v212 offset:6144
 ds_read_b64_tr_b16 v[138:139], v212 offset:9216
 v_exp_f32 v183, v183
 v_add_f32 v226, v226, v180
 v_mfma_f32_32x32x16_bf16 v[160:175], v[88:91], v[40:43], v[160:175]
 ds_read_b64_tr_b16 v[140:141], v213 offset:6144
 ds_read_b64_tr_b16 v[142:143], v213 offset:9216
 v_add_f32 v227, v227, v181
 v_cvt_pk_bf16_f32 v194, v180, v181
 v_exp_f32 v184, v184
 v_mfma_f32_32x32x16_bf16 v[160:175], v[92:95], v[44:47], v[160:175]
 ds_read_b64_tr_b16 v[144:145], v212 offset:6272
 ds_read_b64_tr_b16 v[146:147], v212 offset:9344
 v_exp_f32 v185, v185
 v_add_f32 v226, v226, v182
 v_mfma_f32_32x32x16_bf16 v[160:175], v[96:99], v[48:51], v[160:175]
 ds_read_b64_tr_b16 v[148:149], v213 offset:6272
 ds_read_b64_tr_b16 v[150:151], v213 offset:9344
 v_add_f32 v227, v227, v183
 v_cvt_pk_bf16_f32 v195, v182, v183
 v_exp_f32 v186, v186
 v_mfma_f32_32x32x16_bf16 v[160:175], v[100:103], v[52:55], v[160:175]
 ds_read_b64_tr_b16 v[152:153], v212 offset:6400
 ds_read_b64_tr_b16 v[154:155], v212 offset:9472
 v_exp_f32 v187, v187
 v_add_f32 v226, v226, v184
 v_mfma_f32_32x32x16_bf16 v[160:175], v[104:107], v[56:59], v[160:175]
 ds_read_b64_tr_b16 v[156:157], v213 offset:6400
 ds_read_b64_tr_b16 v[158:159], v213 offset:9472
 v_add_f32 v227, v227, v185
 v_cvt_pk_bf16_f32 v196, v184, v185
 v_exp_f32 v188, v188
 v_mfma_f32_32x32x16_bf16 v[160:175], v[108:111], v[60:63], v[160:175]
 v_exp_f32 v189, v189
 v_add_f32 v226, v226, v186
 v_add_u32 v208, s24, v200
 v_xor_b32 v209, 32, v208
 v_xor_b32 v210, 64, v208
 v_xor_b32 v211, 96, v208
 s_waitcnt lgkmcnt(6)
 v_mfma_f32_32x32x16_bf16 a[160:175], v[112:115], v[192:195], a[160:175]
 v_add_f32 v227, v227, v187
 v_cvt_pk_bf16_f32 v197, v186, v187
 v_exp_f32 v190, v190
 v_exp_f32 v191, v191
 ds_read_b128 v[64:67], v208 offset:12288
 ds_read_b128 v[68:71], v209 offset:12288
 s_add_u32 m0, s25, s40
 s_nop 0
 buffer_load_dwordx4 v214, s[8:11], s27 offen offset:0 nt lds
 v_mfma_f32_32x32x16_bf16 a[176:191], v[116:119], v[192:195], a[176:191]
 v_add_f32 v226, v226, v188
 v_add_f32 v227, v227, v189
 v_cvt_pk_bf16_f32 v198, v188, v189
 ds_read_b128 v[72:75], v210 offset:12288
 buffer_load_dwordx4 v215, s[8:11], s27 offen offset:1024 nt lds
 v_mfma_f32_32x32x16_bf16 a[192:207], v[120:123], v[192:195], a[192:207]
 v_add_f32 v226, v226, v190
 v_add_f32 v227, v227, v191
 v_cvt_pk_bf16_f32 v199, v190, v191
 ds_read_b128 v[76:79], v211 offset:12288
 ds_read_b128 v[80:83], v208 offset:12416
 v_mfma_f32_32x32x16_bf16 a[208:223], v[124:127], v[192:195], a[208:223]
 ds_read_b128 v[84:87], v209 offset:12416
 v_max3_f32 v228, v160, v161, v162
 v_max3_f32 v228, v228, v163, v164
 v_max3_f32 v228, v228, v165, v166
 buffer_load_dwordx4 v216, s[8:11], s27 offen offset:2048 nt lds
 s_add_u32 s27, s27, 12288
 v_mfma_f32_32x32x16_bf16 a[224:239], v[128:131], v[192:195], a[224:239]
 ds_read_b128 v[88:91], v210 offset:12416
 ds_read_b128 v[92:95], v211 offset:12416
 v_max3_f32 v228, v228, v167, v168
 v_max3_f32 v228, v228, v169, v170
 v_max3_f32 v228, v228, v171, v172
 v_mfma_f32_32x32x16_bf16 a[240:255], v[132:135], v[192:195], a[240:255]
 ds_read_b128 v[96:99], v208 offset:12544
 v_max3_f32 v228, v228, v173, v174
 v_max_f32 v228, v228, v175
 v_cmp_gt_f32 vcc, v228, v225
 s_add_u32 m0, s25, s41
 s_nop 0
 buffer_load_dwordx4 v214, s[8:11], s27 offen offset:0 nt lds
 s_waitcnt lgkmcnt(9)
 v_mfma_f32_32x32x16_bf16 a[160:175], v[136:139], v[196:199], a[160:175]
 ds_read_b128 v[100:103], v209 offset:12544
 ds_read_b128 v[104:107], v210 offset:12544
 v_fma_f32 v176, v160, s32, -v224
 v_fma_f32 v177, v161, s32, -v224
 v_fma_f32 v178, v162, s32, -v224
 v_fma_f32 v179, v163, s32, -v224
 v_mfma_f32_32x32x16_bf16 a[176:191], v[140:143], v[196:199], a[176:191]
 ds_read_b128 v[108:111], v211 offset:12544
 v_fma_f32 v180, v164, s32, -v224
 v_fma_f32 v181, v165, s32, -v224
 v_fma_f32 v182, v166, s32, -v224
 buffer_load_dwordx4 v215, s[8:11], s27 offen offset:1024 nt lds
 v_mfma_f32_32x32x16_bf16 a[192:207], v[144:147], v[196:199], a[192:207]
 v_fma_f32 v183, v167, s32, -v224
 v_fma_f32 v184, v168, s32, -v224
 v_fma_f32 v185, v169, s32, -v224
 v_mfma_f32_32x32x16_bf16 a[208:223], v[148:151], v[196:199], a[208:223]
 v_fma_f32 v186, v170, s32, -v224
 v_fma_f32 v187, v171, s32, -v224
 v_fma_f32 v188, v172, s32, -v224
 buffer_load_dwordx4 v216, s[8:11], s27 offen offset:2048 nt lds
 s_add_u32 s27, s27, 12288
 v_mfma_f32_32x32x16_bf16 a[224:239], v[152:155], v[196:199], a[224:239]
 v_fma_f32 v189, v173, s32, -v224
 v_fma_f32 v190, v174, s32, -v224
 v_fma_f32 v191, v175, s32, -v224
 v_mfma_f32_32x32x16_bf16 a[240:255], v[156:159], v[196:199], a[240:255]
 s_mov_b32 s25, s24
 s_add_u32 s24, s24, 24576
 s_cmp_eq_u32 s24, 147456
 s_cselect_b32 s24, 0, s24
 v_add_u32 v212, s24, v204
 v_xor_b32 v213, 64, v212
 s_cbranch_vccz L_skip27
 s_call_b64 s[30:31], L_rescale
L_skip27:
 s_waitcnt vmcnt(24)
 s_call_b64 s[72:73], L_sub0
 s_waitcnt vmcnt(24)
 s_call_b64 s[72:73], L_sub0
 s_waitcnt vmcnt(24)
 s_call_b64 s[72:73], L_sub0
 s_waitcnt vmcnt(24) lgkmcnt(0)
 s_barrier
 v_mfma_f32_32x32x16_bf16 v[160:175], v[64:67], v[16:19], 0
 ds_read_b64_tr_b16 v[112:113], v212 offset:0
 ds_read_b64_tr_b16 v[114:115], v212 offset:3072
 ds_read_b64_tr_b16 v[116:117], v213 offset:0
 v_exp_f32 v176, v176
 v_exp_f32 v177, v177
 v_exp_f32 v178, v178
 v_mfma_f32_32x32x16_bf16 v[160:175], v[68:71], v[20:23], v[160:175]
 ds_read_b64_tr_b16 v[118:119], v213 offset:3072
 ds_read_b64_tr_b16 v[120:121], v212 offset:128
 v_exp_f32 v179, v179
 v_add_f32 v226, v226, v176
 v_mfma_f32_32x32x16_bf16 v[160:175], v[72:75], v[24:27], v[160:175]
 ds_read_b64_tr_b16 v[122:123], v212 offset:3200
 ds_read_b64_tr_b16 v[124:125], v213 offset:128
 v_add_f32 v227, v227, v177
 v_cvt_pk_bf16_f32 v192, v176, v177
 v_exp_f32 v180, v180
 v_mfma_f32_32x32x16_bf16 v[160:175], v[76:79], v[28:31], v[160:175]
 ds_read_b64_tr_b16 v[126:127], v213 offset:3200
 ds_read_b64_tr_b16 v[128:129], v212 offset:256
 v_exp_f32 v181, v181
 v_add_f32 v226, v226, v178
 v_mfma_f32_32x32x16_bf16 v[160:175], v[80:83], v[32:35], v[160:175]
 ds_read_b64_tr_b16 v[130:131], v212 offset:3328
 ds_read_b64_tr_b16 v[132:133], v213 offset:256
 v_add_f32 v227, v227, v179
 v_cvt_pk_bf16_f32 v193, v178, v179
 v_exp_f32 v182, v182
 v_mfma_f32_32x32x16_bf16 v[160:175], v[84:87], v[36:39], v[160:175]
 ds_read_b64_tr_b16 v[134:135], v213 offset:3328
 ds_read_b64_tr_b16 v[136:137], v212 offset:6144
 ds_read_b64_tr_b16 v[138:139], v212 offset:9216
 v_exp_f32 v183, v183
 v_add_f32 v226, v226, v180
 v_mfma_f32_32x32x16_bf16 v[160:175], v[88:91], v[40:43], v[160:175]
 ds_read_b64_tr_b16 v[140:141], v213 offset:6144
 ds_read_b64_tr_b16 v[142:143], v213 offset:9216
 v_add_f32 v227, v227, v181
 v_cvt_pk_bf16_f32 v194, v180, v181
 v_exp_f32 v184, v184
 v_mfma_f32_32x32x16_bf16 v[160:175], v[92:95], v[44:47], v[160:175]
 ds_read_b64_tr_b16 v[144:145], v212 offset:6272
 ds_read_b64_tr_b16 v[146:147], v212 offset:9344
 v_exp_f32 v185, v185
 v_add_f32 v226, v226, v182
 v_mfma_f32_32x32x16_bf16 v[160:175], v[96:99], v[48:51], v[160:175]
 ds_read_b64_tr_b16 v[148:149], v213 offset:6272
 ds_read_b64_tr_b16 v[150:151], v213 offset:9344
 v_add_f32 v227, v227, v183
 v_cvt_pk_bf16_f32 v195, v182, v183
 v_exp_f32 v186, v186
 v_mfma_f32_32x32x16_bf16 v[160:175], v[100:103], v[52:55], v[160:175]
 ds_read_b64_tr_b16 v[152:153], v212 offset:6400
 ds_read_b64_tr_b16 v[154:155], v212 offset:9472
 v_exp_f32 v187, v187
 v_add_f32 v226, v226, v184
 v_mfma_f32_32x32x16_bf16 v[160:175], v[104:107], v[56:59], v[160:175]
 ds_read_b64_tr_b16 v[156:157], v213 offset:6400
 ds_read_b64_tr_b16 v[158:159], v213 offset:9472
 v_add_f32 v227, v227, v185
 v_cvt_pk_bf16_f32 v196, v184, v185
 v_exp_f32 v188, v188
 v_mfma_f32_32x32x16_bf16 v[160:175], v[108:111], v[60:63], v[160:175]
 v_exp_f32 v189, v189
 v_add_f32 v226, v226, v186
 s_waitcnt lgkmcnt(6)
 v_mfma_f32_32x32x16_bf16 a[160:175], v[112:115], v[192:195], a[160:175]
 v_add_f32 v227, v227, v187
 v_cvt_pk_bf16_f32 v197, v186, v187
 v_exp_f32 v190, v190
 v_exp_f32 v191, v191
 ds_read_b64_tr_b16 v[64:65], v212 offset:12288
 ds_read_b64_tr_b16 v[66:67], v212 offset:15360
 ds_read_b64_tr_b16 v[68:69], v213 offset:12288
 s_add_u32 m0, s25, s40
 s_nop 0
 buffer_load_dwordx4 v217, s[12:15], s28 offen offset:0 nt lds
 v_mfma_f32_32x32x16_bf16 a[176:191], v[116:119], v[192:195], a[176:191]
 v_add_f32 v226, v226, v188
 v_add_f32 v227, v227, v189
 v_cvt_pk_bf16_f32 v198, v188, v189
 ds_read_b64_tr_b16 v[70:71], v213 offset:15360
 ds_read_b64_tr_b16 v[72:73], v212 offset:12416
 ds_read_b64_tr_b16 v[74:75], v212 offset:15488
 buffer_load_dwordx4 v218, s[12:15], s28 offen offset:1024 nt lds
 v_mfma_f32_32x32x16_bf16 a[192:207], v[120:123], v[192:195], a[192:207]
 v_add_f32 v226, v226, v190
 v_add_f32 v227, v227, v191
 v_cvt_pk_bf16_f32 v199, v190, v191
 ds_read_b64_tr_b16 v[76:77], v213 offset:12416
 ds_read_b64_tr_b16 v[78:79], v213 offset:15488
 ds_read_b64_tr_b16 v[80:81], v212 offset:12544
 v_mfma_f32_32x32x16_bf16 a[208:223], v[124:127], v[192:195], a[208:223]
 ds_read_b64_tr_b16 v[82:83], v212 offset:15616
 ds_read_b64_tr_b16 v[84:85], v213 offset:12544
 ds_read_b64_tr_b16 v[86:87], v213 offset:15616
 v_max3_f32 v228, v160, v161, v162
 v_max3_f32 v228, v228, v163, v164
 v_max3_f32 v228, v228, v165, v166
 buffer_load_dwordx4 v219, s[12:15], s28 offen offset:2048 nt lds
 s_add_u32 s28, s28, 12288
 v_mfma_f32_32x32x16_bf16 a[224:239], v[128:131], v[192:195], a[224:239]
 ds_read_b64_tr_b16 v[88:89], v212 offset:18432
 ds_read_b64_tr_b16 v[90:91], v212 offset:21504
 ds_read_b64_tr_b16 v[92:93], v213 offset:18432
 v_max3_f32 v228, v228, v167, v168
 v_max3_f32 v228, v228, v169, v170
 v_max3_f32 v228, v228, v171, v172
 v_mfma_f32_32x32x16_bf16 a[240:255], v[132:135], v[192:195], a[240:255]
 ds_read_b64_tr_b16 v[94:95], v213 offset:21504
 ds_read_b64_tr_b16 v[96:97], v212 offset:18560
 ds_read_b64_tr_b16 v[98:99], v212 offset:21632
 v_max3_f32 v228, v228, v173, v174
 v_max_f32 v228, v228, v175
 v_cmp_gt_f32 vcc, v228, v225
 s_add_u32 m0, s25, s41
 s_nop 0
 buffer_load_dwordx4 v214, s[8:11], s27 offen offset:0 nt lds
 s_waitcnt lgkmcnt(15)
 v_mfma_f32_32x32x16_bf16 a[160:175], v[136:139], v[196:199], a[160:175]
 ds_read_b64_tr_b16 v[100:101], v213 offset:18560
 ds_read_b64_tr_b16 v[102:103], v213 offset:21632
 ds_read_b64_tr_b16 v[104:105], v212 offset:18688
 v_fma_f32 v176, v160, s32, -v224
 v_fma_f32 v177, v161, s32, -v224
 v_fma_f32 v178, v162, s32, -v224
 v_fma_f32 v179, v163, s32, -v224
 v_mfma_f32_32x32x16_bf16 a[176:191], v[140:143], v[196:199], a[176:191]
 ds_read_b64_tr_b16 v[106:107], v212 offset:21760
 ds_read_b64_tr_b16 v[108:109], v213 offset:18688
 ds_read_b64_tr_b16 v[110:111], v213 offset:21760
 v_fma_f32 v180, v164, s32, -v224
 v_fma_f32 v181, v165, s32, -v224
 v_fma_f32 v182, v166, s32, -v224
 buffer_load_dwordx4 v215, s[8:11], s27 offen offset:1024 nt lds
 v_mfma_f32_32x32x16_bf16 a[192:207], v[144:147], v[196:199], a[192:207]
 v_fma_f32 v183, v167, s32, -v224
 v_fma_f32 v184, v168, s32, -v224
 v_fma_f32 v185, v169, s32, -v224
 v_mfma_f32_32x32x16_bf16 a[208:223], v[148:151], v[196:199], a[208:223]
 v_fma_f32 v186, v170, s32, -v224
 v_fma_f32 v187, v171, s32, -v224
 v_fma_f32 v188, v172, s32, -v224
 buffer_load_dwordx4 v216, s[8:11], s27 offen offset:2048 nt lds
 s_add_u32 s27, s27, 12288
 v_mfma_f32_32x32x16_bf16 a[224:239], v[152:155], v[196:199], a[224:239]
 v_fma_f32 v189, v173, s32, -v224
 v_fma_f32 v190, v174, s32, -v224
 v_fma_f32 v191, v175, s32, -v224
 v_mfma_f32_32x32x16_bf16 a[240:255], v[156:159], v[196:199], a[240:255]
 s_mov_b32 s25, s24
 s_add_u32 s24, s24, 24576
 s_cmp_eq_u32 s24, 147456
 s_cselect_b32 s24, 0, s24
 v_add_u32 v208, s24, v200
 v_xor_b32 v209, 32, v208
 v_xor_b32 v210, 64, v208
 v_xor_b32 v211, 96, v208
 s_cbranch_vccz L_skip31
 s_call_b64 s[30:31], L_rescale
L_skip31:
 v_exp_f32 v176, v176
 v_exp_f32 v177, v177
 v_exp_f32 v178, v178
 v_exp_f32 v179, v179
 v_add_f32 v226, v226, v176
 v_add_f32 v227, v227, v177
 v_cvt_pk_bf16_f32 v192, v176, v177
 v_exp_f32 v180, v180
 v_exp_f32 v181, v181
 v_add_f32 v226, v226, v178
 v_add_f32 v227, v227, v179
 v_cvt_pk_bf16_f32 v193, v178, v179
 v_exp_f32 v182, v182
 v_exp_f32 v183, v183
 v_add_f32 v226, v226, v180
 v_add_f32 v227, v227, v181
 v_cvt_pk_bf16_f32 v194, v180, v181
 v_exp_f32 v184, v184
 v_exp_f32 v185, v185
 v_add_f32 v226, v226, v182
 v_add_f32 v227, v227, v183
 v_cvt_pk_bf16_f32 v195, v182, v183
 v_exp_f32 v186, v186
 v_exp_f32 v187, v187
 v_add_f32 v226, v226, v184
 v_add_f32 v227, v227, v185
 v_cvt_pk_bf16_f32 v196, v184, v185
 v_exp_f32 v188, v188
 v_exp_f32 v189, v189
 v_add_f32 v226, v226, v186
 v_add_f32 v227, v227, v187
 v_cvt_pk_bf16_f32 v197, v186, v187
 v_exp_f32 v190, v190
 v_exp_f32 v191, v191
 v_add_f32 v226, v226, v188
 v_add_f32 v227, v227, v189
 v_cvt_pk_bf16_f32 v198, v188, v189
 v_add_f32 v226, v226, v190
 v_add_f32 v227, v227, v191
 v_cvt_pk_bf16_f32 v199, v190, v191
 s_waitcnt lgkmcnt(0)
 s_nop 0
 v_mfma_f32_32x32x16_bf16 a[160:175], v[64:67], v[192:195], a[160:175]
 v_mfma_f32_32x32x16_bf16 a[160:175], v[88:91], v[196:199], a[160:175]
 v_mfma_f32_32x32x16_bf16 a[176:191], v[68:71], v[192:195], a[176:191]
 v_add_f32 v226, v226, v227
 v_mov_b32 v229, v226
 s_nop 1
 v_permlane32_swap_b32 v229, v226
 s_nop 1
 v_mfma_f32_32x32x16_bf16 a[176:191], v[92:95], v[196:199], a[176:191]
 v_add_f32 v226, v226, v229
 v_rcp_f32 v226, v226
 s_mov_b32 s35, 0
 s_nop 7
 v_mfma_f32_32x32x16_bf16 a[192:207], v[72:75], v[192:195], a[192:207]
 v_accvgpr_read_b32 v176, a160
 v_accvgpr_read_b32 v177, a161
 v_accvgpr_read_b32 v178, a162
 v_accvgpr_read_b32 v179, a163
 v_accvgpr_read_b32 v180, a164
 v_accvgpr_read_b32 v181, a165
 v_accvgpr_read_b32 v182, a166
 v_accvgpr_read_b32 v183, a167
 v_mfma_f32_32x32x16_bf16 a[192:207], v[96:99], v[196:199], a[192:207]
 v_mul_f32 v176, v176, v226
 v_mul_f32 v177, v177, v226
 v_mul_f32 v178, v178, v226
 v_mul_f32 v179, v179, v226
 v_mul_f32 v180, v180, v226
 v_mul_f32 v181, v181, v226
 v_mul_f32 v182, v182, v226
 v_mul_f32 v183, v183, v226
 v_mfma_f32_32x32x16_bf16 a[208:223], v[76:79], v[192:195], a[208:223]
 v_cvt_pk_bf16_f32 v112, v176, v177
 v_cvt_pk_bf16_f32 v113, v178, v179
 v_cvt_pk_bf16_f32 v114, v180, v181
 v_cvt_pk_bf16_f32 v115, v182, v183
 v_accvgpr_write_b32 a80, v112
 v_accvgpr_write_b32 a81, v113
 v_accvgpr_write_b32 a82, v114
 v_accvgpr_write_b32 a83, v115
 v_mfma_f32_32x32x16_bf16 a[208:223], v[100:103], v[196:199], a[208:223]
 v_accvgpr_read_b32 v176, a168
 v_accvgpr_read_b32 v177, a169
 v_accvgpr_read_b32 v178, a170
 v_accvgpr_read_b32 v179, a171
 v_accvgpr_read_b32 v180, a172
 v_accvgpr_read_b32 v181, a173
 v_accvgpr_read_b32 v182, a174
 v_accvgpr_read_b32 v183, a175
 v_mfma_f32_32x32x16_bf16 a[224:239], v[80:83], v[192:195], a[224:239]
 v_mul_f32 v176, v176, v226
 v_mul_f32 v177, v177, v226
 v_mul_f32 v178, v178, v226
 v_mul_f32 v179, v179, v226
 v_mul_f32 v180, v180, v226
 v_mul_f32 v181, v181, v226
 v_mul_f32 v182, v182, v226
 v_mul_f32 v183, v183, v226
 v_mfma_f32_32x32x16_bf16 a[224:239], v[104:107], v[196:199], a[224:239]
 v_cvt_pk_bf16_f32 v116, v176, v177
 v_cvt_pk_bf16_f32 v117, v178, v179
 v_cvt_pk_bf16_f32 v118, v180, v181
 v_cvt_pk_bf16_f32 v119, v182, v183
 v_accvgpr_write_b32 a84, v116
 v_accvgpr_write_b32 a85, v117
 v_accvgpr_write_b32 a86, v118
 v_accvgpr_write_b32 a87, v119
 v_mfma_f32_32x32x16_bf16 a[240:255], v[84:87], v[192:195], a[240:255]
 v_accvgpr_read_b32 v176, a176
 v_accvgpr_read_b32 v177, a177
 v_accvgpr_read_b32 v178, a178
 v_accvgpr_read_b32 v179, a179
 v_accvgpr_read_b32 v180, a180
 v_accvgpr_read_b32 v181, a181
 v_accvgpr_read_b32 v182, a182
 v_accvgpr_read_b32 v183, a183
 v_mfma_f32_32x32x16_bf16 a[240:255], v[108:111], v[196:199], a[240:255]
 v_mul_f32 v176, v176, v226
 v_mul_f32 v177, v177, v226
 v_mul_f32 v178, v178, v226
 v_mul_f32 v179, v179, v226
 v_mul_f32 v180, v180, v226
 v_mul_f32 v181, v181, v226
 v_mul_f32 v182, v182, v226
 v_mul_f32 v183, v183, v226
 v_cvt_pk_bf16_f32 v120, v176, v177
 v_cvt_pk_bf16_f32 v121, v178, v179
 v_cvt_pk_bf16_f32 v122, v180, v181
 v_cvt_pk_bf16_f32 v123, v182, v183
 v_accvgpr_write_b32 a88, v120
 v_accvgpr_write_b32 a89, v121
 v_accvgpr_write_b32 a90, v122
 v_accvgpr_write_b32 a91, v123
 v_accvgpr_read_b32 v176, a184
 v_accvgpr_read_b32 v177, a185
 v_accvgpr_read_b32 v178, a186
 v_accvgpr_read_b32 v179, a187
 v_accvgpr_read_b32 v180, a188
 v_accvgpr_read_b32 v181, a189
 v_accvgpr_read_b32 v182, a190
 v_accvgpr_read_b32 v183, a191
 v_mul_f32 v176, v176, v226
 v_mul_f32 v177, v177, v226
 v_mul_f32 v178, v178, v226
 v_mul_f32 v179, v179, v226
 v_mul_f32 v180, v180, v226
 v_mul_f32 v181, v181, v226
 v_mul_f32 v182, v182, v226
 v_mul_f32 v183, v183, v226
 v_cvt_pk_bf16_f32 v124, v176, v177
 v_cvt_pk_bf16_f32 v125, v178, v179
 v_cvt_pk_bf16_f32 v126, v180, v181
 v_cvt_pk_bf16_f32 v127, v182, v183
 v_accvgpr_write_b32 a92, v124
 v_accvgpr_write_b32 a93, v125
 v_accvgpr_write_b32 a94, v126
 v_accvgpr_write_b32 a95, v127
 v_accvgpr_read_b32 v176, a192
 v_accvgpr_read_b32 v177, a193
 v_accvgpr_read_b32 v178, a194
 v_accvgpr_read_b32 v179, a195
 v_accvgpr_read_b32 v180, a196
 v_accvgpr_read_b32 v181, a197
 v_accvgpr_read_b32 v182, a198
 v_accvgpr_read_b32 v183, a199
 v_mul_f32 v176, v176, v226
 v_mul_f32 v177, v177, v226
 v_mul_f32 v178, v178, v226
 v_mul_f32 v179, v179, v226
 v_mul_f32 v180, v180, v226
 v_mul_f32 v181, v181, v226
 v_mul_f32 v182, v182, v226
 v_mul_f32 v183, v183, v226
 v_cvt_pk_bf16_f32 v128, v176, v177
 v_cvt_pk_bf16_f32 v129, v178, v179
 v_cvt_pk_bf16_f32 v130, v180, v181
 v_cvt_pk_bf16_f32 v131, v182, v183
 v_accvgpr_write_b32 a96, v128
 v_accvgpr_write_b32 a97, v129
 v_accvgpr_write_b32 a98, v130
 v_accvgpr_write_b32 a99, v131
 v_accvgpr_read_b32 v176, a200
 v_accvgpr_read_b32 v177, a201
 v_accvgpr_read_b32 v178, a202
 v_accvgpr_read_b32 v179, a203
 v_accvgpr_read_b32 v180, a204
 v_accvgpr_read_b32 v181, a205
 v_accvgpr_read_b32 v182, a206
 v_accvgpr_read_b32 v183, a207
 v_mul_f32 v176, v176, v226
 v_mul_f32 v177, v177, v226
 v_mul_f32 v178, v178, v226
 v_mul_f32 v179, v179, v226
 v_mul_f32 v180, v180, v226
 v_mul_f32 v181, v181, v226
 v_mul_f32 v182, v182, v226
 v_mul_f32 v183, v183, v226
 v_cvt_pk_bf16_f32 v132, v176, v177
 v_cvt_pk_bf16_f32 v133, v178, v179
 v_cvt_pk_bf16_f32 v134, v180, v181
 v_cvt_pk_bf16_f32 v135, v182, v183
 v_accvgpr_write_b32 a100, v132
 v_accvgpr_write_b32 a101, v133
 v_accvgpr_write_b32 a102, v134
 v_accvgpr_write_b32 a103, v135
 v_accvgpr_read_b32 v176, a208
 v_accvgpr_read_b32 v177, a209
 v_accvgpr_read_b32 v178, a210
 v_accvgpr_read_b32 v179, a211
 v_accvgpr_read_b32 v180, a212
 v_accvgpr_read_b32 v181, a213
 v_accvgpr_read_b32 v182, a214
 v_accvgpr_read_b32 v183, a215
 v_mul_f32 v176, v176, v226
 v_mul_f32 v177, v177, v226
 v_mul_f32 v178, v178, v226
 v_mul_f32 v179, v179, v226
 v_mul_f32 v180, v180, v226
 v_mul_f32 v181, v181, v226
 v_mul_f32 v182, v182, v226
 v_mul_f32 v183, v183, v226
 v_cvt_pk_bf16_f32 v136, v176, v177
 v_cvt_pk_bf16_f32 v137, v178, v179
 v_cvt_pk_bf16_f32 v138, v180, v181
 v_cvt_pk_bf16_f32 v139, v182, v183
 v_accvgpr_write_b32 a104, v136
 v_accvgpr_write_b32 a105, v137
 v_accvgpr_write_b32 a106, v138
 v_accvgpr_write_b32 a107, v139
 v_accvgpr_read_b32 v176, a216
 v_accvgpr_read_b32 v177, a217
 v_accvgpr_read_b32 v178, a218
 v_accvgpr_read_b32 v179, a219
 v_accvgpr_read_b32 v180, a220
 v_accvgpr_read_b32 v181, a221
 v_accvgpr_read_b32 v182, a222
 v_accvgpr_read_b32 v183, a223
 v_mul_f32 v176, v176, v226
 v_mul_f32 v177, v177, v226
 v_mul_f32 v178, v178, v226
 v_mul_f32 v179, v179, v226
 v_mul_f32 v180, v180, v226
 v_mul_f32 v181, v181, v226
 v_mul_f32 v182, v182, v226
 v_mul_f32 v183, v183, v226
 v_cvt_pk_bf16_f32 v140, v176, v177
 v_cvt_pk_bf16_f32 v141, v178, v179
 v_cvt_pk_bf16_f32 v142, v180, v181
 v_cvt_pk_bf16_f32 v143, v182, v183
 v_accvgpr_write_b32 a108, v140
 v_accvgpr_write_b32 a109, v141
 v_accvgpr_write_b32 a110, v142
 v_accvgpr_write_b32 a111, v143
 v_accvgpr_read_b32 v176, a224
 v_accvgpr_read_b32 v177, a225
 v_accvgpr_read_b32 v178, a226
 v_accvgpr_read_b32 v179, a227
 v_accvgpr_read_b32 v180, a228
 v_accvgpr_read_b32 v181, a229
 v_accvgpr_read_b32 v182, a230
 v_accvgpr_read_b32 v183, a231
 v_mul_f32 v176, v176, v226
 v_mul_f32 v177, v177, v226
 v_mul_f32 v178, v178, v226
 v_mul_f32 v179, v179, v226
 v_mul_f32 v180, v180, v226
 v_mul_f32 v181, v181, v226
 v_mul_f32 v182, v182, v226
 v_mul_f32 v183, v183, v226
 v_cvt_pk_bf16_f32 v144, v176, v177
 v_cvt_pk_bf16_f32 v145, v178, v179
 v_cvt_pk_bf16_f32 v146, v180, v181
 v_cvt_pk_bf16_f32 v147, v182, v183
 v_accvgpr_write_b32 a112, v144
 v_accvgpr_write_b32 a113, v145
 v_accvgpr_write_b32 a114, v146
 v_accvgpr_write_b32 a115, v147
 v_accvgpr_read_b32 v176, a232
 v_accvgpr_read_b32 v177, a233
 v_accvgpr_read_b32 v178, a234
 v_accvgpr_read_b32 v179, a235
 v_accvgpr_read_b32 v180, a236
 v_accvgpr_read_b32 v181, a237
 v_accvgpr_read_b32 v182, a238
 v_accvgpr_read_b32 v183, a239
 v_mul_f32 v176, v176, v226
 v_mul_f32 v177, v177, v226
 v_mul_f32 v178, v178, v226
 v_mul_f32 v179, v179, v226
 v_mul_f32 v180, v180, v226
 v_mul_f32 v181, v181, v226
 v_mul_f32 v182, v182, v226
 v_mul_f32 v183, v183, v226
 v_cvt_pk_bf16_f32 v148, v176, v177
 v_cvt_pk_bf16_f32 v149, v178, v179
 v_cvt_pk_bf16_f32 v150, v180, v181
 v_cvt_pk_bf16_f32 v151, v182, v183
 v_accvgpr_write_b32 a116, v148
 v_accvgpr_write_b32 a117, v149
 v_accvgpr_write_b32 a118, v150
 v_accvgpr_write_b32 a119, v151
 v_accvgpr_read_b32 v176, a240
 v_accvgpr_read_b32 v177, a241
 v_accvgpr_read_b32 v178, a242
 v_accvgpr_read_b32 v179, a243
 v_accvgpr_read_b32 v180, a244
 v_accvgpr_read_b32 v181, a245
 v_accvgpr_read_b32 v182, a246
 v_accvgpr_read_b32 v183, a247
 v_mul_f32 v176, v176, v226
 v_mul_f32 v177, v177, v226
 v_mul_f32 v178, v178, v226
 v_mul_f32 v179, v179, v226
 v_mul_f32 v180, v180, v226
 v_mul_f32 v181, v181, v226
 v_mul_f32 v182, v182, v226
 v_mul_f32 v183, v183, v226
 v_cvt_pk_bf16_f32 v152, v176, v177
 v_cvt_pk_bf16_f32 v153, v178, v179
 v_cvt_pk_bf16_f32 v154, v180, v181
 v_cvt_pk_bf16_f32 v155, v182, v183
 v_accvgpr_write_b32 a120, v152
 v_accvgpr_write_b32 a121, v153
 v_accvgpr_write_b32 a122, v154
 v_accvgpr_write_b32 a123, v155
 v_accvgpr_read_b32 v176, a248
 v_accvgpr_read_b32 v177, a249
 v_accvgpr_read_b32 v178, a250
 v_accvgpr_read_b32 v179, a251
 v_accvgpr_read_b32 v180, a252
 v_accvgpr_read_b32 v181, a253
 v_accvgpr_read_b32 v182, a254
 v_accvgpr_read_b32 v183, a255
 v_mul_f32 v176, v176, v226
 v_mul_f32 v177, v177, v226
 v_mul_f32 v178, v178, v226
 v_mul_f32 v179, v179, v226
 v_mul_f32 v180, v180, v226
 v_mul_f32 v181, v181, v226
 v_mul_f32 v182, v182, v226
 v_mul_f32 v183, v183, v226
 v_cvt_pk_bf16_f32 v156, v176, v177
 v_cvt_pk_bf16_f32 v157, v178, v179
 v_cvt_pk_bf16_f32 v158, v180, v181
 v_cvt_pk_bf16_f32 v159, v182, v183
 v_accvgpr_write_b32 a124, v156
 v_accvgpr_write_b32 a125, v157
 v_accvgpr_write_b32 a126, v158
 v_accvgpr_write_b32 a127, v159
 s_waitcnt vmcnt(24) lgkmcnt(0)
 s_barrier
 ds_read_b128 v[112:115], v208 offset:0
 ds_read_b128 v[116:119], v209 offset:0
 ds_read_b128 v[120:123], v210 offset:0
 ds_read_b128 v[124:127], v211 offset:0
 ds_read_b128 v[128:131], v208 offset:128
 ds_read_b128 v[132:135], v209 offset:128
 ds_read_b128 v[136:139], v210 offset:128
 ds_read_b128 v[140:143], v211 offset:128
 ds_read_b128 v[144:147], v208 offset:256
 ds_read_b128 v[148:151], v209 offset:256
 ds_read_b128 v[152:155], v210 offset:256
 ds_read_b128 v[156:159], v211 offset:256
 s_add_u32 m0, s25, s40
 s_nop 0
 buffer_load_dwordx4 v217, s[12:15], s28 offen offset:0 nt lds
 buffer_load_dwordx4 v218, s[12:15], s28 offen offset:1024 nt lds
 buffer_load_dwordx4 v219, s[12:15], s28 offen offset:2048 nt lds
 s_add_u32 s28, s28, 12288
 v_mbcnt_lo_u32_b32 v229, -1, 0
 v_mbcnt_hi_u32_b32 v229, -1, v229
 s_lshl_b32 s37, s7, 12
 s_add_u32 s37, s37, 147456
 v_lshlrev_b32 v229, 4, v229
 v_add_u32 v229, s37, v229
 ds_read_b128 v[16:19], v229 offset:0
 ds_read_b128 v[20:23], v229 offset:1024
 ds_read_b128 v[24:27], v229 offset:2048
 ds_read_b128 v[28:31], v229 offset:3072
 v_mov_b32 v32, v201
 v_mov_b32 v33, v202
 v_mov_b32 v34, v203
 v_mov_b32 v35, v205
 v_mov_b32 v36, v207
 v_mov_b32 v37, v221
 v_mov_b32 v38, v222
 v_mov_b32 v39, v231
 v_mov_b32 v40, v232
 v_mov_b32 v41, v233
 v_mov_b32 v42, v234
 v_mov_b32 v43, v235
 v_mov_b32 v44, v236
 v_mov_b32 v45, v237
 v_mov_b32 v46, v238
 v_mov_b32 v47, v239
 v_mov_b32 v48, v0
 v_mov_b32 v49, v1
 v_mov_b32 v50, v2
 v_mov_b32 v51, v3
 v_mov_b32 v52, v4
 v_mov_b32 v53, v5
 v_mov_b32 v54, v6
 v_mov_b32 v55, v7
 v_mov_b32 v56, v240
 v_mov_b32 v57, v241
 v_mov_b32 v58, v242
 v_mov_b32 v59, v243
 v_mov_b32 v60, v244
 v_mov_b32 v61, v245
 v_mov_b32 v62, v246
 v_mov_b32 v63, v247
 s_waitcnt lgkmcnt(0)
 v_mfma_f32_32x32x16_bf16 v[160:175], v[112:115], v[16:19], 0
 ds_read_b128 v[64:67], v208 offset:12288
 ds_read_b128 v[68:71], v209 offset:12288
 v_mfma_f32_32x32x16_bf16 v[160:175], v[116:119], v[20:23], v[160:175]
 ds_read_b128 v[72:75], v210 offset:12288
 v_mfma_f32_32x32x16_bf16 v[160:175], v[120:123], v[24:27], v[160:175]
 ds_read_b128 v[76:79], v211 offset:12288
 ds_read_b128 v[80:83], v208 offset:12416
 s_add_u32 m0, s25, s41
 s_nop 0
 buffer_load_dwordx4 v214, s[8:11], s27 offen offset:0 nt lds
 v_mfma_f32_32x32x16_bf16 v[160:175], v[124:127], v[28:31], v[160:175]
 ds_read_b128 v[84:87], v209 offset:12416
 v_mfma_f32_32x32x16_bf16 v[160:175], v[128:131], v[32:35], v[160:175]
 ds_read_b128 v[88:91], v210 offset:12416
 ds_read_b128 v[92:95], v211 offset:12416
 buffer_load_dwordx4 v215, s[8:11], s27 offen offset:1024 nt lds
 v_mfma_f32_32x32x16_bf16 v[160:175], v[132:135], v[36:39], v[160:175]
 ds_read_b128 v[96:99], v208 offset:12544
 v_mfma_f32_32x32x16_bf16 v[160:175], v[136:139], v[40:43], v[160:175]
 ds_read_b128 v[100:103], v209 offset:12544
 ds_read_b128 v[104:107], v210 offset:12544
 buffer_load_dwordx4 v216, s[8:11], s27 offen offset:2048 nt lds
 s_add_u32 s27, s27, 12288
 v_mfma_f32_32x32x16_bf16 v[160:175], v[140:143], v[44:47], v[160:175]
 ds_read_b128 v[108:111], v211 offset:12544
 v_mfma_f32_32x32x16_bf16 v[160:175], v[144:147], v[48:51], v[160:175]
 v_mov_b32 v226, 0
 v_mov_b32 v227, 0
 v_mfma_f32_32x32x16_bf16 v[160:175], v[148:151], v[52:55], v[160:175]
 s_mov_b32 s25, s24
 s_add_u32 s24, s24, 24576
 v_mfma_f32_32x32x16_bf16 v[160:175], v[152:155], v[56:59], v[160:175]
 s_cmp_eq_u32 s24, 147456
 s_cselect_b32 s24, 0, s24
 v_mfma_f32_32x32x16_bf16 v[160:175], v[156:159], v[60:63], v[160:175]
 v_add_u32 v212, s24, v204
 v_xor_b32 v213, 64, v212
 s_nop 7
 s_nop 7
 v_max3_f32 v228, v160, v161, v162
 v_max3_f32 v228, v228, v163, v164
 v_max3_f32 v228, v228, v165, v166
 v_max3_f32 v228, v228, v167, v168
 v_max3_f32 v228, v228, v169, v170
 v_max3_f32 v228, v228, v171, v172
 v_max3_f32 v228, v228, v173, v174
 v_max_f32 v228, v228, v175
 v_mov_b32 v229, v228
 s_nop 1
 v_permlane32_swap_b32 v229, v228
 s_nop 1
 v_max_f32 v223, v229, v228
 v_mul_f32 v224, s32, v223
 v_add_f32 v225, s36, v223
 v_fma_f32 v176, v160, s32, -v224
 v_fma_f32 v177, v161, s32, -v224
 v_fma_f32 v178, v162, s32, -v224
 v_fma_f32 v179, v163, s32, -v224
 v_fma_f32 v180, v164, s32, -v224
 v_fma_f32 v181, v165, s32, -v224
 v_fma_f32 v182, v166, s32, -v224
 v_fma_f32 v183, v167, s32, -v224
 v_fma_f32 v184, v168, s32, -v224
 v_fma_f32 v185, v169, s32, -v224
 v_fma_f32 v186, v170, s32, -v224
 v_fma_f32 v187, v171, s32, -v224
 v_fma_f32 v188, v172, s32, -v224
 v_fma_f32 v189, v173, s32, -v224
 v_fma_f32 v190, v174, s32, -v224
 v_fma_f32 v191, v175, s32, -v224
 v_mov_b32 v1, s7
 v_mbcnt_lo_u32_b32 v2, -1, 0
 v_mbcnt_hi_u32_b32 v2, -1, v2
 v_add_u32 v3, 0, v2
 v_mul_u32_u24 v4, 205, v3
 v_lshrrev_b32 v4, 12, v4
 v_mul_u32_u24 v5, 20, v4
 v_sub_u32 v5, v3, v5
 v_lshl_add_u32 v4, v1, 4, v4
 v_mul_u32_u24 v4, 1280, v4
 v_lshl_add_u32 v4, v5, 4, v4
 v_subrev_u32 v232, 0, v4
 v_add_u32 v3, 64, v2
 v_mul_u32_u24 v4, 205, v3
 v_lshrrev_b32 v4, 12, v4
 v_mul_u32_u24 v5, 20, v4
 v_sub_u32 v5, v3, v5
 v_lshl_add_u32 v4, v1, 4, v4
 v_mul_u32_u24 v4, 1280, v4
 v_lshl_add_u32 v4, v5, 4, v4
 v_subrev_u32 v233, 1024, v4
 v_add_u32 v3, 128, v2
 v_mul_u32_u24 v4, 205, v3
 v_lshrrev_b32 v4, 12, v4
 v_mul_u32_u24 v5, 20, v4
 v_sub_u32 v5, v3, v5
 v_lshl_add_u32 v4, v1, 4, v4
 v_mul_u32_u24 v4, 1280, v4
 v_lshl_add_u32 v4, v5, 4, v4
 v_subrev_u32 v234, 2048, v4
 v_add_u32 v3, 192, v2
 v_mul_u32_u24 v4, 205, v3
 v_lshrrev_b32 v4, 12, v4
 v_mul_u32_u24 v5, 20, v4
 v_sub_u32 v5, v3, v5
 v_lshl_add_u32 v4, v1, 4, v4
 v_mul_u32_u24 v4, 1280, v4
 v_lshl_add_u32 v4, v5, 4, v4
 v_subrev_u32 v235, 3072, v4
 v_add_u32 v3, 256, v2
 v_mul_u32_u24 v4, 205, v3
 v_lshrrev_b32 v4, 12, v4
 v_mul_u32_u24 v5, 20, v4
 v_sub_u32 v5, v3, v5
 v_lshl_add_u32 v4, v1, 4, v4
 v_mul_u32_u24 v4, 1280, v4
 v_lshl_add_u32 v4, v5, 4, v4
 v_subrev_u32 v236, 0, v4
 v_lshrrev_b32 v6, 5, v2
 v_bfe_u32 v8, v2, 2, 2
 v_bfe_u32 v9, v2, 4, 1
 v_lshlrev_b32 v9, 5, v9
 v_and_b32 v10, 1, v2
 v_lshl_add_u32 v9, v10, 4, v9
 v_bfe_u32 v10, v2, 1, 1
 v_lshl_add_u32 v9, v10, 3, v9
 v_lshl_add_u32 v10, v6, 3, v8
 v_mul_u32_u24 v10, 320, v10
 v_add_u32 v237, v10, v9
 v_lshlrev_b32 v231, 4, v2
 s_mul_i32 s37, s7, 10240
 v_add_u32 v231, s37, v231
 s_lshl_b32 s37, s47, 3
 v_mov_b32 v238, s37
 s_mul_i32 s37, s4, 61440
 s_mul_i32 s39, s7, 15360
 s_add_u32 s37, s37, s39
 v_lshlrev_b32 v8, 6, v2
 v_add_u32 v11, s37, v8
 s_waitcnt vmcnt(24) lgkmcnt(0)
 s_barrier
 v_mfma_f32_32x32x16_bf16 v[160:175], v[64:67], v[16:19], 0
 ds_read_b64_tr_b16 v[112:113], v212 offset:0
 ds_read_b64_tr_b16 v[114:115], v212 offset:3072
 ds_read_b64_tr_b16 v[116:117], v213 offset:0
 v_exp_f32 v176, v176
 v_exp_f32 v177, v177
 v_exp_f32 v178, v178
 v_mfma_f32_32x32x16_bf16 v[160:175], v[68:71], v[20:23], v[160:175]
 ds_read_b64_tr_b16 v[118:119], v213 offset:3072
 ds_read_b64_tr_b16 v[120:121], v212 offset:128
 v_exp_f32 v179, v179
 v_add_f32 v226, v226, v176
 v_mfma_f32_32x32x16_bf16 v[160:175], v[72:75], v[24:27], v[160:175]
 ds_read_b64_tr_b16 v[122:123], v212 offset:3200
 ds_read_b64_tr_b16 v[124:125], v213 offset:128
 v_add_f32 v227, v227, v177
 v_cvt_pk_bf16_f32 v192, v176, v177
 v_exp_f32 v180, v180
 v_mfma_f32_32x32x16_bf16 v[160:175], v[76:79], v[28:31], v[160:175]
 ds_read_b64_tr_b16 v[126:127], v213 offset:3200
 ds_read_b64_tr_b16 v[128:129], v212 offset:256
 v_exp_f32 v181, v181
 v_add_f32 v226, v226, v178
 v_mfma_f32_32x32x16_bf16 v[160:175], v[80:83], v[32:35], v[160:175]
 ds_read_b64_tr_b16 v[130:131], v212 offset:3328
 ds_read_b64_tr_b16 v[132:133], v213 offset:256
 v_add_f32 v227, v227, v179
 v_cvt_pk_bf16_f32 v193, v178, v179
 v_exp_f32 v182, v182
 v_mfma_f32_32x32x16_bf16 v[160:175], v[84:87], v[36:39], v[160:175]
 ds_read_b64_tr_b16 v[134:135], v213 offset:3328
 ds_read_b64_tr_b16 v[136:137], v212 offset:6144
 ds_read_b64_tr_b16 v[138:139], v212 offset:9216
 v_exp_f32 v183, v183
 v_add_f32 v226, v226, v180
 v_mfma_f32_32x32x16_bf16 v[160:175], v[88:91], v[40:43], v[160:175]
 ds_read_b64_tr_b16 v[140:141], v213 offset:6144
 ds_read_b64_tr_b16 v[142:143], v213 offset:9216
 v_add_f32 v227, v227, v181
 v_cvt_pk_bf16_f32 v194, v180, v181
 v_exp_f32 v184, v184
 v_mfma_f32_32x32x16_bf16 v[160:175], v[92:95], v[44:47], v[160:175]
 ds_read_b64_tr_b16 v[144:145], v212 offset:6272
 ds_read_b64_tr_b16 v[146:147], v212 offset:9344
 v_exp_f32 v185, v185
 v_add_f32 v226, v226, v182
 v_mfma_f32_32x32x16_bf16 v[160:175], v[96:99], v[48:51], v[160:175]
 ds_read_b64_tr_b16 v[148:149], v213 offset:6272
 ds_read_b64_tr_b16 v[150:151], v213 offset:9344
 v_add_f32 v227, v227, v183
 v_cvt_pk_bf16_f32 v195, v182, v183
 v_exp_f32 v186, v186
 v_mfma_f32_32x32x16_bf16 v[160:175], v[100:103], v[52:55], v[160:175]
 ds_read_b64_tr_b16 v[152:153], v212 offset:6400
 ds_read_b64_tr_b16 v[154:155], v212 offset:9472
 v_exp_f32 v187, v187
 v_add_f32 v226, v226, v184
 v_mfma_f32_32x32x16_bf16 v[160:175], v[104:107], v[56:59], v[160:175]
 ds_read_b64_tr_b16 v[156:157], v213 offset:6400
 ds_read_b64_tr_b16 v[158:159], v213 offset:9472
 v_add_f32 v227, v227, v185
 v_cvt_pk_bf16_f32 v196, v184, v185
 v_exp_f32 v188, v188
 v_mfma_f32_32x32x16_bf16 v[160:175], v[108:111], v[60:63], v[160:175]
 v_exp_f32 v189, v189
 v_add_f32 v226, v226, v186
 v_add_u32 v208, s24, v200
 v_xor_b32 v209, 32, v208
 v_xor_b32 v210, 64, v208
 v_xor_b32 v211, 96, v208
 s_waitcnt lgkmcnt(6)
 v_mfma_f32_32x32x16_bf16 a[160:175], v[112:115], v[192:195], 0
 v_add_f32 v227, v227, v187
 v_cvt_pk_bf16_f32 v197, v186, v187
 v_exp_f32 v190, v190
 v_exp_f32 v191, v191
 ds_read_b128 v[64:67], v208 offset:12288
 ds_read_b128 v[68:71], v209 offset:12288
 s_add_u32 m0, s25, s40
 s_nop 0
 buffer_load_dwordx4 v217, s[12:15], s28 offen offset:0 nt lds
 v_mfma_f32_32x32x16_bf16 a[176:191], v[116:119], v[192:195], 0
 v_add_f32 v226, v226, v188
 v_add_f32 v227, v227, v189
 v_cvt_pk_bf16_f32 v198, v188, v189
 ds_read_b128 v[72:75], v210 offset:12288
 buffer_load_dwordx4 v218, s[12:15], s28 offen offset:1024 nt lds
 v_mfma_f32_32x32x16_bf16 a[192:207], v[120:123], v[192:195], 0
 v_add_f32 v226, v226, v190
 v_add_f32 v227, v227, v191
 v_cvt_pk_bf16_f32 v199, v190, v191
 ds_read_b128 v[76:79], v211 offset:12288
 ds_read_b128 v[80:83], v208 offset:12416
 v_mfma_f32_32x32x16_bf16 a[208:223], v[124:127], v[192:195], 0
 ds_read_b128 v[84:87], v209 offset:12416
 v_max3_f32 v228, v160, v161, v162
 v_max3_f32 v228, v228, v163, v164
 v_max3_f32 v228, v228, v165, v166
 buffer_load_dwordx4 v219, s[12:15], s28 offen offset:2048 nt lds
 s_add_u32 s28, s28, 12288
 v_mfma_f32_32x32x16_bf16 a[224:239], v[128:131], v[192:195], 0
 ds_read_b128 v[88:91], v210 offset:12416
 ds_read_b128 v[92:95], v211 offset:12416
 v_max3_f32 v228, v228, v167, v168
 v_max3_f32 v228, v228, v169, v170
 v_max3_f32 v228, v228, v171, v172
 v_mfma_f32_32x32x16_bf16 a[240:255], v[132:135], v[192:195], 0
 ds_read_b128 v[96:99], v208 offset:12544
 v_max3_f32 v228, v228, v173, v174
 v_max_f32 v228, v228, v175
 v_cmp_gt_f32 vcc, v228, v225
 s_add_u32 m0, s25, s41
 s_nop 0
 buffer_load_dwordx4 v214, s[8:11], s27 offen offset:0 nt lds
 s_waitcnt lgkmcnt(9)
 v_mfma_f32_32x32x16_bf16 a[160:175], v[136:139], v[196:199], a[160:175]
 ds_read_b128 v[100:103], v209 offset:12544
 ds_read_b128 v[104:107], v210 offset:12544
 v_fma_f32 v176, v160, s32, -v224
 v_fma_f32 v177, v161, s32, -v224
 v_fma_f32 v178, v162, s32, -v224
 v_fma_f32 v179, v163, s32, -v224
 v_mfma_f32_32x32x16_bf16 a[176:191], v[140:143], v[196:199], a[176:191]
 ds_read_b128 v[108:111], v211 offset:12544
 v_fma_f32 v180, v164, s32, -v224
 v_fma_f32 v181, v165, s32, -v224
 v_fma_f32 v182, v166, s32, -v224
 buffer_load_dwordx4 v215, s[8:11], s27 offen offset:1024 nt lds
 v_mfma_f32_32x32x16_bf16 a[192:207], v[144:147], v[196:199], a[192:207]
 v_fma_f32 v183, v167, s32, -v224
 v_fma_f32 v184, v168, s32, -v224
 v_fma_f32 v185, v169, s32, -v224
 v_mfma_f32_32x32x16_bf16 a[208:223], v[148:151], v[196:199], a[208:223]
 v_fma_f32 v186, v170, s32, -v224
 v_fma_f32 v187, v171, s32, -v224
 v_fma_f32 v188, v172, s32, -v224
 buffer_load_dwordx4 v216, s[8:11], s27 offen offset:2048 nt lds
 s_add_u32 s27, s27, 12288
 v_mfma_f32_32x32x16_bf16 a[224:239], v[152:155], v[196:199], a[224:239]
 v_fma_f32 v189, v173, s32, -v224
 v_fma_f32 v190, v174, s32, -v224
 v_fma_f32 v191, v175, s32, -v224
 v_mfma_f32_32x32x16_bf16 a[240:255], v[156:159], v[196:199], a[240:255]
 s_mov_b32 s25, s24
 s_add_u32 s24, s24, 24576
 s_cmp_eq_u32 s24, 147456
 s_cselect_b32 s24, 0, s24
 v_add_u32 v212, s24, v204
 v_xor_b32 v213, 64, v212
 s_cbranch_vccz L_skip32
 s_call_b64 s[30:31], L_rescale
L_skip32:
 s_waitcnt vmcnt(24)
 s_call_b64 s[72:73], L_sub0
 s_waitcnt vmcnt(24)
 s_call_b64 s[72:73], L_sub0
 s_waitcnt vmcnt(24)
 s_call_b64 s[72:73], L_sub0
 s_waitcnt vmcnt(24)
 s_call_b64 s[72:73], L_sub0
 s_mov_b32 s43, 0
 s_waitcnt vmcnt(24)
 s_call_b64 s[72:73], L_sub62
 s_waitcnt vmcnt(23)
 s_call_b64 s[72:73], L_sub0
 s_waitcnt vmcnt(23)
 s_call_b64 s[72:73], L_sub0
 s_waitcnt vmcnt(23)
 s_call_b64 s[72:73], L_sub0
 s_waitcnt vmcnt(23)
 s_call_b64 s[72:73], L_sub0
 v_add_u32 v212, s24, v237
 s_waitcnt vmcnt(24) lgkmcnt(0)
 s_barrier
 ds_read_b64_tr_b16 v[112:113], v212 offset:0
 ds_read_b64_tr_b16 v[114:115], v212 offset:1280
 ds_read_b64_tr_b16 v[116:117], v212 offset:64
 ds_read_b64_tr_b16 v[118:119], v212 offset:1344
 ds_read_b64_tr_b16 v[120:121], v212 offset:128
 ds_read_b64_tr_b16 v[122:123], v212 offset:1408
 ds_read_b64_tr_b16 v[124:125], v212 offset:192
 ds_read_b64_tr_b16 v[126:127], v212 offset:1472
 ds_read_b64_tr_b16 v[128:129], v212 offset:256
 ds_read_b64_tr_b16 v[130:131], v212 offset:1536
 ds_read_b64_tr_b16 v[132:133], v212 offset:5120
 ds_read_b64_tr_b16 v[134:135], v212 offset:6400
 ds_read_b64_tr_b16 v[136:137], v212 offset:5184
 ds_read_b64_tr_b16 v[138:139], v212 offset:6464
 v_exp_f32 v176, v176
 v_exp_f32 v177, v177
 v_exp_f32 v178, v178
 v_exp_f32 v179, v179
 v_add_f32 v226, v226, v176
 v_add_f32 v227, v227, v177
 v_cvt_pk_bf16_f32 v192, v176, v177
 s_waitcnt lgkmcnt(6)
 v_mfma_f32_32x32x16_bf16 a[0:15], v[112:115], a[80:83], 0
 ds_read_b64_tr_b16 v[140:141], v212 offset:5248
 ds_read_b64_tr_b16 v[142:143], v212 offset:6528
 v_exp_f32 v180, v180
 v_exp_f32 v181, v181
 v_add_f32 v226, v226, v178
 v_mfma_f32_32x32x16_bf16 a[16:31], v[116:119], a[80:83], 0
 ds_read_b64_tr_b16 v[144:145], v212 offset:5312
 ds_read_b64_tr_b16 v[146:147], v212 offset:6592
 v_add_f32 v227, v227, v179
 v_cvt_pk_bf16_f32 v193, v178, v179
 v_mfma_f32_32x32x16_bf16 a[32:47], v[120:123], a[80:83], 0
 ds_read_b64_tr_b16 v[148:149], v212 offset:5376
 ds_read_b64_tr_b16 v[150:151], v212 offset:6656
 v_exp_f32 v182, v182
 v_exp_f32 v183, v183
 s_add_u32 m0, s25, s40
 s_nop 0
 buffer_load_dwordx4 v217, s[12:15], s28 offen offset:0 nt lds
 v_mfma_f32_32x32x16_bf16 a[48:63], v[124:127], a[80:83], 0
 ds_read_b64_tr_b16 v[152:153], v212 offset:10240
 ds_read_b64_tr_b16 v[154:155], v212 offset:11520
 v_add_f32 v226, v226, v180
 v_add_f32 v227, v227, v181
 s_waitcnt lgkmcnt(6)
 v_mfma_f32_32x32x16_bf16 a[64:79], v[128:131], a[80:83], 0
 ds_read_b64_tr_b16 v[156:157], v212 offset:10304
 ds_read_b64_tr_b16 v[158:159], v212 offset:11584
 v_cvt_pk_bf16_f32 v194, v180, v181
 v_exp_f32 v184, v184
 buffer_load_dwordx4 v218, s[12:15], s28 offen offset:1024 nt lds
 v_mfma_f32_32x32x16_bf16 a[0:15], v[132:135], a[84:87], a[0:15]
 ds_read_b64_tr_b16 v[160:161], v212 offset:10368
 ds_read_b64_tr_b16 v[162:163], v212 offset:11648
 v_exp_f32 v185, v185
 v_add_f32 v226, v226, v182
 v_add_f32 v227, v227, v183
 v_mfma_f32_32x32x16_bf16 a[16:31], v[136:139], a[84:87], a[16:31]
 ds_read_b64_tr_b16 v[164:165], v212 offset:10432
 ds_read_b64_tr_b16 v[166:167], v212 offset:11712
 v_cvt_pk_bf16_f32 v195, v182, v183
 v_exp_f32 v186, v186
 v_mfma_f32_32x32x16_bf16 a[32:47], v[140:143], a[84:87], a[32:47]
 ds_read_b64_tr_b16 v[168:169], v212 offset:10496
 ds_read_b64_tr_b16 v[170:171], v212 offset:11776
 v_exp_f32 v187, v187
 v_add_f32 v226, v226, v184
 buffer_load_dwordx4 v219, s[12:15], s28 offen offset:2048 nt lds
 s_add_u32 s28, s28, 12288
 s_waitcnt lgkmcnt(6)
 v_mfma_f32_32x32x16_bf16 a[48:63], v[144:147], a[84:87], a[48:63]
 ds_read_b64_tr_b16 v[172:173], v212 offset:15360
 ds_read_b64_tr_b16 v[174:175], v212 offset:16640
 v_add_f32 v227, v227, v185
 v_cvt_pk_bf16_f32 v196, v184, v185
 v_mfma_f32_32x32x16_bf16 a[64:79], v[148:151], a[84:87], a[64:79]
 ds_read_b64_tr_b16 v[112:113], v212 offset:15424
 ds_read_b64_tr_b16 v[114:115], v212 offset:16704
 v_exp_f32 v188, v188
 v_exp_f32 v189, v189
 v_mfma_f32_32x32x16_bf16 a[0:15], v[152:155], a[88:91], a[0:15]
 ds_read_b64_tr_b16 v[116:117], v212 offset:15488
 ds_read_b64_tr_b16 v[118:119], v212 offset:16768
 v_add_f32 v226, v226, v186
 v_add_f32 v227, v227, v187
 v_cvt_pk_bf16_f32 v197, v186, v187
 s_add_u32 m0, s25, s41
 s_nop 0
 buffer_load_dwordx4 v214, s[8:11], s27 offen offset:0 nt lds
 v_mfma_f32_32x32x16_bf16 a[16:31], v[156:159], a[88:91], a[16:31]
 ds_read_b64_tr_b16 v[120:121], v212 offset:15552
 ds_read_b64_tr_b16 v[122:123], v212 offset:16832
 v_exp_f32 v190, v190
 v_exp_f32 v191, v191
 s_waitcnt lgkmcnt(6)
 v_mfma_f32_32x32x16_bf16 a[32:47], v[160:163], a[88:91], a[32:47]
 ds_read_b64_tr_b16 v[124:125], v212 offset:15616
 ds_read_b64_tr_b16 v[126:127], v212 offset:16896
 v_add_f32 v226, v226, v188
 v_add_f32 v227, v227, v189
 buffer_load_dwordx4 v215, s[8:11], s27 offen offset:1024 nt lds
 v_mfma_f32_32x32x16_bf16 a[48:63], v[164:167], a[88:91], a[48:63]
 v_cvt_pk_bf16_f32 v198, v188, v189
 v_add_f32 v226, v226, v190
 v_mfma_f32_32x32x16_bf16 a[64:79], v[168:171], a[88:91], a[64:79]
 v_add_f32 v227, v227, v191
 v_cvt_pk_bf16_f32 v199, v190, v191
 v_mfma_f32_32x32x16_bf16 a[0:15], v[172:175], a[92:95], a[0:15]
 buffer_load_dwordx4 v216, s[8:11], s27 offen offset:2048 nt lds
 s_add_u32 s27, s27, 12288
 s_waitcnt lgkmcnt(0)
 v_mfma_f32_32x32x16_bf16 a[16:31], v[112:115], a[92:95], a[16:31]
 v_mfma_f32_32x32x16_bf16 a[32:47], v[116:119], a[92:95], a[32:47]
 v_mfma_f32_32x32x16_bf16 a[48:63], v[120:123], a[92:95], a[48:63]
 v_mfma_f32_32x32x16_bf16 a[64:79], v[124:127], a[92:95], a[64:79]
 s_mov_b32 s25, s24
 s_add_u32 s24, s24, 24576
 s_cmp_eq_u32 s24, 147456
 s_cselect_b32 s24, 0, s24
 v_add_u32 v212, s24, v204
 v_xor_b32 v213, 64, v212
 s_waitcnt vmcnt(24)
 s_call_b64 s[72:73], L_sub55
 s_mov_b32 s43, 81920
 s_waitcnt vmcnt(24)
 s_call_b64 s[72:73], L_sub62
 s_waitcnt vmcnt(23)
 s_call_b64 s[72:73], L_sub0
 s_waitcnt vmcnt(23)
 s_call_b64 s[72:73], L_sub0
 s_waitcnt vmcnt(23)
 s_call_b64 s[72:73], L_sub0
 s_waitcnt vmcnt(23)
 s_call_b64 s[72:73], L_sub0
 v_add_u32 v212, s24, v237
 s_waitcnt vmcnt(24) lgkmcnt(0)
 s_barrier
 ds_read_b64_tr_b16 v[112:113], v212 offset:0
 ds_read_b64_tr_b16 v[114:115], v212 offset:1280
 ds_read_b64_tr_b16 v[116:117], v212 offset:64
 ds_read_b64_tr_b16 v[118:119], v212 offset:1344
 ds_read_b64_tr_b16 v[120:121], v212 offset:128
 ds_read_b64_tr_b16 v[122:123], v212 offset:1408
 ds_read_b64_tr_b16 v[124:125], v212 offset:192
 ds_read_b64_tr_b16 v[126:127], v212 offset:1472
 ds_read_b64_tr_b16 v[128:129], v212 offset:256
 ds_read_b64_tr_b16 v[130:131], v212 offset:1536
 ds_read_b64_tr_b16 v[132:133], v212 offset:5120
 ds_read_b64_tr_b16 v[134:135], v212 offset:6400
 ds_read_b64_tr_b16 v[136:137], v212 offset:5184
 ds_read_b64_tr_b16 v[138:139], v212 offset:6464
 v_exp_f32 v176, v176
 v_exp_f32 v177, v177
 v_exp_f32 v178, v178
 v_exp_f32 v179, v179
 v_add_f32 v226, v226, v176
 v_add_f32 v227, v227, v177
 v_cvt_pk_bf16_f32 v192, v176, v177
 s_waitcnt lgkmcnt(6)
 v_mfma_f32_32x32x16_bf16 a[0:15], v[112:115], a[96:99], a[0:15]
 ds_read_b64_tr_b16 v[140:141], v212 offset:5248
 ds_read_b64_tr_b16 v[142:143], v212 offset:6528
 v_exp_f32 v180, v180
 v_exp_f32 v181, v181
 v_add_f32 v226, v226, v178
 v_mfma_f32_32x32x16_bf16 a[16:31], v[116:119], a[96:99], a[16:31]
 ds_read_b64_tr_b16 v[144:145], v212 offset:5312
 ds_read_b64_tr_b16 v[146:147], v212 offset:6592
 v_add_f32 v227, v227, v179
 v_cvt_pk_bf16_f32 v193, v178, v179
 v_mfma_f32_32x32x16_bf16 a[32:47], v[120:123], a[96:99], a[32:47]
 ds_read_b64_tr_b16 v[148:149], v212 offset:5376
 ds_read_b64_tr_b16 v[150:151], v212 offset:6656
 v_exp_f32 v182, v182
 v_exp_f32 v183, v183
 s_add_u32 m0, s25, s40
 s_nop 0
 buffer_load_dwordx4 v217, s[12:15], s28 offen offset:0 nt lds
 v_mfma_f32_32x32x16_bf16 a[48:63], v[124:127], a[96:99], a[48:63]
 ds_read_b64_tr_b16 v[152:153], v212 offset:10240
 ds_read_b64_tr_b16 v[154:155], v212 offset:11520
 v_add_f32 v226, v226, v180
 v_add_f32 v227, v227, v181
 s_waitcnt lgkmcnt(6)
 v_mfma_f32_32x32x16_bf16 a[64:79], v[128:131], a[96:99], a[64:79]
 ds_read_b64_tr_b16 v[156:157], v212 offset:10304
 ds_read_b64_tr_b16 v[158:159], v212 offset:11584
 v_cvt_pk_bf16_f32 v194, v180, v181
 v_exp_f32 v184, v184
 buffer_load_dwordx4 v218, s[12:15], s28 offen offset:1024 nt lds
 v_mfma_f32_32x32x16_bf16 a[0:15], v[132:135], a[100:103], a[0:15]
 ds_read_b64_tr_b16 v[160:161], v212 offset:10368
 ds_read_b64_tr_b16 v[162:163], v212 offset:11648
 v_exp_f32 v185, v185
 v_add_f32 v226, v226, v182
 v_add_f32 v227, v227, v183
 v_mfma_f32_32x32x16_bf16 a[16:31], v[136:139], a[100:103], a[16:31]
 ds_read_b64_tr_b16 v[164:165], v212 offset:10432
 ds_read_b64_tr_b16 v[166:167], v212 offset:11712
 v_cvt_pk_bf16_f32 v195, v182, v183
 v_exp_f32 v186, v186
 v_mfma_f32_32x32x16_bf16 a[32:47], v[140:143], a[100:103], a[32:47]
 ds_read_b64_tr_b16 v[168:169], v212 offset:10496
 ds_read_b64_tr_b16 v[170:171], v212 offset:11776
 v_exp_f32 v187, v187
 v_add_f32 v226, v226, v184
 buffer_load_dwordx4 v219, s[12:15], s28 offen offset:2048 nt lds
 s_add_u32 s28, s28, 12288
 s_waitcnt lgkmcnt(6)
 v_mfma_f32_32x32x16_bf16 a[48:63], v[144:147], a[100:103], a[48:63]
 ds_read_b64_tr_b16 v[172:173], v212 offset:15360
 ds_read_b64_tr_b16 v[174:175], v212 offset:16640
 v_add_f32 v227, v227, v185
 v_cvt_pk_bf16_f32 v196, v184, v185
 v_mfma_f32_32x32x16_bf16 a[64:79], v[148:151], a[100:103], a[64:79]
 ds_read_b64_tr_b16 v[112:113], v212 offset:15424
 ds_read_b64_tr_b16 v[114:115], v212 offset:16704
 v_exp_f32 v188, v188
 v_exp_f32 v189, v189
 v_mfma_f32_32x32x16_bf16 a[0:15], v[152:155], a[104:107], a[0:15]
 ds_read_b64_tr_b16 v[116:117], v212 offset:15488
 ds_read_b64_tr_b16 v[118:119], v212 offset:16768
 v_add_f32 v226, v226, v186
 v_add_f32 v227, v227, v187
 v_cvt_pk_bf16_f32 v197, v186, v187
 s_add_u32 m0, s25, s41
 s_nop 0
 buffer_load_dwordx4 v214, s[8:11], s27 offen offset:0 nt lds
 v_mfma_f32_32x32x16_bf16 a[16:31], v[156:159], a[104:107], a[16:31]
 ds_read_b64_tr_b16 v[120:121], v212 offset:15552
 ds_read_b64_tr_b16 v[122:123], v212 offset:16832
 v_exp_f32 v190, v190
 v_exp_f32 v191, v191
 s_waitcnt lgkmcnt(6)
 v_mfma_f32_32x32x16_bf16 a[32:47], v[160:163], a[104:107], a[32:47]
 ds_read_b64_tr_b16 v[124:125], v212 offset:15616
 ds_read_b64_tr_b16 v[126:127], v212 offset:16896
 v_add_f32 v226, v226, v188
 v_add_f32 v227, v227, v189
 buffer_load_dwordx4 v215, s[8:11], s27 offen offset:1024 nt lds
 v_mfma_f32_32x32x16_bf16 a[48:63], v[164:167], a[104:107], a[48:63]
 v_cvt_pk_bf16_f32 v198, v188, v189
 v_add_f32 v226, v226, v190
 v_mfma_f32_32x32x16_bf16 a[64:79], v[168:171], a[104:107], a[64:79]
 v_add_f32 v227, v227, v191
 v_cvt_pk_bf16_f32 v199, v190, v191
 v_mfma_f32_32x32x16_bf16 a[0:15], v[172:175], a[108:111], a[0:15]
 buffer_load_dwordx4 v216, s[8:11], s27 offen offset:2048 nt lds
 s_add_u32 s27, s27, 12288
 s_waitcnt lgkmcnt(0)
 v_mfma_f32_32x32x16_bf16 a[16:31], v[112:115], a[108:111], a[16:31]
 v_mfma_f32_32x32x16_bf16 a[32:47], v[116:119], a[108:111], a[32:47]
 v_mfma_f32_32x32x16_bf16 a[48:63], v[120:123], a[108:111], a[48:63]
 v_mfma_f32_32x32x16_bf16 a[64:79], v[124:127], a[108:111], a[64:79]
 s_mov_b32 s25, s24
 s_add_u32 s24, s24, 24576
 s_cmp_eq_u32 s24, 147456
 s_cselect_b32 s24, 0, s24
 v_add_u32 v212, s24, v204
 v_xor_b32 v213, 64, v212
 s_waitcnt vmcnt(24)
 s_call_b64 s[72:73], L_sub55
 s_mov_b32 s43, 163840
 s_waitcnt vmcnt(24)
 s_call_b64 s[72:73], L_sub62
 s_waitcnt vmcnt(23)
 s_call_b64 s[72:73], L_sub0
 s_waitcnt vmcnt(23)
 s_call_b64 s[72:73], L_sub0
 s_waitcnt vmcnt(23)
 s_call_b64 s[72:73], L_sub0
 s_waitcnt vmcnt(23)
 s_call_b64 s[72:73], L_sub0
 v_add_u32 v212, s24, v237
 s_waitcnt vmcnt(24) lgkmcnt(0)
 s_barrier
 ds_read_b64_tr_b16 v[112:113], v212 offset:0
 ds_read_b64_tr_b16 v[114:115], v212 offset:1280
 ds_read_b64_tr_b16 v[116:117], v212 offset:64
 ds_read_b64_tr_b16 v[118:119], v212 offset:1344
 ds_read_b64_tr_b16 v[120:121], v212 offset:128
 ds_read_b64_tr_b16 v[122:123], v212 offset:1408
 ds_read_b64_tr_b16 v[124:125], v212 offset:192
 ds_read_b64_tr_b16 v[126:127], v212 offset:1472
 ds_read_b64_tr_b16 v[128:129], v212 offset:256
 ds_read_b64_tr_b16 v[130:131], v212 offset:1536
 ds_read_b64_tr_b16 v[132:133], v212 offset:5120
 ds_read_b64_tr_b16 v[134:135], v212 offset:6400
 ds_read_b64_tr_b16 v[136:137], v212 offset:5184
 ds_read_b64_tr_b16 v[138:139], v212 offset:6464
 v_exp_f32 v176, v176
 v_exp_f32 v177, v177
 v_exp_f32 v178, v178
 v_exp_f32 v179, v179
 v_add_f32 v226, v226, v176
 v_add_f32 v227, v227, v177
 v_cvt_pk_bf16_f32 v192, v176, v177
 s_waitcnt lgkmcnt(6)
 v_mfma_f32_32x32x16_bf16 a[0:15], v[112:115], a[112:115], a[0:15]
 ds_read_b64_tr_b16 v[140:141], v212 offset:5248
 ds_read_b64_tr_b16 v[142:143], v212 offset:6528
 v_exp_f32 v180, v180
 v_exp_f32 v181, v181
 v_add_f32 v226, v226, v178
 v_mfma_f32_32x32x16_bf16 a[16:31], v[116:119], a[112:115], a[16:31]
 ds_read_b64_tr_b16 v[144:145], v212 offset:5312
 ds_read_b64_tr_b16 v[146:147], v212 offset:6592
 v_add_f32 v227, v227, v179
 v_cvt_pk_bf16_f32 v193, v178, v179
 v_mfma_f32_32x32x16_bf16 a[32:47], v[120:123], a[112:115], a[32:47]
 ds_read_b64_tr_b16 v[148:149], v212 offset:5376
 ds_read_b64_tr_b16 v[150:151], v212 offset:6656
 v_exp_f32 v182, v182
 v_exp_f32 v183, v183
 s_add_u32 m0, s25, s40
 s_nop 0
 buffer_load_dwordx4 v217, s[12:15], s28 offen offset:0 nt lds
 v_mfma_f32_32x32x16_bf16 a[48:63], v[124:127], a[112:115], a[48:63]
 ds_read_b64_tr_b16 v[152:153], v212 offset:10240
 ds_read_b64_tr_b16 v[154:155], v212 offset:11520
 v_add_f32 v226, v226, v180
 v_add_f32 v227, v227, v181
 s_waitcnt lgkmcnt(6)
 v_mfma_f32_32x32x16_bf16 a[64:79], v[128:131], a[112:115], a[64:79]
 ds_read_b64_tr_b16 v[156:157], v212 offset:10304
 ds_read_b64_tr_b16 v[158:159], v212 offset:11584
 v_cvt_pk_bf16_f32 v194, v180, v181
 v_exp_f32 v184, v184
 buffer_load_dwordx4 v218, s[12:15], s28 offen offset:1024 nt lds
 v_mfma_f32_32x32x16_bf16 a[0:15], v[132:135], a[116:119], a[0:15]
 ds_read_b64_tr_b16 v[160:161], v212 offset:10368
 ds_read_b64_tr_b16 v[162:163], v212 offset:11648
 v_exp_f32 v185, v185
 v_add_f32 v226, v226, v182
 v_add_f32 v227, v227, v183
 v_mfma_f32_32x32x16_bf16 a[16:31], v[136:139], a[116:119], a[16:31]
 ds_read_b64_tr_b16 v[164:165], v212 offset:10432
 ds_read_b64_tr_b16 v[166:167], v212 offset:11712
 v_cvt_pk_bf16_f32 v195, v182, v183
 v_exp_f32 v186, v186
 v_mfma_f32_32x32x16_bf16 a[32:47], v[140:143], a[116:119], a[32:47]
 ds_read_b64_tr_b16 v[168:169], v212 offset:10496
 ds_read_b64_tr_b16 v[170:171], v212 offset:11776
 v_exp_f32 v187, v187
 v_add_f32 v226, v226, v184
 buffer_load_dwordx4 v219, s[12:15], s28 offen offset:2048 nt lds
 s_add_u32 s28, s28, 12288
 s_waitcnt lgkmcnt(6)
 v_mfma_f32_32x32x16_bf16 a[48:63], v[144:147], a[116:119], a[48:63]
 ds_read_b64_tr_b16 v[172:173], v212 offset:15360
 ds_read_b64_tr_b16 v[174:175], v212 offset:16640
 v_add_f32 v227, v227, v185
 v_cvt_pk_bf16_f32 v196, v184, v185
 v_mfma_f32_32x32x16_bf16 a[64:79], v[148:151], a[116:119], a[64:79]
 ds_read_b64_tr_b16 v[112:113], v212 offset:15424
 ds_read_b64_tr_b16 v[114:115], v212 offset:16704
 v_exp_f32 v188, v188
 v_exp_f32 v189, v189
 v_mfma_f32_32x32x16_bf16 a[0:15], v[152:155], a[120:123], a[0:15]
 ds_read_b64_tr_b16 v[116:117], v212 offset:15488
 ds_read_b64_tr_b16 v[118:119], v212 offset:16768
 v_add_f32 v226, v226, v186
 v_add_f32 v227, v227, v187
 v_cvt_pk_bf16_f32 v197, v186, v187
 s_add_u32 m0, s25, s41
 s_nop 0
 buffer_load_dwordx4 v214, s[8:11], s27 offen offset:0 nt lds
 v_mfma_f32_32x32x16_bf16 a[16:31], v[156:159], a[120:123], a[16:31]
 ds_read_b64_tr_b16 v[120:121], v212 offset:15552
 ds_read_b64_tr_b16 v[122:123], v212 offset:16832
 v_exp_f32 v190, v190
 v_exp_f32 v191, v191
 s_waitcnt lgkmcnt(6)
 v_mfma_f32_32x32x16_bf16 a[32:47], v[160:163], a[120:123], a[32:47]
 ds_read_b64_tr_b16 v[124:125], v212 offset:15616
 ds_read_b64_tr_b16 v[126:127], v212 offset:16896
 v_add_f32 v226, v226, v188
 v_add_f32 v227, v227, v189
 buffer_load_dwordx4 v215, s[8:11], s27 offen offset:1024 nt lds
 v_mfma_f32_32x32x16_bf16 a[48:63], v[164:167], a[120:123], a[48:63]
 v_cvt_pk_bf16_f32 v198, v188, v189
 v_add_f32 v226, v226, v190
 v_mfma_f32_32x32x16_bf16 a[64:79], v[168:171], a[120:123], a[64:79]
 v_add_f32 v227, v227, v191
 v_cvt_pk_bf16_f32 v199, v190, v191
 v_mfma_f32_32x32x16_bf16 a[0:15], v[172:175], a[124:127], a[0:15]
 buffer_load_dwordx4 v216, s[8:11], s27 offen offset:2048 nt lds
 s_add_u32 s27, s27, 12288
 s_waitcnt lgkmcnt(0)
 v_mfma_f32_32x32x16_bf16 a[16:31], v[112:115], a[124:127], a[16:31]
 v_mfma_f32_32x32x16_bf16 a[32:47], v[116:119], a[124:127], a[32:47]
 v_mfma_f32_32x32x16_bf16 a[48:63], v[120:123], a[124:127], a[48:63]
 v_mfma_f32_32x32x16_bf16 a[64:79], v[124:127], a[124:127], a[64:79]
 s_mov_b32 s25, s24
 s_add_u32 s24, s24, 24576
 s_cmp_eq_u32 s24, 147456
 s_cselect_b32 s24, 0, s24
 v_add_u32 v212, s24, v204
 v_xor_b32 v213, 64, v212
 s_waitcnt vmcnt(24)
 s_call_b64 s[72:73], L_sub55
 s_mov_b32 s37, 0
 buffer_load_dword v12, v11, s[48:51], s37 offen
 s_mov_b32 s37, 4096
 buffer_load_dword v12, v11, s[48:51], s37 offen
 s_mov_b32 s37, 8192
 buffer_load_dword v12, v11, s[48:51], s37 offen
 s_mov_b32 s37, 11264
 buffer_load_dword v12, v11, s[48:51], s37 offen
 s_waitcnt vmcnt(28)
 s_call_b64 s[72:73], L_sub0
 s_waitcnt vmcnt(28)
 s_call_b64 s[72:73], L_sub0
 s_waitcnt vmcnt(28)
 s_call_b64 s[72:73], L_sub60
 s_mov_b32 s43, 245760
 s_waitcnt vmcnt(28)
 s_call_b64 s[72:73], L_sub62
 s_mov_b32 s43, 327680
 s_waitcnt vmcnt(27)
 s_call_b64 s[72:73], L_sub62
 s_mov_b32 s43, 409600
 s_waitcnt vmcnt(22)
 s_call_b64 s[72:73], L_sub62
 s_mov_b32 s43, 320
 s_waitcnt vmcnt(21)
 s_call_b64 s[72:73], L_sub62
 s_mov_b32 s43, 82240
 s_waitcnt vmcnt(20) lgkmcnt(0)
 s_barrier
 v_mfma_f32_32x32x16_bf16 v[160:175], v[64:67], v[16:19], 0
 ds_read_b64_tr_b16 v[112:113], v212 offset:0
 ds_read_b64_tr_b16 v[114:115], v212 offset:3072
 ds_read_b64_tr_b16 v[116:117], v213 offset:0
 v_exp_f32 v176, v176
 v_exp_f32 v177, v177
 v_exp_f32 v178, v178
 v_mfma_f32_32x32x16_bf16 v[160:175], v[68:71], v[20:23], v[160:175]
 ds_read_b64_tr_b16 v[118:119], v213 offset:3072
 ds_read_b64_tr_b16 v[120:121], v212 offset:128
 v_exp_f32 v179, v179
 v_add_f32 v226, v226, v176
 v_mfma_f32_32x32x16_bf16 v[160:175], v[72:75], v[24:27], v[160:175]
 ds_read_b64_tr_b16 v[122:123], v212 offset:3200
 ds_read_b64_tr_b16 v[124:125], v213 offset:128
 v_add_f32 v227, v227, v177
 v_cvt_pk_bf16_f32 v192, v176, v177
 v_exp_f32 v180, v180
 v_mfma_f32_32x32x16_bf16 v[160:175], v[76:79], v[28:31], v[160:175]
 ds_read_b64_tr_b16 v[126:127], v213 offset:3200
 ds_read_b64_tr_b16 v[128:129], v212 offset:256
 v_exp_f32 v181, v181
 v_add_f32 v226, v226, v178
 v_mfma_f32_32x32x16_bf16 v[160:175], v[80:83], v[32:35], v[160:175]
 ds_read_b64_tr_b16 v[130:131], v212 offset:3328
 ds_read_b64_tr_b16 v[132:133], v213 offset:256
 v_add_f32 v227, v227, v179
 v_cvt_pk_bf16_f32 v193, v178, v179
 v_exp_f32 v182, v182
 v_mfma_f32_32x32x16_bf16 v[160:175], v[84:87], v[36:39], v[160:175]
 ds_read_b64_tr_b16 v[134:135], v213 offset:3328
 ds_read_b64_tr_b16 v[136:137], v212 offset:6144
 ds_read_b64_tr_b16 v[138:139], v212 offset:9216
 v_exp_f32 v183, v183
 v_add_f32 v226, v226, v180
 v_mfma_f32_32x32x16_bf16 v[160:175], v[88:91], v[40:43], v[160:175]
 ds_read_b64_tr_b16 v[140:141], v213 offset:6144
 ds_read_b64_tr_b16 v[142:143], v213 offset:9216
 v_add_f32 v227, v227, v181
 v_cvt_pk_bf16_f32 v194, v180, v181
 v_exp_f32 v184, v184
 v_mfma_f32_32x32x16_bf16 v[160:175], v[92:95], v[44:47], v[160:175]
 ds_read_b64_tr_b16 v[144:145], v212 offset:6272
 ds_read_b64_tr_b16 v[146:147], v212 offset:9344
 v_exp_f32 v185, v185
 v_add_f32 v226, v226, v182
 v_mfma_f32_32x32x16_bf16 v[160:175], v[96:99], v[48:51], v[160:175]
 ds_read_b64_tr_b16 v[148:149], v213 offset:6272
 ds_read_b64_tr_b16 v[150:151], v213 offset:9344
 v_add_f32 v227, v227, v183
 v_cvt_pk_bf16_f32 v195, v182, v183
 v_exp_f32 v186, v186
 v_mfma_f32_32x32x16_bf16 v[160:175], v[100:103], v[52:55], v[160:175]
 ds_read_b64_tr_b16 v[152:153], v212 offset:6400
 ds_read_b64_tr_b16 v[154:155], v212 offset:9472
 v_exp_f32 v187, v187
 v_add_f32 v226, v226, v184
 v_mfma_f32_32x32x16_bf16 v[160:175], v[104:107], v[56:59], v[160:175]
 ds_read_b64_tr_b16 v[156:157], v213 offset:6400
 ds_read_b64_tr_b16 v[158:159], v213 offset:9472
 v_add_f32 v227, v227, v185
 v_cvt_pk_bf16_f32 v196, v184, v185
 v_exp_f32 v188, v188
 v_mfma_f32_32x32x16_bf16 v[160:175], v[108:111], v[60:63], v[160:175]
 v_exp_f32 v189, v189
 v_add_f32 v226, v226, v186
 s_waitcnt lgkmcnt(6)
 v_mfma_f32_32x32x16_bf16 a[160:175], v[112:115], v[192:195], a[160:175]
 v_add_f32 v227, v227, v187
 v_cvt_pk_bf16_f32 v197, v186, v187
 v_exp_f32 v190, v190
 v_exp_f32 v191, v191
 ds_read_b64_tr_b16 v[64:65], v212 offset:12288
 ds_read_b64_tr_b16 v[66:67], v212 offset:15360
 ds_read_b64_tr_b16 v[68:69], v213 offset:12288
 s_add_u32 m0, s25, s42
 s_nop 0
 buffer_load_dwordx4 v232, s[48:51], s43 offen offset:0 lds
 v_mfma_f32_32x32x16_bf16 a[176:191], v[116:119], v[192:195], a[176:191]
 v_add_f32 v226, v226, v188
 v_add_f32 v227, v227, v189
 v_cvt_pk_bf16_f32 v198, v188, v189
 ds_read_b64_tr_b16 v[70:71], v213 offset:15360
 ds_read_b64_tr_b16 v[72:73], v212 offset:12416
 ds_read_b64_tr_b16 v[74:75], v212 offset:15488
 v_mfma_f32_32x32x16_bf16 a[192:207], v[120:123], v[192:195], a[192:207]
 v_add_f32 v226, v226, v190
 v_add_f32 v227, v227, v191
 v_cvt_pk_bf16_f32 v199, v190, v191
 ds_read_b64_tr_b16 v[76:77], v213 offset:12416
 ds_read_b64_tr_b16 v[78:79], v213 offset:15488
 ds_read_b64_tr_b16 v[80:81], v212 offset:12544
 buffer_load_dwordx4 v233, s[48:51], s43 offen offset:1024 lds
 v_mfma_f32_32x32x16_bf16 a[208:223], v[124:127], v[192:195], a[208:223]
 ds_read_b64_tr_b16 v[82:83], v212 offset:15616
 ds_read_b64_tr_b16 v[84:85], v213 offset:12544
 ds_read_b64_tr_b16 v[86:87], v213 offset:15616
 v_max3_f32 v228, v160, v161, v162
 v_max3_f32 v228, v228, v163, v164
 v_max3_f32 v228, v228, v165, v166
 v_mfma_f32_32x32x16_bf16 a[224:239], v[128:131], v[192:195], a[224:239]
 ds_read_b64_tr_b16 v[88:89], v212 offset:18432
 ds_read_b64_tr_b16 v[90:91], v212 offset:21504
 ds_read_b64_tr_b16 v[92:93], v213 offset:18432
 v_max3_f32 v228, v228, v167, v168
 v_max3_f32 v228, v228, v169, v170
 v_max3_f32 v228, v228, v171, v172
 buffer_load_dwordx4 v234, s[48:51], s43 offen offset:2048 lds
 v_mfma_f32_32x32x16_bf16 a[240:255], v[132:135], v[192:195], a[240:255]
 ds_read_b64_tr_b16 v[94:95], v213 offset:21504
 ds_read_b64_tr_b16 v[96:97], v212 offset:18560
 ds_read_b64_tr_b16 v[98:99], v212 offset:21632
 v_max3_f32 v228, v228, v173, v174
 v_max_f32 v228, v228, v175
 v_cmp_gt_f32 vcc, v228, v225
 s_waitcnt lgkmcnt(15)
 v_mfma_f32_32x32x16_bf16 a[160:175], v[136:139], v[196:199], a[160:175]
 ds_read_b64_tr_b16 v[100:101], v213 offset:18560
 ds_read_b64_tr_b16 v[102:103], v213 offset:21632
 ds_read_b64_tr_b16 v[104:105], v212 offset:18688
 v_fma_f32 v176, v160, s32, -v224
 v_fma_f32 v177, v161, s32, -v224
 v_fma_f32 v178, v162, s32, -v224
 v_fma_f32 v179, v163, s32, -v224
 buffer_load_dwordx4 v235, s[48:51], s43 offen offset:3072 lds
 v_mfma_f32_32x32x16_bf16 a[176:191], v[140:143], v[196:199], a[176:191]
 ds_read_b64_tr_b16 v[106:107], v212 offset:21760
 ds_read_b64_tr_b16 v[108:109], v213 offset:18688
 ds_read_b64_tr_b16 v[110:111], v213 offset:21760
 v_fma_f32 v180, v164, s32, -v224
 v_fma_f32 v181, v165, s32, -v224
 v_fma_f32 v182, v166, s32, -v224
 v_mfma_f32_32x32x16_bf16 a[192:207], v[144:147], v[196:199], a[192:207]
 v_fma_f32 v183, v167, s32, -v224
 v_fma_f32 v184, v168, s32, -v224
 v_fma_f32 v185, v169, s32, -v224
 s_add_u32 m0, m0, 4096
 s_nop 0
 buffer_load_dwordx4 v236, s[48:51], s43 offen offset:0 lds
 v_mfma_f32_32x32x16_bf16 a[208:223], v[148:151], v[196:199], a[208:223]
 v_fma_f32 v186, v170, s32, -v224
 v_fma_f32 v187, v171, s32, -v224
 v_fma_f32 v188, v172, s32, -v224
 v_mfma_f32_32x32x16_bf16 a[224:239], v[152:155], v[196:199], a[224:239]
 v_fma_f32 v189, v173, s32, -v224
 v_fma_f32 v190, v174, s32, -v224
 v_fma_f32 v191, v175, s32, -v224
 v_mfma_f32_32x32x16_bf16 a[240:255], v[156:159], v[196:199], a[240:255]
 s_mov_b32 s25, s24
 s_add_u32 s24, s24, 24576
 s_cmp_eq_u32 s24, 147456
 s_cselect_b32 s24, 0, s24
 v_add_u32 v212, s24, v237
 s_cbranch_vccz L_skip62
 s_call_b64 s[30:31], L_rescale
L_skip62:
 v_exp_f32 v176, v176
 v_exp_f32 v177, v177
 v_exp_f32 v178, v178
 v_exp_f32 v179, v179
 v_add_f32 v226, v226, v176
 v_add_f32 v227, v227, v177
 v_cvt_pk_bf16_f32 v192, v176, v177
 v_exp_f32 v180, v180
 v_exp_f32 v181, v181
 v_add_f32 v226, v226, v178
 v_add_f32 v227, v227, v179
 v_cvt_pk_bf16_f32 v193, v178, v179
 v_exp_f32 v182, v182
 v_exp_f32 v183, v183
 v_add_f32 v226, v226, v180
 v_add_f32 v227, v227, v181
 v_cvt_pk_bf16_f32 v194, v180, v181
 v_exp_f32 v184, v184
 v_exp_f32 v185, v185
 v_add_f32 v226, v226, v182
 v_add_f32 v227, v227, v183
 v_cvt_pk_bf16_f32 v195, v182, v183
 v_exp_f32 v186, v186
 v_exp_f32 v187, v187
 v_add_f32 v226, v226, v184
 v_add_f32 v227, v227, v185
 v_cvt_pk_bf16_f32 v196, v184, v185
 v_exp_f32 v188, v188
 v_exp_f32 v189, v189
 v_add_f32 v226, v226, v186
 v_add_f32 v227, v227, v187
 v_cvt_pk_bf16_f32 v197, v186, v187
 v_exp_f32 v190, v190
 v_exp_f32 v191, v191
 v_add_f32 v226, v226, v188
 v_add_f32 v227, v227, v189
 v_cvt_pk_bf16_f32 v198, v188, v189
 v_add_f32 v226, v226, v190
 v_add_f32 v227, v227, v191
 v_cvt_pk_bf16_f32 v199, v190, v191
 s_waitcnt lgkmcnt(0)
 s_nop 0
 v_mfma_f32_32x32x16_bf16 a[160:175], v[64:67], v[192:195], a[160:175]
 v_mfma_f32_32x32x16_bf16 a[160:175], v[88:91], v[196:199], a[160:175]
 v_mfma_f32_32x32x16_bf16 a[176:191], v[68:71], v[192:195], a[176:191]
 v_add_f32 v226, v226, v227
 v_mov_b32 v229, v226
 s_nop 1
 v_permlane32_swap_b32 v229, v226
 s_nop 1
 v_mfma_f32_32x32x16_bf16 a[176:191], v[92:95], v[196:199], a[176:191]
 v_add_f32 v226, v226, v229
 v_rcp_f32 v226, v226
 s_mov_b32 s35, 49152
 s_nop 7
 v_mfma_f32_32x32x16_bf16 a[192:207], v[72:75], v[192:195], a[192:207]
 v_accvgpr_read_b32 v176, a160
 v_accvgpr_read_b32 v177, a161
 v_accvgpr_read_b32 v178, a162
 v_accvgpr_read_b32 v179, a163
 v_accvgpr_read_b32 v180, a164
 v_accvgpr_read_b32 v181, a165
 v_accvgpr_read_b32 v182, a166
 v_accvgpr_read_b32 v183, a167
 v_mfma_f32_32x32x16_bf16 a[192:207], v[96:99], v[196:199], a[192:207]
 v_mul_f32 v176, v176, v226
 v_mul_f32 v177, v177, v226
 v_mul_f32 v178, v178, v226
 v_mul_f32 v179, v179, v226
 v_mul_f32 v180, v180, v226
 v_mul_f32 v181, v181, v226
 v_mul_f32 v182, v182, v226
 v_mul_f32 v183, v183, v226
 v_mfma_f32_32x32x16_bf16 a[208:223], v[76:79], v[192:195], a[208:223]
 v_cvt_pk_bf16_f32 v16, v176, v177
 v_cvt_pk_bf16_f32 v17, v178, v179
 v_cvt_pk_bf16_f32 v18, v180, v181
 v_cvt_pk_bf16_f32 v19, v182, v183
 v_accvgpr_read_b32 v176, a168
 v_accvgpr_read_b32 v177, a169
 v_accvgpr_read_b32 v178, a170
 v_accvgpr_read_b32 v179, a171
 v_mfma_f32_32x32x16_bf16 a[208:223], v[100:103], v[196:199], a[208:223]
 v_accvgpr_read_b32 v180, a172
 v_accvgpr_read_b32 v181, a173
 v_accvgpr_read_b32 v182, a174
 v_accvgpr_read_b32 v183, a175
 v_mul_f32 v176, v176, v226
 v_mul_f32 v177, v177, v226
 v_mul_f32 v178, v178, v226
 v_mul_f32 v179, v179, v226
 v_mfma_f32_32x32x16_bf16 a[224:239], v[80:83], v[192:195], a[224:239]
 v_mul_f32 v180, v180, v226
 v_mul_f32 v181, v181, v226
 v_mul_f32 v182, v182, v226
 v_mul_f32 v183, v183, v226
 v_cvt_pk_bf16_f32 v20, v176, v177
 v_cvt_pk_bf16_f32 v21, v178, v179
 v_cvt_pk_bf16_f32 v22, v180, v181
 v_cvt_pk_bf16_f32 v23, v182, v183
 v_mfma_f32_32x32x16_bf16 a[224:239], v[104:107], v[196:199], a[224:239]
 v_accvgpr_read_b32 v176, a176
 v_accvgpr_read_b32 v177, a177
 v_accvgpr_read_b32 v178, a178
 v_accvgpr_read_b32 v179, a179
 v_accvgpr_read_b32 v180, a180
 v_accvgpr_read_b32 v181, a181
 v_accvgpr_read_b32 v182, a182
 v_accvgpr_read_b32 v183, a183
 v_mfma_f32_32x32x16_bf16 a[240:255], v[84:87], v[192:195], a[240:255]
 v_mul_f32 v176, v176, v226
 v_mul_f32 v177, v177, v226
 v_mul_f32 v178, v178, v226
 v_mul_f32 v179, v179, v226
 v_mul_f32 v180, v180, v226
 v_mul_f32 v181, v181, v226
 v_mul_f32 v182, v182, v226
 v_mul_f32 v183, v183, v226
 v_mfma_f32_32x32x16_bf16 a[240:255], v[108:111], v[196:199], a[240:255]
 v_cvt_pk_bf16_f32 v24, v176, v177
 v_cvt_pk_bf16_f32 v25, v178, v179
 v_cvt_pk_bf16_f32 v26, v180, v181
 v_cvt_pk_bf16_f32 v27, v182, v183
 v_accvgpr_read_b32 v176, a184
 v_accvgpr_read_b32 v177, a185
 v_accvgpr_read_b32 v178, a186
 v_accvgpr_read_b32 v179, a187
 v_accvgpr_read_b32 v180, a188
 v_accvgpr_read_b32 v181, a189
 v_accvgpr_read_b32 v182, a190
 v_accvgpr_read_b32 v183, a191
 v_mul_f32 v176, v176, v226
 v_mul_f32 v177, v177, v226
 v_mul_f32 v178, v178, v226
 v_mul_f32 v179, v179, v226
 v_mul_f32 v180, v180, v226
 v_mul_f32 v181, v181, v226
 v_mul_f32 v182, v182, v226
 v_mul_f32 v183, v183, v226
 v_cvt_pk_bf16_f32 v28, v176, v177
 v_cvt_pk_bf16_f32 v29, v178, v179
 v_cvt_pk_bf16_f32 v30, v180, v181
 v_cvt_pk_bf16_f32 v31, v182, v183
 v_accvgpr_read_b32 v176, a192
 v_accvgpr_read_b32 v177, a193
 v_accvgpr_read_b32 v178, a194
 v_accvgpr_read_b32 v179, a195
 v_accvgpr_read_b32 v180, a196
 v_accvgpr_read_b32 v181, a197
 v_accvgpr_read_b32 v182, a198
 v_accvgpr_read_b32 v183, a199
 v_mul_f32 v176, v176, v226
 v_mul_f32 v177, v177, v226
 v_mul_f32 v178, v178, v226
 v_mul_f32 v179, v179, v226
 v_mul_f32 v180, v180, v226
 v_mul_f32 v181, v181, v226
 v_mul_f32 v182, v182, v226
 v_mul_f32 v183, v183, v226
 v_cvt_pk_bf16_f32 v32, v176, v177
 v_cvt_pk_bf16_f32 v33, v178, v179
 v_cvt_pk_bf16_f32 v34, v180, v181
 v_cvt_pk_bf16_f32 v35, v182, v183
 v_accvgpr_read_b32 v176, a200
 v_accvgpr_read_b32 v177, a201
 v_accvgpr_read_b32 v178, a202
 v_accvgpr_read_b32 v179, a203
 v_accvgpr_read_b32 v180, a204
 v_accvgpr_read_b32 v181, a205
 v_accvgpr_read_b32 v182, a206
 v_accvgpr_read_b32 v183, a207
 v_mul_f32 v176, v176, v226
 v_mul_f32 v177, v177, v226
 v_mul_f32 v178, v178, v226
 v_mul_f32 v179, v179, v226
 v_mul_f32 v180, v180, v226
 v_mul_f32 v181, v181, v226
 v_mul_f32 v182, v182, v226
 v_mul_f32 v183, v183, v226
 v_cvt_pk_bf16_f32 v36, v176, v177
 v_cvt_pk_bf16_f32 v37, v178, v179
 v_cvt_pk_bf16_f32 v38, v180, v181
 v_cvt_pk_bf16_f32 v39, v182, v183
 v_accvgpr_read_b32 v176, a208
 v_accvgpr_read_b32 v177, a209
 v_accvgpr_read_b32 v178, a210
 v_accvgpr_read_b32 v179, a211
 v_accvgpr_read_b32 v180, a212
 v_accvgpr_read_b32 v181, a213
 v_accvgpr_read_b32 v182, a214
 v_accvgpr_read_b32 v183, a215
 v_mul_f32 v176, v176, v226
 v_mul_f32 v177, v177, v226
 v_mul_f32 v178, v178, v226
 v_mul_f32 v179, v179, v226
 v_mul_f32 v180, v180, v226
 v_mul_f32 v181, v181, v226
 v_mul_f32 v182, v182, v226
 v_mul_f32 v183, v183, v226
 v_cvt_pk_bf16_f32 v40, v176, v177
 v_cvt_pk_bf16_f32 v41, v178, v179
 v_cvt_pk_bf16_f32 v42, v180, v181
 v_cvt_pk_bf16_f32 v43, v182, v183
 v_accvgpr_read_b32 v176, a216
 v_accvgpr_read_b32 v177, a217
 v_accvgpr_read_b32 v178, a218
 v_accvgpr_read_b32 v179, a219
 v_accvgpr_read_b32 v180, a220
 v_accvgpr_read_b32 v181, a221
 v_accvgpr_read_b32 v182, a222
 v_accvgpr_read_b32 v183, a223
 v_mul_f32 v176, v176, v226
 v_mul_f32 v177, v177, v226
 v_mul_f32 v178, v178, v226
 v_mul_f32 v179, v179, v226
 v_mul_f32 v180, v180, v226
 v_mul_f32 v181, v181, v226
 v_mul_f32 v182, v182, v226
 v_mul_f32 v183, v183, v226
 v_cvt_pk_bf16_f32 v44, v176, v177
 v_cvt_pk_bf16_f32 v45, v178, v179
 v_cvt_pk_bf16_f32 v46, v180, v181
 v_cvt_pk_bf16_f32 v47, v182, v183
 v_accvgpr_read_b32 v176, a224
 v_accvgpr_read_b32 v177, a225
 v_accvgpr_read_b32 v178, a226
 v_accvgpr_read_b32 v179, a227
 v_accvgpr_read_b32 v180, a228
 v_accvgpr_read_b32 v181, a229
 v_accvgpr_read_b32 v182, a230
 v_accvgpr_read_b32 v183, a231
 v_mul_f32 v176, v176, v226
 v_mul_f32 v177, v177, v226
 v_mul_f32 v178, v178, v226
 v_mul_f32 v179, v179, v226
 v_mul_f32 v180, v180, v226
 v_mul_f32 v181, v181, v226
 v_mul_f32 v182, v182, v226
 v_mul_f32 v183, v183, v226
 v_cvt_pk_bf16_f32 v48, v176, v177
 v_cvt_pk_bf16_f32 v49, v178, v179
 v_cvt_pk_bf16_f32 v50, v180, v181
 v_cvt_pk_bf16_f32 v51, v182, v183
 v_accvgpr_read_b32 v176, a232
 v_accvgpr_read_b32 v177, a233
 v_accvgpr_read_b32 v178, a234
 v_accvgpr_read_b32 v179, a235
 v_accvgpr_read_b32 v180, a236
 v_accvgpr_read_b32 v181, a237
 v_accvgpr_read_b32 v182, a238
 v_accvgpr_read_b32 v183, a239
 v_mul_f32 v176, v176, v226
 v_mul_f32 v177, v177, v226
 v_mul_f32 v178, v178, v226
 v_mul_f32 v179, v179, v226
 v_mul_f32 v180, v180, v226
 v_mul_f32 v181, v181, v226
 v_mul_f32 v182, v182, v226
 v_mul_f32 v183, v183, v226
 v_cvt_pk_bf16_f32 v52, v176, v177
 v_cvt_pk_bf16_f32 v53, v178, v179
 v_cvt_pk_bf16_f32 v54, v180, v181
 v_cvt_pk_bf16_f32 v55, v182, v183
 v_accvgpr_read_b32 v176, a240
 v_accvgpr_read_b32 v177, a241
 v_accvgpr_read_b32 v178, a242
 v_accvgpr_read_b32 v179, a243
 v_accvgpr_read_b32 v180, a244
 v_accvgpr_read_b32 v181, a245
 v_accvgpr_read_b32 v182, a246
 v_accvgpr_read_b32 v183, a247
 v_mul_f32 v176, v176, v226
 v_mul_f32 v177, v177, v226
 v_mul_f32 v178, v178, v226
 v_mul_f32 v179, v179, v226
 v_mul_f32 v180, v180, v226
 v_mul_f32 v181, v181, v226
 v_mul_f32 v182, v182, v226
 v_mul_f32 v183, v183, v226
 v_cvt_pk_bf16_f32 v56, v176, v177
 v_cvt_pk_bf16_f32 v57, v178, v179
 v_cvt_pk_bf16_f32 v58, v180, v181
 v_cvt_pk_bf16_f32 v59, v182, v183
 v_accvgpr_read_b32 v176, a248
 v_accvgpr_read_b32 v177, a249
 v_accvgpr_read_b32 v178, a250
 v_accvgpr_read_b32 v179, a251
 v_accvgpr_read_b32 v180, a252
 v_accvgpr_read_b32 v181, a253
 v_accvgpr_read_b32 v182, a254
 v_accvgpr_read_b32 v183, a255
 v_mul_f32 v176, v176, v226
 v_mul_f32 v177, v177, v226
 v_mul_f32 v178, v178, v226
 v_mul_f32 v179, v179, v226
 v_mul_f32 v180, v180, v226
 v_mul_f32 v181, v181, v226
 v_mul_f32 v182, v182, v226
 v_mul_f32 v183, v183, v226
 v_cvt_pk_bf16_f32 v60, v176, v177
 v_cvt_pk_bf16_f32 v61, v178, v179
 v_cvt_pk_bf16_f32 v62, v180, v181
 v_cvt_pk_bf16_f32 v63, v182, v183
 s_mov_b32 s43, 164160
 s_waitcnt vmcnt(20) lgkmcnt(0)
 s_barrier
 ds_read_b64_tr_b16 v[112:113], v212 offset:0
 ds_read_b64_tr_b16 v[114:115], v212 offset:1280
 ds_read_b64_tr_b16 v[116:117], v212 offset:64
 ds_read_b64_tr_b16 v[118:119], v212 offset:1344
 ds_read_b64_tr_b16 v[120:121], v212 offset:128
 ds_read_b64_tr_b16 v[122:123], v212 offset:1408
 ds_read_b64_tr_b16 v[124:125], v212 offset:192
 ds_read_b64_tr_b16 v[126:127], v212 offset:1472
 ds_read_b64_tr_b16 v[128:129], v212 offset:256
 ds_read_b64_tr_b16 v[130:131], v212 offset:1536
 ds_read_b64_tr_b16 v[132:133], v212 offset:5120
 ds_read_b64_tr_b16 v[134:135], v212 offset:6400
 ds_read_b64_tr_b16 v[136:137], v212 offset:5184
 ds_read_b64_tr_b16 v[138:139], v212 offset:6464
 ds_read_b64_tr_b16 v[140:141], v212 offset:5248
 ds_read_b64_tr_b16 v[142:143], v212 offset:6528
 ds_read_b64_tr_b16 v[144:145], v212 offset:5312
 ds_read_b64_tr_b16 v[146:147], v212 offset:6592
 ds_read_b64_tr_b16 v[148:149], v212 offset:5376
 ds_read_b64_tr_b16 v[150:151], v212 offset:6656
 s_add_u32 m0, s25, s42
 s_nop 0
 buffer_load_dwordx4 v232, s[48:51], s43 offen offset:0 lds
 buffer_load_dwordx4 v233, s[48:51], s43 offen offset:1024 lds
 buffer_load_dwordx4 v234, s[48:51], s43 offen offset:2048 lds
 buffer_load_dwordx4 v235, s[48:51], s43 offen offset:3072 lds
 s_add_u32 m0, m0, 4096
 s_nop 0
 buffer_load_dwordx4 v236, s[48:51], s43 offen offset:0 lds
 s_waitcnt lgkmcnt(0)
 v_mfma_f32_32x32x16_bf16 a[0:15], v[112:115], v[16:19], a[0:15]
 ds_read_b64_tr_b16 v[64:65], v212 offset:10240
 ds_read_b64_tr_b16 v[66:67], v212 offset:11520
 ds_read_b64_tr_b16 v[68:69], v212 offset:10304
 v_mfma_f32_32x32x16_bf16 a[16:31], v[116:119], v[16:19], a[16:31]
 ds_read_b64_tr_b16 v[70:71], v212 offset:11584
 ds_read_b64_tr_b16 v[72:73], v212 offset:10368
 ds_read_b64_tr_b16 v[74:75], v212 offset:11648
 v_mfma_f32_32x32x16_bf16 a[32:47], v[120:123], v[16:19], a[32:47]
 ds_read_b64_tr_b16 v[76:77], v212 offset:10432
 ds_read_b64_tr_b16 v[78:79], v212 offset:11712
 ds_read_b64_tr_b16 v[80:81], v212 offset:10496
 v_mfma_f32_32x32x16_bf16 a[48:63], v[124:127], v[16:19], a[48:63]
 ds_read_b64_tr_b16 v[82:83], v212 offset:11776
 ds_read_b64_tr_b16 v[84:85], v212 offset:15360
 ds_read_b64_tr_b16 v[86:87], v212 offset:16640
 v_mfma_f32_32x32x16_bf16 a[64:79], v[128:131], v[16:19], a[64:79]
 ds_read_b64_tr_b16 v[88:89], v212 offset:15424
 ds_read_b64_tr_b16 v[90:91], v212 offset:16704
 ds_read_b64_tr_b16 v[92:93], v212 offset:15488
 v_mfma_f32_32x32x16_bf16 a[0:15], v[132:135], v[20:23], a[0:15]
 ds_read_b64_tr_b16 v[94:95], v212 offset:16768
 ds_read_b64_tr_b16 v[96:97], v212 offset:15552
 ds_read_b64_tr_b16 v[98:99], v212 offset:16832
 v_mfma_f32_32x32x16_bf16 a[16:31], v[136:139], v[20:23], a[16:31]
 ds_read_b64_tr_b16 v[100:101], v212 offset:15616
 ds_read_b64_tr_b16 v[102:103], v212 offset:16896
 v_mfma_f32_32x32x16_bf16 a[32:47], v[140:143], v[20:23], a[32:47]
 v_mfma_f32_32x32x16_bf16 a[48:63], v[144:147], v[20:23], a[48:63]
 v_mfma_f32_32x32x16_bf16 a[64:79], v[148:151], v[20:23], a[64:79]
 s_mov_b32 s25, s24
 s_add_u32 s24, s24, 24576
 s_cmp_eq_u32 s24, 147456
 s_cselect_b32 s24, 0, s24
 v_add_u32 v212, s24, v237
 s_mov_b32 s43, 246080
 s_waitcnt vmcnt(20) lgkmcnt(0)
 s_barrier
 v_mfma_f32_32x32x16_bf16 a[0:15], v[64:67], v[24:27], a[0:15]
 ds_read_b64_tr_b16 v[112:113], v212 offset:0
 ds_read_b64_tr_b16 v[114:115], v212 offset:1280
 ds_read_b64_tr_b16 v[116:117], v212 offset:64
 s_add_u32 m0, s25, s42
 s_nop 0
 buffer_load_dwordx4 v232, s[48:51], s43 offen offset:0 lds
 v_mfma_f32_32x32x16_bf16 a[16:31], v[68:71], v[24:27], a[16:31]
 ds_read_b64_tr_b16 v[118:119], v212 offset:1344
 ds_read_b64_tr_b16 v[120:121], v212 offset:128
 ds_read_b64_tr_b16 v[122:123], v212 offset:1408
 v_mfma_f32_32x32x16_bf16 a[32:47], v[72:75], v[24:27], a[32:47]
 ds_read_b64_tr_b16 v[124:125], v212 offset:192
 ds_read_b64_tr_b16 v[126:127], v212 offset:1472
 ds_read_b64_tr_b16 v[128:129], v212 offset:256
 buffer_load_dwordx4 v233, s[48:51], s43 offen offset:1024 lds
 v_mfma_f32_32x32x16_bf16 a[48:63], v[76:79], v[24:27], a[48:63]
 ds_read_b64_tr_b16 v[130:131], v212 offset:1536
 ds_read_b64_tr_b16 v[132:133], v212 offset:5120
 ds_read_b64_tr_b16 v[134:135], v212 offset:6400
 v_mfma_f32_32x32x16_bf16 a[64:79], v[80:83], v[24:27], a[64:79]
 ds_read_b64_tr_b16 v[136:137], v212 offset:5184
 ds_read_b64_tr_b16 v[138:139], v212 offset:6464
 ds_read_b64_tr_b16 v[140:141], v212 offset:5248
 buffer_load_dwordx4 v234, s[48:51], s43 offen offset:2048 lds
 v_mfma_f32_32x32x16_bf16 a[0:15], v[84:87], v[28:31], a[0:15]
 ds_read_b64_tr_b16 v[142:143], v212 offset:6528
 ds_read_b64_tr_b16 v[144:145], v212 offset:5312
 ds_read_b64_tr_b16 v[146:147], v212 offset:6592
 v_mfma_f32_32x32x16_bf16 a[16:31], v[88:91], v[28:31], a[16:31]
 ds_read_b64_tr_b16 v[148:149], v212 offset:5376
 ds_read_b64_tr_b16 v[150:151], v212 offset:6656
 buffer_load_dwordx4 v235, s[48:51], s43 offen offset:3072 lds
 v_mfma_f32_32x32x16_bf16 a[32:47], v[92:95], v[28:31], a[32:47]
 v_mfma_f32_32x32x16_bf16 a[48:63], v[96:99], v[28:31], a[48:63]
 s_add_u32 m0, m0, 4096
 s_nop 0
 buffer_load_dwordx4 v236, s[48:51], s43 offen offset:0 lds
 v_mfma_f32_32x32x16_bf16 a[64:79], v[100:103], v[28:31], a[64:79]
 s_waitcnt lgkmcnt(0)
 v_mfma_f32_32x32x16_bf16 a[0:15], v[112:115], v[32:35], a[0:15]
 ds_read_b64_tr_b16 v[64:65], v212 offset:10240
 ds_read_b64_tr_b16 v[66:67], v212 offset:11520
 ds_read_b64_tr_b16 v[68:69], v212 offset:10304
 v_mfma_f32_32x32x16_bf16 a[16:31], v[116:119], v[32:35], a[16:31]
 ds_read_b64_tr_b16 v[70:71], v212 offset:11584
 ds_read_b64_tr_b16 v[72:73], v212 offset:10368
 ds_read_b64_tr_b16 v[74:75], v212 offset:11648
 v_mfma_f32_32x32x16_bf16 a[32:47], v[120:123], v[32:35], a[32:47]
 ds_read_b64_tr_b16 v[76:77], v212 offset:10432
 ds_read_b64_tr_b16 v[78:79], v212 offset:11712
 ds_read_b64_tr_b16 v[80:81], v212 offset:10496
 v_mfma_f32_32x32x16_bf16 a[48:63], v[124:127], v[32:35], a[48:63]
 ds_read_b64_tr_b16 v[82:83], v212 offset:11776
 ds_read_b64_tr_b16 v[84:85], v212 offset:15360
 ds_read_b64_tr_b16 v[86:87], v212 offset:16640
 v_mfma_f32_32x32x16_bf16 a[64:79], v[128:131], v[32:35], a[64:79]
 ds_read_b64_tr_b16 v[88:89], v212 offset:15424
 ds_read_b64_tr_b16 v[90:91], v212 offset:16704
 ds_read_b64_tr_b16 v[92:93], v212 offset:15488
 v_mfma_f32_32x32x16_bf16 a[0:15], v[132:135], v[36:39], a[0:15]
 ds_read_b64_tr_b16 v[94:95], v212 offset:16768
 ds_read_b64_tr_b16 v[96:97], v212 offset:15552
 ds_read_b64_tr_b16 v[98:99], v212 offset:16832
 v_mfma_f32_32x32x16_bf16 a[16:31], v[136:139], v[36:39], a[16:31]
 ds_read_b64_tr_b16 v[100:101], v212 offset:15616
 ds_read_b64_tr_b16 v[102:103], v212 offset:16896
 v_mfma_f32_32x32x16_bf16 a[32:47], v[140:143], v[36:39], a[32:47]
 v_mfma_f32_32x32x16_bf16 a[48:63], v[144:147], v[36:39], a[48:63]
 v_mfma_f32_32x32x16_bf16 a[64:79], v[148:151], v[36:39], a[64:79]
 s_mov_b32 s25, s24
 s_add_u32 s24, s24, 24576
 s_cmp_eq_u32 s24, 147456
 s_cselect_b32 s24, 0, s24
 v_add_u32 v212, s24, v237
 s_mov_b32 s43, 328000
 s_waitcnt vmcnt(20) lgkmcnt(0)
 s_barrier
 v_mfma_f32_32x32x16_bf16 a[0:15], v[64:67], v[40:43], a[0:15]
 ds_read_b64_tr_b16 v[112:113], v212 offset:0
 ds_read_b64_tr_b16 v[114:115], v212 offset:1280
 ds_read_b64_tr_b16 v[116:117], v212 offset:64
 s_add_u32 m0, s25, s42
 s_nop 0
 buffer_load_dwordx4 v232, s[48:51], s43 offen offset:0 lds
 v_mfma_f32_32x32x16_bf16 a[16:31], v[68:71], v[40:43], a[16:31]
 ds_read_b64_tr_b16 v[118:119], v212 offset:1344
 ds_read_b64_tr_b16 v[120:121], v212 offset:128
 ds_read_b64_tr_b16 v[122:123], v212 offset:1408
 v_mfma_f32_32x32x16_bf16 a[32:47], v[72:75], v[40:43], a[32:47]
 ds_read_b64_tr_b16 v[124:125], v212 offset:192
 ds_read_b64_tr_b16 v[126:127], v212 offset:1472
 ds_read_b64_tr_b16 v[128:129], v212 offset:256
 buffer_load_dwordx4 v233, s[48:51], s43 offen offset:1024 lds
 v_mfma_f32_32x32x16_bf16 a[48:63], v[76:79], v[40:43], a[48:63]
 ds_read_b64_tr_b16 v[130:131], v212 offset:1536
 ds_read_b64_tr_b16 v[132:133], v212 offset:5120
 ds_read_b64_tr_b16 v[134:135], v212 offset:6400
 v_mfma_f32_32x32x16_bf16 a[64:79], v[80:83], v[40:43], a[64:79]
 ds_read_b64_tr_b16 v[136:137], v212 offset:5184
 ds_read_b64_tr_b16 v[138:139], v212 offset:6464
 ds_read_b64_tr_b16 v[140:141], v212 offset:5248
 buffer_load_dwordx4 v234, s[48:51], s43 offen offset:2048 lds
 v_mfma_f32_32x32x16_bf16 a[0:15], v[84:87], v[44:47], a[0:15]
 ds_read_b64_tr_b16 v[142:143], v212 offset:6528
 ds_read_b64_tr_b16 v[144:145], v212 offset:5312
 ds_read_b64_tr_b16 v[146:147], v212 offset:6592
 v_mfma_f32_32x32x16_bf16 a[16:31], v[88:91], v[44:47], a[16:31]
 ds_read_b64_tr_b16 v[148:149], v212 offset:5376
 ds_read_b64_tr_b16 v[150:151], v212 offset:6656
 buffer_load_dwordx4 v235, s[48:51], s43 offen offset:3072 lds
 v_mfma_f32_32x32x16_bf16 a[32:47], v[92:95], v[44:47], a[32:47]
 v_mfma_f32_32x32x16_bf16 a[48:63], v[96:99], v[44:47], a[48:63]
 s_add_u32 m0, m0, 4096
 s_nop 0
 buffer_load_dwordx4 v236, s[48:51], s43 offen offset:0 lds
 v_mfma_f32_32x32x16_bf16 a[64:79], v[100:103], v[44:47], a[64:79]
 s_waitcnt lgkmcnt(0)
 v_mfma_f32_32x32x16_bf16 a[0:15], v[112:115], v[48:51], a[0:15]
 ds_read_b64_tr_b16 v[64:65], v212 offset:10240
 ds_read_b64_tr_b16 v[66:67], v212 offset:11520
 ds_read_b64_tr_b16 v[68:69], v212 offset:10304
 v_mfma_f32_32x32x16_bf16 a[16:31], v[116:119], v[48:51], a[16:31]
 ds_read_b64_tr_b16 v[70:71], v212 offset:11584
 ds_read_b64_tr_b16 v[72:73], v212 offset:10368
 ds_read_b64_tr_b16 v[74:75], v212 offset:11648
 v_mfma_f32_32x32x16_bf16 a[32:47], v[120:123], v[48:51], a[32:47]
 ds_read_b64_tr_b16 v[76:77], v212 offset:10432
 ds_read_b64_tr_b16 v[78:79], v212 offset:11712
 ds_read_b64_tr_b16 v[80:81], v212 offset:10496
 v_mfma_f32_32x32x16_bf16 a[48:63], v[124:127], v[48:51], a[48:63]
 ds_read_b64_tr_b16 v[82:83], v212 offset:11776
 ds_read_b64_tr_b16 v[84:85], v212 offset:15360
 ds_read_b64_tr_b16 v[86:87], v212 offset:16640
 v_mfma_f32_32x32x16_bf16 a[64:79], v[128:131], v[48:51], a[64:79]
 ds_read_b64_tr_b16 v[88:89], v212 offset:15424
 ds_read_b64_tr_b16 v[90:91], v212 offset:16704
 ds_read_b64_tr_b16 v[92:93], v212 offset:15488
 v_mfma_f32_32x32x16_bf16 a[0:15], v[132:135], v[52:55], a[0:15]
 ds_read_b64_tr_b16 v[94:95], v212 offset:16768
 ds_read_b64_tr_b16 v[96:97], v212 offset:15552
 ds_read_b64_tr_b16 v[98:99], v212 offset:16832
 v_mfma_f32_32x32x16_bf16 a[16:31], v[136:139], v[52:55], a[16:31]
 ds_read_b64_tr_b16 v[100:101], v212 offset:15616
 ds_read_b64_tr_b16 v[102:103], v212 offset:16896
 v_mfma_f32_32x32x16_bf16 a[32:47], v[140:143], v[52:55], a[32:47]
 v_mfma_f32_32x32x16_bf16 a[48:63], v[144:147], v[52:55], a[48:63]
 v_mfma_f32_32x32x16_bf16 a[64:79], v[148:151], v[52:55], a[64:79]
 s_mov_b32 s25, s24
 s_add_u32 s24, s24, 24576
 s_cmp_eq_u32 s24, 147456
 s_cselect_b32 s24, 0, s24
 v_add_u32 v212, s24, v237
 s_mov_b32 s43, 409920
 s_waitcnt vmcnt(20) lgkmcnt(0)
 s_barrier
 v_mfma_f32_32x32x16_bf16 a[0:15], v[64:67], v[56:59], a[0:15]
 ds_read_b64_tr_b16 v[112:113], v212 offset:0
 ds_read_b64_tr_b16 v[114:115], v212 offset:1280
 ds_read_b64_tr_b16 v[116:117], v212 offset:64
 s_add_u32 m0, s25, s42
 s_nop 0
 buffer_load_dwordx4 v232, s[48:51], s43 offen offset:0 lds
 v_mfma_f32_32x32x16_bf16 a[16:31], v[68:71], v[56:59], a[16:31]
 ds_read_b64_tr_b16 v[118:119], v212 offset:1344
 ds_read_b64_tr_b16 v[120:121], v212 offset:128
 ds_read_b64_tr_b16 v[122:123], v212 offset:1408
 v_mfma_f32_32x32x16_bf16 a[32:47], v[72:75], v[56:59], a[32:47]
 ds_read_b64_tr_b16 v[124:125], v212 offset:192
 ds_read_b64_tr_b16 v[126:127], v212 offset:1472
 ds_read_b64_tr_b16 v[128:129], v212 offset:256
 buffer_load_dwordx4 v233, s[48:51], s43 offen offset:1024 lds
 v_mfma_f32_32x32x16_bf16 a[48:63], v[76:79], v[56:59], a[48:63]
 ds_read_b64_tr_b16 v[130:131], v212 offset:1536
 ds_read_b64_tr_b16 v[132:133], v212 offset:5120
 ds_read_b64_tr_b16 v[134:135], v212 offset:6400
 v_mfma_f32_32x32x16_bf16 a[64:79], v[80:83], v[56:59], a[64:79]
 ds_read_b64_tr_b16 v[136:137], v212 offset:5184
 ds_read_b64_tr_b16 v[138:139], v212 offset:6464
 ds_read_b64_tr_b16 v[140:141], v212 offset:5248
 buffer_load_dwordx4 v234, s[48:51], s43 offen offset:2048 lds
 v_mfma_f32_32x32x16_bf16 a[0:15], v[84:87], v[60:63], a[0:15]
 ds_read_b64_tr_b16 v[142:143], v212 offset:6528
 ds_read_b64_tr_b16 v[144:145], v212 offset:5312
 ds_read_b64_tr_b16 v[146:147], v212 offset:6592
 v_mfma_f32_32x32x16_bf16 a[16:31], v[88:91], v[60:63], a[16:31]
 ds_read_b64_tr_b16 v[148:149], v212 offset:5376
 ds_read_b64_tr_b16 v[150:151], v212 offset:6656
 buffer_load_dwordx4 v235, s[48:51], s43 offen offset:3072 lds
 v_mfma_f32_32x32x16_bf16 a[32:47], v[92:95], v[60:63], a[32:47]
 v_mfma_f32_32x32x16_bf16 a[48:63], v[96:99], v[60:63], a[48:63]
 s_add_u32 m0, m0, 4096
 s_nop 0
 buffer_load_dwordx4 v236, s[48:51], s43 offen offset:0 lds
 v_mfma_f32_32x32x16_bf16 a[64:79], v[100:103], v[60:63], a[64:79]
 s_waitcnt lgkmcnt(0)
 v_mfma_f32_32x32x16_bf16 a[160:175], v[112:115], a[80:83], 0
 ds_read_b64_tr_b16 v[64:65], v212 offset:10240
 ds_read_b64_tr_b16 v[66:67], v212 offset:11520
 ds_read_b64_tr_b16 v[68:69], v212 offset:10304
 v_mfma_f32_32x32x16_bf16 a[176:191], v[116:119], a[80:83], 0
 ds_read_b64_tr_b16 v[70:71], v212 offset:11584
 ds_read_b64_tr_b16 v[72:73], v212 offset:10368
 ds_read_b64_tr_b16 v[74:75], v212 offset:11648
 v_mfma_f32_32x32x16_bf16 a[192:207], v[120:123], a[80:83], 0
 ds_read_b64_tr_b16 v[76:77], v212 offset:10432
 ds_read_b64_tr_b16 v[78:79], v212 offset:11712
 ds_read_b64_tr_b16 v[80:81], v212 offset:10496
 v_mfma_f32_32x32x16_bf16 a[208:223], v[124:127], a[80:83], 0
 ds_read_b64_tr_b16 v[82:83], v212 offset:11776
 ds_read_b64_tr_b16 v[84:85], v212 offset:15360
 ds_read_b64_tr_b16 v[86:87], v212 offset:16640
 v_mfma_f32_32x32x16_bf16 a[224:239], v[128:131], a[80:83], 0
 ds_read_b64_tr_b16 v[88:89], v212 offset:15424
 ds_read_b64_tr_b16 v[90:91], v212 offset:16704
 ds_read_b64_tr_b16 v[92:93], v212 offset:15488
 v_mfma_f32_32x32x16_bf16 a[160:175], v[132:135], a[84:87], a[160:175]
 ds_read_b64_tr_b16 v[94:95], v212 offset:16768
 ds_read_b64_tr_b16 v[96:97], v212 offset:15552
 ds_read_b64_tr_b16 v[98:99], v212 offset:16832
 v_mfma_f32_32x32x16_bf16 a[176:191], v[136:139], a[84:87], a[176:191]
 ds_read_b64_tr_b16 v[100:101], v212 offset:15616
 ds_read_b64_tr_b16 v[102:103], v212 offset:16896
 v_mfma_f32_32x32x16_bf16 a[192:207], v[140:143], a[84:87], a[192:207]
 v_mfma_f32_32x32x16_bf16 a[208:223], v[144:147], a[84:87], a[208:223]
 v_mfma_f32_32x32x16_bf16 a[224:239], v[148:151], a[84:87], a[224:239]
 s_mov_b32 s25, s24
 s_add_u32 s24, s24, 24576
 s_cmp_eq_u32 s24, 147456
 s_cselect_b32 s24, 0, s24
 v_add_u32 v212, s24, v237
 s_mov_b32 s43, 640
 s_waitcnt vmcnt(20) lgkmcnt(0)
 s_barrier
 v_mfma_f32_32x32x16_bf16 a[160:175], v[64:67], a[88:91], a[160:175]
 ds_read_b64_tr_b16 v[112:113], v212 offset:0
 ds_read_b64_tr_b16 v[114:115], v212 offset:1280
 ds_read_b64_tr_b16 v[116:117], v212 offset:64
 s_add_u32 m0, s25, s42
 s_nop 0
 buffer_load_dwordx4 v232, s[48:51], s43 offen offset:0 lds
 v_accvgpr_read_b32 v160, a0
 v_accvgpr_read_b32 v161, a1
 v_mfma_f32_32x32x16_bf16 a[176:191], v[68:71], a[88:91], a[176:191]
 ds_read_b64_tr_b16 v[118:119], v212 offset:1344
 ds_read_b64_tr_b16 v[120:121], v212 offset:128
 ds_read_b64_tr_b16 v[122:123], v212 offset:1408
 v_accvgpr_read_b32 v162, a2
 v_mfma_f32_32x32x16_bf16 a[192:207], v[72:75], a[88:91], a[192:207]
 ds_read_b64_tr_b16 v[124:125], v212 offset:192
 ds_read_b64_tr_b16 v[126:127], v212 offset:1472
 ds_read_b64_tr_b16 v[128:129], v212 offset:256
 buffer_load_dwordx4 v233, s[48:51], s43 offen offset:1024 lds
 v_accvgpr_read_b32 v163, a3
 v_mfma_f32_32x32x16_bf16 a[208:223], v[76:79], a[88:91], a[208:223]
 ds_read_b64_tr_b16 v[130:131], v212 offset:1536
 ds_read_b64_tr_b16 v[132:133], v212 offset:5120
 ds_read_b64_tr_b16 v[134:135], v212 offset:6400
 v_accvgpr_read_b32 v164, a4
 v_accvgpr_read_b32 v165, a5
 v_mfma_f32_32x32x16_bf16 a[224:239], v[80:83], a[88:91], a[224:239]
 ds_read_b64_tr_b16 v[136:137], v212 offset:5184
 ds_read_b64_tr_b16 v[138:139], v212 offset:6464
 ds_read_b64_tr_b16 v[140:141], v212 offset:5248
 buffer_load_dwordx4 v234, s[48:51], s43 offen offset:2048 lds
 v_accvgpr_read_b32 v166, a6
 v_mfma_f32_32x32x16_bf16 a[160:175], v[84:87], a[92:95], a[160:175]
 ds_read_b64_tr_b16 v[142:143], v212 offset:6528
 ds_read_b64_tr_b16 v[144:145], v212 offset:5312
 ds_read_b64_tr_b16 v[146:147], v212 offset:6592
 v_accvgpr_read_b32 v167, a7
 v_mfma_f32_32x32x16_bf16 a[176:191], v[88:91], a[92:95], a[176:191]
 ds_read_b64_tr_b16 v[148:149], v212 offset:5376
 ds_read_b64_tr_b16 v[150:151], v212 offset:6656
 buffer_load_dwordx4 v235, s[48:51], s43 offen offset:3072 lds
 v_cvt_pk_bf16_f32 v176, v160, v161
 v_cvt_pk_bf16_f32 v177, v162, v163
 v_mfma_f32_32x32x16_bf16 a[192:207], v[92:95], a[92:95], a[192:207]
 v_cvt_pk_bf16_f32 v178, v164, v165
 v_mfma_f32_32x32x16_bf16 a[208:223], v[96:99], a[92:95], a[208:223]
 s_add_u32 m0, m0, 4096
 s_nop 0
 buffer_load_dwordx4 v236, s[48:51], s43 offen offset:0 lds
 v_cvt_pk_bf16_f32 v179, v166, v167
 v_mfma_f32_32x32x16_bf16 a[224:239], v[100:103], a[92:95], a[224:239]
 s_mov_b32 s35, 0
 buffer_store_dwordx4 v[176:179], v231, s[60:63], s35 offen offset:0
 s_waitcnt lgkmcnt(0)
 v_mfma_f32_32x32x16_bf16 a[160:175], v[112:115], a[96:99], a[160:175]
 ds_read_b64_tr_b16 v[64:65], v212 offset:10240
 ds_read_b64_tr_b16 v[66:67], v212 offset:11520
 ds_read_b64_tr_b16 v[68:69], v212 offset:10304
 v_accvgpr_read_b32 v168, a8
 v_accvgpr_read_b32 v169, a9
 v_mfma_f32_32x32x16_bf16 a[176:191], v[116:119], a[96:99], a[176:191]
 ds_read_b64_tr_b16 v[70:71], v212 offset:11584
 ds_read_b64_tr_b16 v[72:73], v212 offset:10368
 ds_read_b64_tr_b16 v[74:75], v212 offset:11648
 v_accvgpr_read_b32 v170, a10
 v_mfma_f32_32x32x16_bf16 a[192:207], v[120:123], a[96:99], a[192:207]
 ds_read_b64_tr_b16 v[76:77], v212 offset:10432
 ds_read_b64_tr_b16 v[78:79], v212 offset:11712
 ds_read_b64_tr_b16 v[80:81], v212 offset:10496
 v_accvgpr_read_b32 v171, a11
 v_mfma_f32_32x32x16_bf16 a[208:223], v[124:127], a[96:99], a[208:223]
 ds_read_b64_tr_b16 v[82:83], v212 offset:11776
 ds_read_b64_tr_b16 v[84:85], v212 offset:15360
 ds_read_b64_tr_b16 v[86:87], v212 offset:16640
 v_accvgpr_read_b32 v172, a12
 v_accvgpr_read_b32 v173, a13
 v_mfma_f32_32x32x16_bf16 a[224:239], v[128:131], a[96:99], a[224:239]
 ds_read_b64_tr_b16 v[88:89], v212 offset:15424
 ds_read_b64_tr_b16 v[90:91], v212 offset:16704
 ds_read_b64_tr_b16 v[92:93], v212 offset:15488
 v_accvgpr_read_b32 v174, a14
 v_mfma_f32_32x32x16_bf16 a[160:175], v[132:135], a[100:103], a[160:175]
 ds_read_b64_tr_b16 v[94:95], v212 offset:16768
 ds_read_b64_tr_b16 v[96:97], v212 offset:15552
 ds_read_b64_tr_b16 v[98:99], v212 offset:16832
 v_accvgpr_read_b32 v175, a15
 v_mfma_f32_32x32x16_bf16 a[176:191], v[136:139], a[100:103], a[176:191]
 ds_read_b64_tr_b16 v[100:101], v212 offset:15616
 ds_read_b64_tr_b16 v[102:103], v212 offset:16896
 v_cvt_pk_bf16_f32 v180, v168, v169
 v_cvt_pk_bf16_f32 v181, v170, v171
 v_mfma_f32_32x32x16_bf16 a[192:207], v[140:143], a[100:103], a[192:207]
 v_cvt_pk_bf16_f32 v182, v172, v173
 v_mfma_f32_32x32x16_bf16 a[208:223], v[144:147], a[100:103], a[208:223]
 v_cvt_pk_bf16_f32 v183, v174, v175
 v_mfma_f32_32x32x16_bf16 a[224:239], v[148:151], a[100:103], a[224:239]
 s_mov_b32 s35, 0
 buffer_store_dwordx4 v[180:183], v231, s[60:63], s35 offen offset:1024
 s_mov_b32 s25, s24
 s_add_u32 s24, s24, 24576
 s_cmp_eq_u32 s24, 147456
 s_cselect_b32 s24, 0, s24
 v_add_u32 v212, s24, v237
 s_mov_b32 s43, 82560
 s_waitcnt vmcnt(22) lgkmcnt(0)
 s_barrier
 v_mfma_f32_32x32x16_bf16 a[160:175], v[64:67], a[104:107], a[160:175]
 ds_read_b64_tr_b16 v[112:113], v212 offset:0
 ds_read_b64_tr_b16 v[114:115], v212 offset:1280
 ds_read_b64_tr_b16 v[116:117], v212 offset:64
 s_add_u32 m0, s25, s42
 s_nop 0
 buffer_load_dwordx4 v232, s[48:51], s43 offen offset:0 lds
 v_accvgpr_read_b32 v160, a16
 v_accvgpr_read_b32 v161, a17
 v_mfma_f32_32x32x16_bf16 a[176:191], v[68:71], a[104:107], a[176:191]
 ds_read_b64_tr_b16 v[118:119], v212 offset:1344
 ds_read_b64_tr_b16 v[120:121], v212 offset:128
 ds_read_b64_tr_b16 v[122:123], v212 offset:1408
 v_accvgpr_read_b32 v162, a18
 v_mfma_f32_32x32x16_bf16 a[192:207], v[72:75], a[104:107], a[192:207]
 ds_read_b64_tr_b16 v[124:125], v212 offset:192
 ds_read_b64_tr_b16 v[126:127], v212 offset:1472
 ds_read_b64_tr_b16 v[128:129], v212 offset:256
 buffer_load_dwordx4 v233, s[48:51], s43 offen offset:1024 lds
 v_accvgpr_read_b32 v163, a19
 v_mfma_f32_32x32x16_bf16 a[208:223], v[76:79], a[104:107], a[208:223]
 ds_read_b64_tr_b16 v[130:131], v212 offset:1536
 ds_read_b64_tr_b16 v[132:133], v212 offset:5120
 ds_read_b64_tr_b16 v[134:135], v212 offset:6400
 v_accvgpr_read_b32 v164, a20
 v_accvgpr_read_b32 v165, a21
 v_mfma_f32_32x32x16_bf16 a[224:239], v[80:83], a[104:107], a[224:239]
 ds_read_b64_tr_b16 v[136:137], v212 offset:5184
 ds_read_b64_tr_b16 v[138:139], v212 offset:6464
 ds_read_b64_tr_b16 v[140:141], v212 offset:5248
 buffer_load_dwordx4 v234, s[48:51], s43 offen offset:2048 lds
 v_accvgpr_read_b32 v166, a22
 v_mfma_f32_32x32x16_bf16 a[160:175], v[84:87], a[108:111], a[160:175]
 ds_read_b64_tr_b16 v[142:143], v212 offset:6528
 ds_read_b64_tr_b16 v[144:145], v212 offset:5312
 ds_read_b64_tr_b16 v[146:147], v212 offset:6592
 v_accvgpr_read_b32 v167, a23
 v_mfma_f32_32x32x16_bf16 a[176:191], v[88:91], a[108:111], a[176:191]
 ds_read_b64_tr_b16 v[148:149], v212 offset:5376
 ds_read_b64_tr_b16 v[150:151], v212 offset:6656
 buffer_load_dwordx4 v235, s[48:51], s43 offen offset:3072 lds
 v_cvt_pk_bf16_f32 v184, v160, v161
 v_cvt_pk_bf16_f32 v185, v162, v163
 v_mfma_f32_32x32x16_bf16 a[192:207], v[92:95], a[108:111], a[192:207]
 v_cvt_pk_bf16_f32 v186, v164, v165
 v_mfma_f32_32x32x16_bf16 a[208:223], v[96:99], a[108:111], a[208:223]
 s_add_u32 m0, m0, 4096
 s_nop 0
 buffer_load_dwordx4 v236, s[48:51], s43 offen offset:0 lds
 v_cvt_pk_bf16_f32 v187, v166, v167
 v_mfma_f32_32x32x16_bf16 a[224:239], v[100:103], a[108:111], a[224:239]
 s_mov_b32 s35, 0
 buffer_store_dwordx4 v[184:187], v231, s[60:63], s35 offen offset:2048
 s_waitcnt lgkmcnt(0)
 v_mfma_f32_32x32x16_bf16 a[160:175], v[112:115], a[112:115], a[160:175]
 ds_read_b64_tr_b16 v[64:65], v212 offset:10240
 ds_read_b64_tr_b16 v[66:67], v212 offset:11520
 ds_read_b64_tr_b16 v[68:69], v212 offset:10304
 v_accvgpr_read_b32 v168, a24
 v_accvgpr_read_b32 v169, a25
 v_mfma_f32_32x32x16_bf16 a[176:191], v[116:119], a[112:115], a[176:191]
 ds_read_b64_tr_b16 v[70:71], v212 offset:11584
 ds_read_b64_tr_b16 v[72:73], v212 offset:10368
 ds_read_b64_tr_b16 v[74:75], v212 offset:11648
 v_accvgpr_read_b32 v170, a26
 v_mfma_f32_32x32x16_bf16 a[192:207], v[120:123], a[112:115], a[192:207]
 ds_read_b64_tr_b16 v[76:77], v212 offset:10432
 ds_read_b64_tr_b16 v[78:79], v212 offset:11712
 ds_read_b64_tr_b16 v[80:81], v212 offset:10496
 v_accvgpr_read_b32 v171, a27
 v_mfma_f32_32x32x16_bf16 a[208:223], v[124:127], a[112:115], a[208:223]
 ds_read_b64_tr_b16 v[82:83], v212 offset:11776
 ds_read_b64_tr_b16 v[84:85], v212 offset:15360
 ds_read_b64_tr_b16 v[86:87], v212 offset:16640
 v_accvgpr_read_b32 v172, a28
 v_accvgpr_read_b32 v173, a29
 v_mfma_f32_32x32x16_bf16 a[224:239], v[128:131], a[112:115], a[224:239]
 ds_read_b64_tr_b16 v[88:89], v212 offset:15424
 ds_read_b64_tr_b16 v[90:91], v212 offset:16704
 ds_read_b64_tr_b16 v[92:93], v212 offset:15488
 v_accvgpr_read_b32 v174, a30
 v_mfma_f32_32x32x16_bf16 a[160:175], v[132:135], a[116:119], a[160:175]
 ds_read_b64_tr_b16 v[94:95], v212 offset:16768
 ds_read_b64_tr_b16 v[96:97], v212 offset:15552
 ds_read_b64_tr_b16 v[98:99], v212 offset:16832
 v_accvgpr_read_b32 v175, a31
 v_mfma_f32_32x32x16_bf16 a[176:191], v[136:139], a[116:119], a[176:191]
 ds_read_b64_tr_b16 v[100:101], v212 offset:15616
 ds_read_b64_tr_b16 v[102:103], v212 offset:16896
 v_cvt_pk_bf16_f32 v188, v168, v169
 v_cvt_pk_bf16_f32 v189, v170, v171
 v_mfma_f32_32x32x16_bf16 a[192:207], v[140:143], a[116:119], a[192:207]
 v_cvt_pk_bf16_f32 v190, v172, v173
 v_mfma_f32_32x32x16_bf16 a[208:223], v[144:147], a[116:119], a[208:223]
 v_cvt_pk_bf16_f32 v191, v174, v175
 v_mfma_f32_32x32x16_bf16 a[224:239], v[148:151], a[116:119], a[224:239]
 s_mov_b32 s35, 0
 buffer_store_dwordx4 v[188:191], v231, s[60:63], s35 offen offset:3072
 s_mov_b32 s25, s24
 s_add_u32 s24, s24, 24576
 s_cmp_eq_u32 s24, 147456
 s_cselect_b32 s24, 0, s24
 v_add_u32 v212, s24, v237
 s_mov_b32 s43, 164480
 s_waitcnt vmcnt(24) lgkmcnt(0)
 s_barrier
 v_mfma_f32_32x32x16_bf16 a[160:175], v[64:67], a[120:123], a[160:175]
 ds_read_b64_tr_b16 v[112:113], v212 offset:0
 ds_read_b64_tr_b16 v[114:115], v212 offset:1280
 ds_read_b64_tr_b16 v[116:117], v212 offset:64
 s_add_u32 m0, s25, s42
 s_nop 0
 buffer_load_dwordx4 v232, s[48:51], s43 offen offset:0 lds
 v_accvgpr_read_b32 v160, a32
 v_accvgpr_read_b32 v161, a33
 v_mfma_f32_32x32x16_bf16 a[176:191], v[68:71], a[120:123], a[176:191]
 ds_read_b64_tr_b16 v[118:119], v212 offset:1344
 ds_read_b64_tr_b16 v[120:121], v212 offset:128
 ds_read_b64_tr_b16 v[122:123], v212 offset:1408
 v_accvgpr_read_b32 v162, a34
 v_mfma_f32_32x32x16_bf16 a[192:207], v[72:75], a[120:123], a[192:207]
 ds_read_b64_tr_b16 v[124:125], v212 offset:192
 ds_read_b64_tr_b16 v[126:127], v212 offset:1472
 ds_read_b64_tr_b16 v[128:129], v212 offset:256
 buffer_load_dwordx4 v233, s[48:51], s43 offen offset:1024 lds
 v_accvgpr_read_b32 v163, a35
 v_mfma_f32_32x32x16_bf16 a[208:223], v[76:79], a[120:123], a[208:223]
 ds_read_b64_tr_b16 v[130:131], v212 offset:1536
 ds_read_b64_tr_b16 v[132:133], v212 offset:5120
 ds_read_b64_tr_b16 v[134:135], v212 offset:6400
 v_accvgpr_read_b32 v164, a36
 v_accvgpr_read_b32 v165, a37
 v_mfma_f32_32x32x16_bf16 a[224:239], v[80:83], a[120:123], a[224:239]
 ds_read_b64_tr_b16 v[136:137], v212 offset:5184
 ds_read_b64_tr_b16 v[138:139], v212 offset:6464
 ds_read_b64_tr_b16 v[140:141], v212 offset:5248
 buffer_load_dwordx4 v234, s[48:51], s43 offen offset:2048 lds
 v_accvgpr_read_b32 v166, a38
 v_mfma_f32_32x32x16_bf16 a[160:175], v[84:87], a[124:127], a[160:175]
 ds_read_b64_tr_b16 v[142:143], v212 offset:6528
 ds_read_b64_tr_b16 v[144:145], v212 offset:5312
 ds_read_b64_tr_b16 v[146:147], v212 offset:6592
 v_accvgpr_read_b32 v167, a39
 v_mfma_f32_32x32x16_bf16 a[176:191], v[88:91], a[124:127], a[176:191]
 ds_read_b64_tr_b16 v[148:149], v212 offset:5376
 ds_read_b64_tr_b16 v[150:151], v212 offset:6656
 buffer_load_dwordx4 v235, s[48:51], s43 offen offset:3072 lds
 v_cvt_pk_bf16_f32 v176, v160, v161
 v_cvt_pk_bf16_f32 v177, v162, v163
 v_mfma_f32_32x32x16_bf16 a[192:207], v[92:95], a[124:127], a[192:207]
 v_cvt_pk_bf16_f32 v178, v164, v165
 v_mfma_f32_32x32x16_bf16 a[208:223], v[96:99], a[124:127], a[208:223]
 s_add_u32 m0, m0, 4096
 s_nop 0
 buffer_load_dwordx4 v236, s[48:51], s43 offen offset:0 lds
 v_cvt_pk_bf16_f32 v179, v166, v167
 v_mfma_f32_32x32x16_bf16 a[224:239], v[100:103], a[124:127], a[224:239]
 s_mov_b32 s35, 4096
 buffer_store_dwordx4 v[176:179], v231, s[60:63], s35 offen offset:0
 s_waitcnt lgkmcnt(0)
 v_mfma_f32_32x32x16_bf16 a[160:175], v[112:115], v[16:19], a[160:175]
 ds_read_b64_tr_b16 v[64:65], v212 offset:10240
 ds_read_b64_tr_b16 v[66:67], v212 offset:11520
 ds_read_b64_tr_b16 v[68:69], v212 offset:10304
 v_accvgpr_read_b32 v168, a40
 v_accvgpr_read_b32 v169, a41
 v_mfma_f32_32x32x16_bf16 a[176:191], v[116:119], v[16:19], a[176:191]
 ds_read_b64_tr_b16 v[70:71], v212 offset:11584
 ds_read_b64_tr_b16 v[72:73], v212 offset:10368
 ds_read_b64_tr_b16 v[74:75], v212 offset:11648
 v_accvgpr_read_b32 v170, a42
 v_mfma_f32_32x32x16_bf16 a[192:207], v[120:123], v[16:19], a[192:207]
 ds_read_b64_tr_b16 v[76:77], v212 offset:10432
 ds_read_b64_tr_b16 v[78:79], v212 offset:11712
 ds_read_b64_tr_b16 v[80:81], v212 offset:10496
 v_accvgpr_read_b32 v171, a43
 v_mfma_f32_32x32x16_bf16 a[208:223], v[124:127], v[16:19], a[208:223]
 ds_read_b64_tr_b16 v[82:83], v212 offset:11776
 ds_read_b64_tr_b16 v[84:85], v212 offset:15360
 ds_read_b64_tr_b16 v[86:87], v212 offset:16640
 v_accvgpr_read_b32 v172, a44
 v_accvgpr_read_b32 v173, a45
 v_mfma_f32_32x32x16_bf16 a[224:239], v[128:131], v[16:19], a[224:239]
 ds_read_b64_tr_b16 v[88:89], v212 offset:15424
 ds_read_b64_tr_b16 v[90:91], v212 offset:16704
 ds_read_b64_tr_b16 v[92:93], v212 offset:15488
 v_accvgpr_read_b32 v174, a46
 v_mfma_f32_32x32x16_bf16 a[160:175], v[132:135], v[20:23], a[160:175]
 ds_read_b64_tr_b16 v[94:95], v212 offset:16768
 ds_read_b64_tr_b16 v[96:97], v212 offset:15552
 ds_read_b64_tr_b16 v[98:99], v212 offset:16832
 v_accvgpr_read_b32 v175, a47
 v_mfma_f32_32x32x16_bf16 a[176:191], v[136:139], v[20:23], a[176:191]
 ds_read_b64_tr_b16 v[100:101], v212 offset:15616
 ds_read_b64_tr_b16 v[102:103], v212 offset:16896
 v_cvt_pk_bf16_f32 v180, v168, v169
 v_cvt_pk_bf16_f32 v181, v170, v171
 v_mfma_f32_32x32x16_bf16 a[192:207], v[140:143], v[20:23], a[192:207]
 v_cvt_pk_bf16_f32 v182, v172, v173
 v_mfma_f32_32x32x16_bf16 a[208:223], v[144:147], v[20:23], a[208:223]
 v_cvt_pk_bf16_f32 v183, v174, v175
 v_mfma_f32_32x32x16_bf16 a[224:239], v[148:151], v[20:23], a[224:239]
 s_mov_b32 s35, 4096
 buffer_store_dwordx4 v[180:183], v231, s[60:63], s35 offen offset:1024
 s_mov_b32 s25, s24
 s_add_u32 s24, s24, 24576
 s_cmp_eq_u32 s24, 147456
 s_cselect_b32 s24, 0, s24
 v_add_u32 v212, s24, v237
 s_mov_b32 s43, 246400
 s_waitcnt vmcnt(26) lgkmcnt(0)
 s_barrier
 v_mfma_f32_32x32x16_bf16 a[160:175], v[64:67], v[24:27], a[160:175]
 ds_read_b64_tr_b16 v[112:113], v212 offset:0
 ds_read_b64_tr_b16 v[114:115], v212 offset:1280
 ds_read_b64_tr_b16 v[116:117], v212 offset:64
 s_add_u32 m0, s25, s42
 s_nop 0
 buffer_load_dwordx4 v232, s[48:51], s43 offen offset:0 lds
 v_accvgpr_read_b32 v160, a48
 v_accvgpr_read_b32 v161, a49
 v_mfma_f32_32x32x16_bf16 a[176:191], v[68:71], v[24:27], a[176:191]
 ds_read_b64_tr_b16 v[118:119], v212 offset:1344
 ds_read_b64_tr_b16 v[120:121], v212 offset:128
 ds_read_b64_tr_b16 v[122:123], v212 offset:1408
 v_accvgpr_read_b32 v162, a50
 v_mfma_f32_32x32x16_bf16 a[192:207], v[72:75], v[24:27], a[192:207]
 ds_read_b64_tr_b16 v[124:125], v212 offset:192
 ds_read_b64_tr_b16 v[126:127], v212 offset:1472
 ds_read_b64_tr_b16 v[128:129], v212 offset:256
 buffer_load_dwordx4 v233, s[48:51], s43 offen offset:1024 lds
 v_accvgpr_read_b32 v163, a51
 v_mfma_f32_32x32x16_bf16 a[208:223], v[76:79], v[24:27], a[208:223]
 ds_read_b64_tr_b16 v[130:131], v212 offset:1536
 ds_read_b64_tr_b16 v[132:133], v212 offset:5120
 ds_read_b64_tr_b16 v[134:135], v212 offset:6400
 v_accvgpr_read_b32 v164, a52
 v_accvgpr_read_b32 v165, a53
 v_mfma_f32_32x32x16_bf16 a[224:239], v[80:83], v[24:27], a[224:239]
 ds_read_b64_tr_b16 v[136:137], v212 offset:5184
 ds_read_b64_tr_b16 v[138:139], v212 offset:6464
 ds_read_b64_tr_b16 v[140:141], v212 offset:5248
 buffer_load_dwordx4 v234, s[48:51], s43 offen offset:2048 lds
 v_accvgpr_read_b32 v166, a54
 v_mfma_f32_32x32x16_bf16 a[160:175], v[84:87], v[28:31], a[160:175]
 ds_read_b64_tr_b16 v[142:143], v212 offset:6528
 ds_read_b64_tr_b16 v[144:145], v212 offset:5312
 ds_read_b64_tr_b16 v[146:147], v212 offset:6592
 v_accvgpr_read_b32 v167, a55
 v_mfma_f32_32x32x16_bf16 a[176:191], v[88:91], v[28:31], a[176:191]
 ds_read_b64_tr_b16 v[148:149], v212 offset:5376
 ds_read_b64_tr_b16 v[150:151], v212 offset:6656
 buffer_load_dwordx4 v235, s[48:51], s43 offen offset:3072 lds
 v_cvt_pk_bf16_f32 v184, v160, v161
 v_cvt_pk_bf16_f32 v185, v162, v163
 v_mfma_f32_32x32x16_bf16 a[192:207], v[92:95], v[28:31], a[192:207]
 v_cvt_pk_bf16_f32 v186, v164, v165
 v_mfma_f32_32x32x16_bf16 a[208:223], v[96:99], v[28:31], a[208:223]
 s_add_u32 m0, m0, 4096
 s_nop 0
 buffer_load_dwordx4 v236, s[48:51], s43 offen offset:0 lds
 v_cvt_pk_bf16_f32 v187, v166, v167
 v_mfma_f32_32x32x16_bf16 a[224:239], v[100:103], v[28:31], a[224:239]
 s_mov_b32 s35, 4096
 buffer_store_dwordx4 v[184:187], v231, s[60:63], s35 offen offset:2048
 s_waitcnt lgkmcnt(0)
 v_mfma_f32_32x32x16_bf16 a[160:175], v[112:115], v[32:35], a[160:175]
 ds_read_b64_tr_b16 v[64:65], v212 offset:10240
 ds_read_b64_tr_b16 v[66:67], v212 offset:11520
 ds_read_b64_tr_b16 v[68:69], v212 offset:10304
 v_accvgpr_read_b32 v168, a56
 v_accvgpr_read_b32 v169, a57
 v_mfma_f32_32x32x16_bf16 a[176:191], v[116:119], v[32:35], a[176:191]
 ds_read_b64_tr_b16 v[70:71], v212 offset:11584
 ds_read_b64_tr_b16 v[72:73], v212 offset:10368
 ds_read_b64_tr_b16 v[74:75], v212 offset:11648
 v_accvgpr_read_b32 v170, a58
 v_mfma_f32_32x32x16_bf16 a[192:207], v[120:123], v[32:35], a[192:207]
 ds_read_b64_tr_b16 v[76:77], v212 offset:10432
 ds_read_b64_tr_b16 v[78:79], v212 offset:11712
 ds_read_b64_tr_b16 v[80:81], v212 offset:10496
 v_accvgpr_read_b32 v171, a59
 v_mfma_f32_32x32x16_bf16 a[208:223], v[124:127], v[32:35], a[208:223]
 ds_read_b64_tr_b16 v[82:83], v212 offset:11776
 ds_read_b64_tr_b16 v[84:85], v212 offset:15360
 ds_read_b64_tr_b16 v[86:87], v212 offset:16640
 v_accvgpr_read_b32 v172, a60
 v_accvgpr_read_b32 v173, a61
 v_mfma_f32_32x32x16_bf16 a[224:239], v[128:131], v[32:35], a[224:239]
 ds_read_b64_tr_b16 v[88:89], v212 offset:15424
 ds_read_b64_tr_b16 v[90:91], v212 offset:16704
 ds_read_b64_tr_b16 v[92:93], v212 offset:15488
 v_accvgpr_read_b32 v174, a62
 v_mfma_f32_32x32x16_bf16 a[160:175], v[132:135], v[36:39], a[160:175]
 ds_read_b64_tr_b16 v[94:95], v212 offset:16768
 ds_read_b64_tr_b16 v[96:97], v212 offset:15552
 ds_read_b64_tr_b16 v[98:99], v212 offset:16832
 v_accvgpr_read_b32 v175, a63
 v_mfma_f32_32x32x16_bf16 a[176:191], v[136:139], v[36:39], a[176:191]
 ds_read_b64_tr_b16 v[100:101], v212 offset:15616
 ds_read_b64_tr_b16 v[102:103], v212 offset:16896
 v_cvt_pk_bf16_f32 v188, v168, v169
 v_cvt_pk_bf16_f32 v189, v170, v171
 v_mfma_f32_32x32x16_bf16 a[192:207], v[140:143], v[36:39], a[192:207]
 v_cvt_pk_bf16_f32 v190, v172, v173
 v_mfma_f32_32x32x16_bf16 a[208:223], v[144:147], v[36:39], a[208:223]
 v_cvt_pk_bf16_f32 v191, v174, v175
 v_mfma_f32_32x32x16_bf16 a[224:239], v[148:151], v[36:39], a[224:239]
 s_mov_b32 s35, 4096
 buffer_store_dwordx4 v[188:191], v231, s[60:63], s35 offen offset:3072
 s_mov_b32 s25, s24
 s_add_u32 s24, s24, 24576
 s_cmp_eq_u32 s24, 147456
 s_cselect_b32 s24, 0, s24
 v_add_u32 v212, s24, v237
 s_mov_b32 s43, 328320
 s_waitcnt vmcnt(28) lgkmcnt(0)
 s_barrier
 v_mfma_f32_32x32x16_bf16 a[160:175], v[64:67], v[40:43], a[160:175]
 ds_read_b64_tr_b16 v[112:113], v212 offset:0
 ds_read_b64_tr_b16 v[114:115], v212 offset:1280
 ds_read_b64_tr_b16 v[116:117], v212 offset:64
 s_add_u32 m0, s25, s42
 s_nop 0
 buffer_load_dwordx4 v232, s[48:51], s43 offen offset:0 lds
 v_accvgpr_read_b32 v160, a64
 v_accvgpr_read_b32 v161, a65
 v_mfma_f32_32x32x16_bf16 a[176:191], v[68:71], v[40:43], a[176:191]
 ds_read_b64_tr_b16 v[118:119], v212 offset:1344
 ds_read_b64_tr_b16 v[120:121], v212 offset:128
 ds_read_b64_tr_b16 v[122:123], v212 offset:1408
 v_accvgpr_read_b32 v162, a66
 v_mfma_f32_32x32x16_bf16 a[192:207], v[72:75], v[40:43], a[192:207]
 ds_read_b64_tr_b16 v[124:125], v212 offset:192
 ds_read_b64_tr_b16 v[126:127], v212 offset:1472
 ds_read_b64_tr_b16 v[128:129], v212 offset:256
 buffer_load_dwordx4 v233, s[48:51], s43 offen offset:1024 lds
 v_accvgpr_read_b32 v163, a67
 v_mfma_f32_32x32x16_bf16 a[208:223], v[76:79], v[40:43], a[208:223]
 ds_read_b64_tr_b16 v[130:131], v212 offset:1536
 ds_read_b64_tr_b16 v[132:133], v212 offset:5120
 ds_read_b64_tr_b16 v[134:135], v212 offset:6400
 v_accvgpr_read_b32 v164, a68
 v_accvgpr_read_b32 v165, a69
 v_mfma_f32_32x32x16_bf16 a[224:239], v[80:83], v[40:43], a[224:239]
 ds_read_b64_tr_b16 v[136:137], v212 offset:5184
 ds_read_b64_tr_b16 v[138:139], v212 offset:6464
 ds_read_b64_tr_b16 v[140:141], v212 offset:5248
 buffer_load_dwordx4 v234, s[48:51], s43 offen offset:2048 lds
 v_accvgpr_read_b32 v166, a70
 v_mfma_f32_32x32x16_bf16 a[160:175], v[84:87], v[44:47], a[160:175]
 ds_read_b64_tr_b16 v[142:143], v212 offset:6528
 ds_read_b64_tr_b16 v[144:145], v212 offset:5312
 ds_read_b64_tr_b16 v[146:147], v212 offset:6592
 v_accvgpr_read_b32 v167, a71
 v_mfma_f32_32x32x16_bf16 a[176:191], v[88:91], v[44:47], a[176:191]
 ds_read_b64_tr_b16 v[148:149], v212 offset:5376
 ds_read_b64_tr_b16 v[150:151], v212 offset:6656
 buffer_load_dwordx4 v235, s[48:51], s43 offen offset:3072 lds
 v_cvt_pk_bf16_f32 v176, v160, v161
 v_cvt_pk_bf16_f32 v177, v162, v163
 v_mfma_f32_32x32x16_bf16 a[192:207], v[92:95], v[44:47], a[192:207]
 v_cvt_pk_bf16_f32 v178, v164, v165
 v_mfma_f32_32x32x16_bf16 a[208:223], v[96:99], v[44:47], a[208:223]
 s_add_u32 m0, m0, 4096
 s_nop 0
 buffer_load_dwordx4 v236, s[48:51], s43 offen offset:0 lds
 v_cvt_pk_bf16_f32 v179, v166, v167
 v_mfma_f32_32x32x16_bf16 a[224:239], v[100:103], v[44:47], a[224:239]
 s_mov_b32 s35, 8192
 buffer_store_dwordx4 v[176:179], v231, s[60:63], s35 offen offset:0
 s_waitcnt lgkmcnt(0)
 v_mfma_f32_32x32x16_bf16 a[160:175], v[112:115], v[48:51], a[160:175]
 ds_read_b64_tr_b16 v[64:65], v212 offset:10240
 ds_read_b64_tr_b16 v[66:67], v212 offset:11520
 ds_read_b64_tr_b16 v[68:69], v212 offset:10304
 v_accvgpr_read_b32 v168, a72
 v_accvgpr_read_b32 v169, a73
 v_mfma_f32_32x32x16_bf16 a[176:191], v[116:119], v[48:51], a[176:191]
 ds_read_b64_tr_b16 v[70:71], v212 offset:11584
 ds_read_b64_tr_b16 v[72:73], v212 offset:10368
 ds_read_b64_tr_b16 v[74:75], v212 offset:11648
 v_accvgpr_read_b32 v170, a74
 v_mfma_f32_32x32x16_bf16 a[192:207], v[120:123], v[48:51], a[192:207]
 ds_read_b64_tr_b16 v[76:77], v212 offset:10432
 ds_read_b64_tr_b16 v[78:79], v212 offset:11712
 ds_read_b64_tr_b16 v[80:81], v212 offset:10496
 v_accvgpr_read_b32 v171, a75
 v_mfma_f32_32x32x16_bf16 a[208:223], v[124:127], v[48:51], a[208:223]
 ds_read_b64_tr_b16 v[82:83], v212 offset:11776
 ds_read_b64_tr_b16 v[84:85], v212 offset:15360
 ds_read_b64_tr_b16 v[86:87], v212 offset:16640
 v_accvgpr_read_b32 v172, a76
 v_accvgpr_read_b32 v173, a77
 v_mfma_f32_32x32x16_bf16 a[224:239], v[128:131], v[48:51], a[224:239]
 ds_read_b64_tr_b16 v[88:89], v212 offset:15424
 ds_read_b64_tr_b16 v[90:91], v212 offset:16704
 ds_read_b64_tr_b16 v[92:93], v212 offset:15488
 v_accvgpr_read_b32 v174, a78
 v_mfma_f32_32x32x16_bf16 a[160:175], v[132:135], v[52:55], a[160:175]
 ds_read_b64_tr_b16 v[94:95], v212 offset:16768
 ds_read_b64_tr_b16 v[96:97], v212 offset:15552
 ds_read_b64_tr_b16 v[98:99], v212 offset:16832
 v_accvgpr_read_b32 v175, a79
 v_mfma_f32_32x32x16_bf16 a[176:191], v[136:139], v[52:55], a[176:191]
 ds_read_b64_tr_b16 v[100:101], v212 offset:15616
 ds_read_b64_tr_b16 v[102:103], v212 offset:16896
 v_cvt_pk_bf16_f32 v180, v168, v169
 v_cvt_pk_bf16_f32 v181, v170, v171
 v_mfma_f32_32x32x16_bf16 a[192:207], v[140:143], v[52:55], a[192:207]
 v_cvt_pk_bf16_f32 v182, v172, v173
 v_mfma_f32_32x32x16_bf16 a[208:223], v[144:147], v[52:55], a[208:223]
 v_cvt_pk_bf16_f32 v183, v174, v175
 v_mfma_f32_32x32x16_bf16 a[224:239], v[148:151], v[52:55], a[224:239]
 s_mov_b32 s35, 8192
 buffer_store_dwordx4 v[180:183], v231, s[60:63], s35 offen offset:1024
 s_mov_b32 s25, s24
 s_add_u32 s24, s24, 24576
 s_cmp_eq_u32 s24, 147456
 s_cselect_b32 s24, 0, s24
 v_add_u32 v212, s24, v237
 s_mov_b32 s43, 410240
 s_waitcnt vmcnt(30) lgkmcnt(0)
 s_barrier
 v_mfma_f32_32x32x16_bf16 a[160:175], v[64:67], v[56:59], a[160:175]
 ds_read_b64_tr_b16 v[112:113], v212 offset:0
 ds_read_b64_tr_b16 v[114:115], v212 offset:1280
 ds_read_b64_tr_b16 v[116:117], v212 offset:64
 s_add_u32 m0, s25, s42
 s_nop 0
 buffer_load_dwordx4 v232, s[48:51], s43 offen offset:0 lds
 v_mfma_f32_32x32x16_bf16 a[176:191], v[68:71], v[56:59], a[176:191]
 ds_read_b64_tr_b16 v[118:119], v212 offset:1344
 ds_read_b64_tr_b16 v[120:121], v212 offset:128
 ds_read_b64_tr_b16 v[122:123], v212 offset:1408
 v_mfma_f32_32x32x16_bf16 a[192:207], v[72:75], v[56:59], a[192:207]
 ds_read_b64_tr_b16 v[124:125], v212 offset:192
 ds_read_b64_tr_b16 v[126:127], v212 offset:1472
 ds_read_b64_tr_b16 v[128:129], v212 offset:256
 buffer_load_dwordx4 v233, s[48:51], s43 offen offset:1024 lds
 v_mfma_f32_32x32x16_bf16 a[208:223], v[76:79], v[56:59], a[208:223]
 ds_read_b64_tr_b16 v[130:131], v212 offset:1536
 ds_read_b64_tr_b16 v[132:133], v212 offset:5120
 ds_read_b64_tr_b16 v[134:135], v212 offset:6400
 v_mfma_f32_32x32x16_bf16 a[224:239], v[80:83], v[56:59], a[224:239]
 ds_read_b64_tr_b16 v[136:137], v212 offset:5184
 ds_read_b64_tr_b16 v[138:139], v212 offset:6464
 ds_read_b64_tr_b16 v[140:141], v212 offset:5248
 buffer_load_dwordx4 v234, s[48:51], s43 offen offset:2048 lds
 v_mfma_f32_32x32x16_bf16 a[160:175], v[84:87], v[60:63], a[160:175]
 ds_read_b64_tr_b16 v[142:143], v212 offset:6528
 ds_read_b64_tr_b16 v[144:145], v212 offset:5312
 ds_read_b64_tr_b16 v[146:147], v212 offset:6592
 v_mfma_f32_32x32x16_bf16 a[176:191], v[88:91], v[60:63], a[176:191]
 ds_read_b64_tr_b16 v[148:149], v212 offset:5376
 ds_read_b64_tr_b16 v[150:151], v212 offset:6656
 buffer_load_dwordx4 v235, s[48:51], s43 offen offset:3072 lds
 v_mfma_f32_32x32x16_bf16 a[192:207], v[92:95], v[60:63], a[192:207]
 v_mfma_f32_32x32x16_bf16 a[208:223], v[96:99], v[60:63], a[208:223]
 s_add_u32 m0, m0, 4096
 s_nop 0
 buffer_load_dwordx4 v236, s[48:51], s43 offen offset:0 lds
 v_mfma_f32_32x32x16_bf16 a[224:239], v[100:103], v[60:63], a[224:239]
 s_waitcnt lgkmcnt(0)
 v_mfma_f32_32x32x16_bf16 a[0:15], v[112:115], a[80:83], 0
 ds_read_b64_tr_b16 v[64:65], v212 offset:10240
 ds_read_b64_tr_b16 v[66:67], v212 offset:11520
 ds_read_b64_tr_b16 v[68:69], v212 offset:10304
 v_mfma_f32_32x32x16_bf16 a[16:31], v[116:119], a[80:83], 0
 ds_read_b64_tr_b16 v[70:71], v212 offset:11584
 ds_read_b64_tr_b16 v[72:73], v212 offset:10368
 ds_read_b64_tr_b16 v[74:75], v212 offset:11648
 v_mfma_f32_32x32x16_bf16 a[32:47], v[120:123], a[80:83], 0
 ds_read_b64_tr_b16 v[76:77], v212 offset:10432
 ds_read_b64_tr_b16 v[78:79], v212 offset:11712
 ds_read_b64_tr_b16 v[80:81], v212 offset:10496
 v_mfma_f32_32x32x16_bf16 a[48:63], v[124:127], a[80:83], 0
 ds_read_b64_tr_b16 v[82:83], v212 offset:11776
 ds_read_b64_tr_b16 v[84:85], v212 offset:15360
 ds_read_b64_tr_b16 v[86:87], v212 offset:16640
 v_mfma_f32_32x32x16_bf16 a[64:79], v[128:131], a[80:83], 0
 ds_read_b64_tr_b16 v[88:89], v212 offset:15424
 ds_read_b64_tr_b16 v[90:91], v212 offset:16704
 ds_read_b64_tr_b16 v[92:93], v212 offset:15488
 v_mfma_f32_32x32x16_bf16 a[0:15], v[132:135], a[84:87], a[0:15]
 ds_read_b64_tr_b16 v[94:95], v212 offset:16768
 ds_read_b64_tr_b16 v[96:97], v212 offset:15552
 ds_read_b64_tr_b16 v[98:99], v212 offset:16832
 v_mfma_f32_32x32x16_bf16 a[16:31], v[136:139], a[84:87], a[16:31]
 ds_read_b64_tr_b16 v[100:101], v212 offset:15616
 ds_read_b64_tr_b16 v[102:103], v212 offset:16896
 v_mfma_f32_32x32x16_bf16 a[32:47], v[140:143], a[84:87], a[32:47]
 v_mfma_f32_32x32x16_bf16 a[48:63], v[144:147], a[84:87], a[48:63]
 v_mfma_f32_32x32x16_bf16 a[64:79], v[148:151], a[84:87], a[64:79]
 s_mov_b32 s25, s24
 s_add_u32 s24, s24, 24576
 s_cmp_eq_u32 s24, 147456
 s_cselect_b32 s24, 0, s24
 v_add_u32 v212, s24, v237
 s_mov_b32 s43, 960
 s_waitcnt vmcnt(28) lgkmcnt(0)
 s_barrier
 v_mfma_f32_32x32x16_bf16 a[0:15], v[64:67], a[88:91], a[0:15]
 ds_read_b64_tr_b16 v[112:113], v212 offset:0
 ds_read_b64_tr_b16 v[114:115], v212 offset:1280
 ds_read_b64_tr_b16 v[116:117], v212 offset:64
 s_add_u32 m0, s25, s42
 s_nop 0
 buffer_load_dwordx4 v232, s[48:51], s43 offen offset:0 lds
 v_accvgpr_read_b32 v160, a160
 v_accvgpr_read_b32 v161, a161
 v_mfma_f32_32x32x16_bf16 a[16:31], v[68:71], a[88:91], a[16:31]
 ds_read_b64_tr_b16 v[118:119], v212 offset:1344
 ds_read_b64_tr_b16 v[120:121], v212 offset:128
 ds_read_b64_tr_b16 v[122:123], v212 offset:1408
 v_accvgpr_read_b32 v162, a162
 v_mfma_f32_32x32x16_bf16 a[32:47], v[72:75], a[88:91], a[32:47]
 ds_read_b64_tr_b16 v[124:125], v212 offset:192
 ds_read_b64_tr_b16 v[126:127], v212 offset:1472
 ds_read_b64_tr_b16 v[128:129], v212 offset:256
 buffer_load_dwordx4 v233, s[48:51], s43 offen offset:1024 lds
 v_accvgpr_read_b32 v163, a163
 v_mfma_f32_32x32x16_bf16 a[48:63], v[76:79], a[88:91], a[48:63]
 ds_read_b64_tr_b16 v[130:131], v212 offset:1536
 ds_read_b64_tr_b16 v[132:133], v212 offset:5120
 ds_read_b64_tr_b16 v[134:135], v212 offset:6400
 v_accvgpr_read_b32 v164, a164
 v_accvgpr_read_b32 v165, a165
 v_mfma_f32_32x32x16_bf16 a[64:79], v[80:83], a[88:91], a[64:79]
 ds_read_b64_tr_b16 v[136:137], v212 offset:5184
 ds_read_b64_tr_b16 v[138:139], v212 offset:6464
 ds_read_b64_tr_b16 v[140:141], v212 offset:5248
 buffer_load_dwordx4 v234, s[48:51], s43 offen offset:2048 lds
 v_accvgpr_read_b32 v166, a166
 v_mfma_f32_32x32x16_bf16 a[0:15], v[84:87], a[92:95], a[0:15]
 ds_read_b64_tr_b16 v[142:143], v212 offset:6528
 ds_read_b64_tr_b16 v[144:145], v212 offset:5312
 ds_read_b64_tr_b16 v[146:147], v212 offset:6592
 v_accvgpr_read_b32 v167, a167
 v_mfma_f32_32x32x16_bf16 a[16:31], v[88:91], a[92:95], a[16:31]
 ds_read_b64_tr_b16 v[148:149], v212 offset:5376
 ds_read_b64_tr_b16 v[150:151], v212 offset:6656
 buffer_load_dwordx4 v235, s[48:51], s43 offen offset:3072 lds
 v_cvt_pk_bf16_f32 v176, v160, v161
 v_cvt_pk_bf16_f32 v177, v162, v163
 v_mfma_f32_32x32x16_bf16 a[32:47], v[92:95], a[92:95], a[32:47]
 v_cvt_pk_bf16_f32 v178, v164, v165
 v_mfma_f32_32x32x16_bf16 a[48:63], v[96:99], a[92:95], a[48:63]
 s_add_u32 m0, m0, 4096
 s_nop 0
 buffer_load_dwordx4 v236, s[48:51], s43 offen offset:0 lds
 v_cvt_pk_bf16_f32 v179, v166, v167
 v_mfma_f32_32x32x16_bf16 a[64:79], v[100:103], a[92:95], a[64:79]
 s_mov_b32 s35, 40960
 buffer_store_dwordx4 v[176:179], v231, s[60:63], s35 offen offset:0
 s_waitcnt lgkmcnt(0)
 v_mfma_f32_32x32x16_bf16 a[0:15], v[112:115], a[96:99], a[0:15]
 ds_read_b64_tr_b16 v[64:65], v212 offset:10240
 ds_read_b64_tr_b16 v[66:67], v212 offset:11520
 ds_read_b64_tr_b16 v[68:69], v212 offset:10304
 v_accvgpr_read_b32 v168, a168
 v_accvgpr_read_b32 v169, a169
 v_mfma_f32_32x32x16_bf16 a[16:31], v[116:119], a[96:99], a[16:31]
 ds_read_b64_tr_b16 v[70:71], v212 offset:11584
 ds_read_b64_tr_b16 v[72:73], v212 offset:10368
 ds_read_b64_tr_b16 v[74:75], v212 offset:11648
 v_accvgpr_read_b32 v170, a170
 v_mfma_f32_32x32x16_bf16 a[32:47], v[120:123], a[96:99], a[32:47]
 ds_read_b64_tr_b16 v[76:77], v212 offset:10432
 ds_read_b64_tr_b16 v[78:79], v212 offset:11712
 ds_read_b64_tr_b16 v[80:81], v212 offset:10496
 v_accvgpr_read_b32 v171, a171
 v_mfma_f32_32x32x16_bf16 a[48:63], v[124:127], a[96:99], a[48:63]
 ds_read_b64_tr_b16 v[82:83], v212 offset:11776
 ds_read_b64_tr_b16 v[84:85], v212 offset:15360
 ds_read_b64_tr_b16 v[86:87], v212 offset:16640
 v_accvgpr_read_b32 v172, a172
 v_accvgpr_read_b32 v173, a173
 v_mfma_f32_32x32x16_bf16 a[64:79], v[128:131], a[96:99], a[64:79]
 ds_read_b64_tr_b16 v[88:89], v212 offset:15424
 ds_read_b64_tr_b16 v[90:91], v212 offset:16704
 ds_read_b64_tr_b16 v[92:93], v212 offset:15488
 v_accvgpr_read_b32 v174, a174
 v_mfma_f32_32x32x16_bf16 a[0:15], v[132:135], a[100:103], a[0:15]
 ds_read_b64_tr_b16 v[94:95], v212 offset:16768
 ds_read_b64_tr_b16 v[96:97], v212 offset:15552
 ds_read_b64_tr_b16 v[98:99], v212 offset:16832
 v_accvgpr_read_b32 v175, a175
 v_mfma_f32_32x32x16_bf16 a[16:31], v[136:139], a[100:103], a[16:31]
 ds_read_b64_tr_b16 v[100:101], v212 offset:15616
 ds_read_b64_tr_b16 v[102:103], v212 offset:16896
 v_cvt_pk_bf16_f32 v180, v168, v169
 v_cvt_pk_bf16_f32 v181, v170, v171
 v_mfma_f32_32x32x16_bf16 a[32:47], v[140:143], a[100:103], a[32:47]
 v_cvt_pk_bf16_f32 v182, v172, v173
 v_mfma_f32_32x32x16_bf16 a[48:63], v[144:147], a[100:103], a[48:63]
 v_cvt_pk_bf16_f32 v183, v174, v175
 v_mfma_f32_32x32x16_bf16 a[64:79], v[148:151], a[100:103], a[64:79]
 s_mov_b32 s35, 40960
 buffer_store_dwordx4 v[180:183], v231, s[60:63], s35 offen offset:1024
 s_mov_b32 s25, s24
 s_add_u32 s24, s24, 24576
 s_cmp_eq_u32 s24, 147456
 s_cselect_b32 s24, 0, s24
 v_add_u32 v212, s24, v237
 s_mov_b32 s43, 82880
 s_waitcnt vmcnt(28) lgkmcnt(0)
 s_barrier
 v_mfma_f32_32x32x16_bf16 a[0:15], v[64:67], a[104:107], a[0:15]
 ds_read_b64_tr_b16 v[112:113], v212 offset:0
 ds_read_b64_tr_b16 v[114:115], v212 offset:1280
 ds_read_b64_tr_b16 v[116:117], v212 offset:64
 s_add_u32 m0, s25, s42
 s_nop 0
 buffer_load_dwordx4 v232, s[48:51], s43 offen offset:0 lds
 v_accvgpr_read_b32 v160, a176
 v_accvgpr_read_b32 v161, a177
 v_mfma_f32_32x32x16_bf16 a[16:31], v[68:71], a[104:107], a[16:31]
 ds_read_b64_tr_b16 v[118:119], v212 offset:1344
 ds_read_b64_tr_b16 v[120:121], v212 offset:128
 ds_read_b64_tr_b16 v[122:123], v212 offset:1408
 v_accvgpr_read_b32 v162, a178
 v_mfma_f32_32x32x16_bf16 a[32:47], v[72:75], a[104:107], a[32:47]
 ds_read_b64_tr_b16 v[124:125], v212 offset:192
 ds_read_b64_tr_b16 v[126:127], v212 offset:1472
 ds_read_b64_tr_b16 v[128:129], v212 offset:256
 buffer_load_dwordx4 v233, s[48:51], s43 offen offset:1024 lds
 v_accvgpr_read_b32 v163, a179
 v_mfma_f32_32x32x16_bf16 a[48:63], v[76:79], a[104:107], a[48:63]
 ds_read_b64_tr_b16 v[130:131], v212 offset:1536
 ds_read_b64_tr_b16 v[132:133], v212 offset:5120
 ds_read_b64_tr_b16 v[134:135], v212 offset:6400
 v_accvgpr_read_b32 v164, a180
 v_accvgpr_read_b32 v165, a181
 v_mfma_f32_32x32x16_bf16 a[64:79], v[80:83], a[104:107], a[64:79]
 ds_read_b64_tr_b16 v[136:137], v212 offset:5184
 ds_read_b64_tr_b16 v[138:139], v212 offset:6464
 ds_read_b64_tr_b16 v[140:141], v212 offset:5248
 buffer_load_dwordx4 v234, s[48:51], s43 offen offset:2048 lds
 v_accvgpr_read_b32 v166, a182
 v_mfma_f32_32x32x16_bf16 a[0:15], v[84:87], a[108:111], a[0:15]
 ds_read_b64_tr_b16 v[142:143], v212 offset:6528
 ds_read_b64_tr_b16 v[144:145], v212 offset:5312
 ds_read_b64_tr_b16 v[146:147], v212 offset:6592
 v_accvgpr_read_b32 v167, a183
 v_mfma_f32_32x32x16_bf16 a[16:31], v[88:91], a[108:111], a[16:31]
 ds_read_b64_tr_b16 v[148:149], v212 offset:5376
 ds_read_b64_tr_b16 v[150:151], v212 offset:6656
 buffer_load_dwordx4 v235, s[48:51], s43 offen offset:3072 lds
 v_cvt_pk_bf16_f32 v184, v160, v161
 v_cvt_pk_bf16_f32 v185, v162, v163
 v_mfma_f32_32x32x16_bf16 a[32:47], v[92:95], a[108:111], a[32:47]
 v_cvt_pk_bf16_f32 v186, v164, v165
 v_mfma_f32_32x32x16_bf16 a[48:63], v[96:99], a[108:111], a[48:63]
 s_add_u32 m0, m0, 4096
 s_nop 0
 buffer_load_dwordx4 v236, s[48:51], s43 offen offset:0 lds
 v_cvt_pk_bf16_f32 v187, v166, v167
 v_mfma_f32_32x32x16_bf16 a[64:79], v[100:103], a[108:111], a[64:79]
 s_mov_b32 s35, 40960
 buffer_store_dwordx4 v[184:187], v231, s[60:63], s35 offen offset:2048
 s_waitcnt lgkmcnt(0)
 v_mfma_f32_32x32x16_bf16 a[0:15], v[112:115], a[112:115], a[0:15]
 ds_read_b64_tr_b16 v[64:65], v212 offset:10240
 ds_read_b64_tr_b16 v[66:67], v212 offset:11520
 ds_read_b64_tr_b16 v[68:69], v212 offset:10304
 v_accvgpr_read_b32 v168, a184
 v_accvgpr_read_b32 v169, a185
 v_mfma_f32_32x32x16_bf16 a[16:31], v[116:119], a[112:115], a[16:31]
 ds_read_b64_tr_b16 v[70:71], v212 offset:11584
 ds_read_b64_tr_b16 v[72:73], v212 offset:10368
 ds_read_b64_tr_b16 v[74:75], v212 offset:11648
 v_accvgpr_read_b32 v170, a186
 v_mfma_f32_32x32x16_bf16 a[32:47], v[120:123], a[112:115], a[32:47]
 ds_read_b64_tr_b16 v[76:77], v212 offset:10432
 ds_read_b64_tr_b16 v[78:79], v212 offset:11712
 ds_read_b64_tr_b16 v[80:81], v212 offset:10496
 v_accvgpr_read_b32 v171, a187
 v_mfma_f32_32x32x16_bf16 a[48:63], v[124:127], a[112:115], a[48:63]
 ds_read_b64_tr_b16 v[82:83], v212 offset:11776
 ds_read_b64_tr_b16 v[84:85], v212 offset:15360
 ds_read_b64_tr_b16 v[86:87], v212 offset:16640
 v_accvgpr_read_b32 v172, a188
 v_accvgpr_read_b32 v173, a189
 v_mfma_f32_32x32x16_bf16 a[64:79], v[128:131], a[112:115], a[64:79]
 ds_read_b64_tr_b16 v[88:89], v212 offset:15424
 ds_read_b64_tr_b16 v[90:91], v212 offset:16704
 ds_read_b64_tr_b16 v[92:93], v212 offset:15488
 v_accvgpr_read_b32 v174, a190
 v_mfma_f32_32x32x16_bf16 a[0:15], v[132:135], a[116:119], a[0:15]
 ds_read_b64_tr_b16 v[94:95], v212 offset:16768
 ds_read_b64_tr_b16 v[96:97], v212 offset:15552
 ds_read_b64_tr_b16 v[98:99], v212 offset:16832
 v_accvgpr_read_b32 v175, a191
 v_mfma_f32_32x32x16_bf16 a[16:31], v[136:139], a[116:119], a[16:31]
 ds_read_b64_tr_b16 v[100:101], v212 offset:15616
 ds_read_b64_tr_b16 v[102:103], v212 offset:16896
 v_cvt_pk_bf16_f32 v188, v168, v169
 v_cvt_pk_bf16_f32 v189, v170, v171
 v_mfma_f32_32x32x16_bf16 a[32:47], v[140:143], a[116:119], a[32:47]
 v_cvt_pk_bf16_f32 v190, v172, v173
 v_mfma_f32_32x32x16_bf16 a[48:63], v[144:147], a[116:119], a[48:63]
 v_cvt_pk_bf16_f32 v191, v174, v175
 v_mfma_f32_32x32x16_bf16 a[64:79], v[148:151], a[116:119], a[64:79]
 s_mov_b32 s35, 40960
 buffer_store_dwordx4 v[188:191], v231, s[60:63], s35 offen offset:3072
 s_mov_b32 s25, s24
 s_add_u32 s24, s24, 24576
 s_cmp_eq_u32 s24, 147456
 s_cselect_b32 s24, 0, s24
 v_add_u32 v212, s24, v237
 s_mov_b32 s43, 164800
 s_waitcnt vmcnt(28) lgkmcnt(0)
 s_barrier
 v_mfma_f32_32x32x16_bf16 a[0:15], v[64:67], a[120:123], a[0:15]
 ds_read_b64_tr_b16 v[112:113], v212 offset:0
 ds_read_b64_tr_b16 v[114:115], v212 offset:1280
 ds_read_b64_tr_b16 v[116:117], v212 offset:64
 s_add_u32 m0, s25, s42
 s_nop 0
 buffer_load_dwordx4 v232, s[48:51], s43 offen offset:0 lds
 v_accvgpr_read_b32 v160, a192
 v_accvgpr_read_b32 v161, a193
 v_mfma_f32_32x32x16_bf16 a[16:31], v[68:71], a[120:123], a[16:31]
 ds_read_b64_tr_b16 v[118:119], v212 offset:1344
 ds_read_b64_tr_b16 v[120:121], v212 offset:128
 ds_read_b64_tr_b16 v[122:123], v212 offset:1408
 v_accvgpr_read_b32 v162, a194
 v_mfma_f32_32x32x16_bf16 a[32:47], v[72:75], a[120:123], a[32:47]
 ds_read_b64_tr_b16 v[124:125], v212 offset:192
 ds_read_b64_tr_b16 v[126:127], v212 offset:1472
 ds_read_b64_tr_b16 v[128:129], v212 offset:256
 buffer_load_dwordx4 v233, s[48:51], s43 offen offset:1024 lds
 v_accvgpr_read_b32 v163, a195
 v_mfma_f32_32x32x16_bf16 a[48:63], v[76:79], a[120:123], a[48:63]
 ds_read_b64_tr_b16 v[130:131], v212 offset:1536
 ds_read_b64_tr_b16 v[132:133], v212 offset:5120
 ds_read_b64_tr_b16 v[134:135], v212 offset:6400
 v_accvgpr_read_b32 v164, a196
 v_accvgpr_read_b32 v165, a197
 v_mfma_f32_32x32x16_bf16 a[64:79], v[80:83], a[120:123], a[64:79]
 ds_read_b64_tr_b16 v[136:137], v212 offset:5184
 ds_read_b64_tr_b16 v[138:139], v212 offset:6464
 ds_read_b64_tr_b16 v[140:141], v212 offset:5248
 buffer_load_dwordx4 v234, s[48:51], s43 offen offset:2048 lds
 v_accvgpr_read_b32 v166, a198
 v_mfma_f32_32x32x16_bf16 a[0:15], v[84:87], a[124:127], a[0:15]
 ds_read_b64_tr_b16 v[142:143], v212 offset:6528
 ds_read_b64_tr_b16 v[144:145], v212 offset:5312
 ds_read_b64_tr_b16 v[146:147], v212 offset:6592
 v_accvgpr_read_b32 v167, a199
 v_mfma_f32_32x32x16_bf16 a[16:31], v[88:91], a[124:127], a[16:31]
 ds_read_b64_tr_b16 v[148:149], v212 offset:5376
 ds_read_b64_tr_b16 v[150:151], v212 offset:6656
 buffer_load_dwordx4 v235, s[48:51], s43 offen offset:3072 lds
 v_cvt_pk_bf16_f32 v176, v160, v161
 v_cvt_pk_bf16_f32 v177, v162, v163
 v_mfma_f32_32x32x16_bf16 a[32:47], v[92:95], a[124:127], a[32:47]
 v_cvt_pk_bf16_f32 v178, v164, v165
 v_mfma_f32_32x32x16_bf16 a[48:63], v[96:99], a[124:127], a[48:63]
 s_add_u32 m0, m0, 4096
 s_nop 0
 buffer_load_dwordx4 v236, s[48:51], s43 offen offset:0 lds
 v_cvt_pk_bf16_f32 v179, v166, v167
 v_mfma_f32_32x32x16_bf16 a[64:79], v[100:103], a[124:127], a[64:79]
 s_mov_b32 s35, 45056
 buffer_store_dwordx4 v[176:179], v231, s[60:63], s35 offen offset:0
 s_waitcnt lgkmcnt(0)
 v_mfma_f32_32x32x16_bf16 a[0:15], v[112:115], v[16:19], a[0:15]
 ds_read_b64_tr_b16 v[64:65], v212 offset:10240
 ds_read_b64_tr_b16 v[66:67], v212 offset:11520
 ds_read_b64_tr_b16 v[68:69], v212 offset:10304
 v_accvgpr_read_b32 v168, a200
 v_accvgpr_read_b32 v169, a201
 v_mfma_f32_32x32x16_bf16 a[16:31], v[116:119], v[16:19], a[16:31]
 ds_read_b64_tr_b16 v[70:71], v212 offset:11584
 ds_read_b64_tr_b16 v[72:73], v212 offset:10368
 ds_read_b64_tr_b16 v[74:75], v212 offset:11648
 v_accvgpr_read_b32 v170, a202
 v_mfma_f32_32x32x16_bf16 a[32:47], v[120:123], v[16:19], a[32:47]
 ds_read_b64_tr_b16 v[76:77], v212 offset:10432
 ds_read_b64_tr_b16 v[78:79], v212 offset:11712
 ds_read_b64_tr_b16 v[80:81], v212 offset:10496
 v_accvgpr_read_b32 v171, a203
 v_mfma_f32_32x32x16_bf16 a[48:63], v[124:127], v[16:19], a[48:63]
 ds_read_b64_tr_b16 v[82:83], v212 offset:11776
 ds_read_b64_tr_b16 v[84:85], v212 offset:15360
 ds_read_b64_tr_b16 v[86:87], v212 offset:16640
 v_accvgpr_read_b32 v172, a204
 v_accvgpr_read_b32 v173, a205
 v_mfma_f32_32x32x16_bf16 a[64:79], v[128:131], v[16:19], a[64:79]
 ds_read_b64_tr_b16 v[88:89], v212 offset:15424
 ds_read_b64_tr_b16 v[90:91], v212 offset:16704
 ds_read_b64_tr_b16 v[92:93], v212 offset:15488
 v_accvgpr_read_b32 v174, a206
 v_mfma_f32_32x32x16_bf16 a[0:15], v[132:135], v[20:23], a[0:15]
 ds_read_b64_tr_b16 v[94:95], v212 offset:16768
 ds_read_b64_tr_b16 v[96:97], v212 offset:15552
 ds_read_b64_tr_b16 v[98:99], v212 offset:16832
 v_accvgpr_read_b32 v175, a207
 v_mfma_f32_32x32x16_bf16 a[16:31], v[136:139], v[20:23], a[16:31]
 ds_read_b64_tr_b16 v[100:101], v212 offset:15616
 ds_read_b64_tr_b16 v[102:103], v212 offset:16896
 v_cvt_pk_bf16_f32 v180, v168, v169
 v_cvt_pk_bf16_f32 v181, v170, v171
 v_mfma_f32_32x32x16_bf16 a[32:47], v[140:143], v[20:23], a[32:47]
 v_cvt_pk_bf16_f32 v182, v172, v173
 v_mfma_f32_32x32x16_bf16 a[48:63], v[144:147], v[20:23], a[48:63]
 v_cvt_pk_bf16_f32 v183, v174, v175
 v_mfma_f32_32x32x16_bf16 a[64:79], v[148:151], v[20:23], a[64:79]
 s_mov_b32 s35, 45056
 buffer_store_dwordx4 v[180:183], v231, s[60:63], s35 offen offset:1024
 s_mov_b32 s25, s24
 s_add_u32 s24, s24, 24576
 s_cmp_eq_u32 s24, 147456
 s_cselect_b32 s24, 0, s24
 v_add_u32 v212, s24, v237
 s_mov_b32 s43, 246720
 s_waitcnt vmcnt(28) lgkmcnt(0)
 s_barrier
 v_mfma_f32_32x32x16_bf16 a[0:15], v[64:67], v[24:27], a[0:15]
 ds_read_b64_tr_b16 v[112:113], v212 offset:0
 ds_read_b64_tr_b16 v[114:115], v212 offset:1280
 ds_read_b64_tr_b16 v[116:117], v212 offset:64
 s_add_u32 m0, s25, s42
 s_nop 0
 buffer_load_dwordx4 v232, s[48:51], s43 offen offset:0 lds
 v_accvgpr_read_b32 v160, a208
 v_accvgpr_read_b32 v161, a209
 v_mfma_f32_32x32x16_bf16 a[16:31], v[68:71], v[24:27], a[16:31]
 ds_read_b64_tr_b16 v[118:119], v212 offset:1344
 ds_read_b64_tr_b16 v[120:121], v212 offset:128
 ds_read_b64_tr_b16 v[122:123], v212 offset:1408
 v_accvgpr_read_b32 v162, a210
 v_mfma_f32_32x32x16_bf16 a[32:47], v[72:75], v[24:27], a[32:47]
 ds_read_b64_tr_b16 v[124:125], v212 offset:192
 ds_read_b64_tr_b16 v[126:127], v212 offset:1472
 ds_read_b64_tr_b16 v[128:129], v212 offset:256
 buffer_load_dwordx4 v233, s[48:51], s43 offen offset:1024 lds
 v_accvgpr_read_b32 v163, a211
 v_mfma_f32_32x32x16_bf16 a[48:63], v[76:79], v[24:27], a[48:63]
 ds_read_b64_tr_b16 v[130:131], v212 offset:1536
 ds_read_b64_tr_b16 v[132:133], v212 offset:5120
 ds_read_b64_tr_b16 v[134:135], v212 offset:6400
 v_accvgpr_read_b32 v164, a212
 v_accvgpr_read_b32 v165, a213
 v_mfma_f32_32x32x16_bf16 a[64:79], v[80:83], v[24:27], a[64:79]
 ds_read_b64_tr_b16 v[136:137], v212 offset:5184
 ds_read_b64_tr_b16 v[138:139], v212 offset:6464
 ds_read_b64_tr_b16 v[140:141], v212 offset:5248
 buffer_load_dwordx4 v234, s[48:51], s43 offen offset:2048 lds
 v_accvgpr_read_b32 v166, a214
 v_mfma_f32_32x32x16_bf16 a[0:15], v[84:87], v[28:31], a[0:15]
 ds_read_b64_tr_b16 v[142:143], v212 offset:6528
 ds_read_b64_tr_b16 v[144:145], v212 offset:5312
 ds_read_b64_tr_b16 v[146:147], v212 offset:6592
 v_accvgpr_read_b32 v167, a215
 v_mfma_f32_32x32x16_bf16 a[16:31], v[88:91], v[28:31], a[16:31]
 ds_read_b64_tr_b16 v[148:149], v212 offset:5376
 ds_read_b64_tr_b16 v[150:151], v212 offset:6656
 buffer_load_dwordx4 v235, s[48:51], s43 offen offset:3072 lds
 v_cvt_pk_bf16_f32 v184, v160, v161
 v_cvt_pk_bf16_f32 v185, v162, v163
 v_mfma_f32_32x32x16_bf16 a[32:47], v[92:95], v[28:31], a[32:47]
 v_cvt_pk_bf16_f32 v186, v164, v165
 v_mfma_f32_32x32x16_bf16 a[48:63], v[96:99], v[28:31], a[48:63]
 s_add_u32 m0, m0, 4096
 s_nop 0
 buffer_load_dwordx4 v236, s[48:51], s43 offen offset:0 lds
 v_cvt_pk_bf16_f32 v187, v166, v167
 v_mfma_f32_32x32x16_bf16 a[64:79], v[100:103], v[28:31], a[64:79]
 s_mov_b32 s35, 45056
 buffer_store_dwordx4 v[184:187], v231, s[60:63], s35 offen offset:2048
 s_waitcnt lgkmcnt(0)
 v_mfma_f32_32x32x16_bf16 a[0:15], v[112:115], v[32:35], a[0:15]
 ds_read_b64_tr_b16 v[64:65], v212 offset:10240
 ds_read_b64_tr_b16 v[66:67], v212 offset:11520
 ds_read_b64_tr_b16 v[68:69], v212 offset:10304
 v_accvgpr_read_b32 v168, a216
 v_accvgpr_read_b32 v169, a217
 v_mfma_f32_32x32x16_bf16 a[16:31], v[116:119], v[32:35], a[16:31]
 ds_read_b64_tr_b16 v[70:71], v212 offset:11584
 ds_read_b64_tr_b16 v[72:73], v212 offset:10368
 ds_read_b64_tr_b16 v[74:75], v212 offset:11648
 v_accvgpr_read_b32 v170, a218
 v_mfma_f32_32x32x16_bf16 a[32:47], v[120:123], v[32:35], a[32:47]
 ds_read_b64_tr_b16 v[76:77], v212 offset:10432
 ds_read_b64_tr_b16 v[78:79], v212 offset:11712
 ds_read_b64_tr_b16 v[80:81], v212 offset:10496
 v_accvgpr_read_b32 v171, a219
 v_mfma_f32_32x32x16_bf16 a[48:63], v[124:127], v[32:35], a[48:63]
 ds_read_b64_tr_b16 v[82:83], v212 offset:11776
 ds_read_b64_tr_b16 v[84:85], v212 offset:15360
 ds_read_b64_tr_b16 v[86:87], v212 offset:16640
 v_accvgpr_read_b32 v172, a220
 v_accvgpr_read_b32 v173, a221
 v_mfma_f32_32x32x16_bf16 a[64:79], v[128:131], v[32:35], a[64:79]
 ds_read_b64_tr_b16 v[88:89], v212 offset:15424
 ds_read_b64_tr_b16 v[90:91], v212 offset:16704
 ds_read_b64_tr_b16 v[92:93], v212 offset:15488
 v_accvgpr_read_b32 v174, a222
 v_mfma_f32_32x32x16_bf16 a[0:15], v[132:135], v[36:39], a[0:15]
 ds_read_b64_tr_b16 v[94:95], v212 offset:16768
 ds_read_b64_tr_b16 v[96:97], v212 offset:15552
 ds_read_b64_tr_b16 v[98:99], v212 offset:16832
 v_accvgpr_read_b32 v175, a223
 v_mfma_f32_32x32x16_bf16 a[16:31], v[136:139], v[36:39], a[16:31]
 ds_read_b64_tr_b16 v[100:101], v212 offset:15616
 ds_read_b64_tr_b16 v[102:103], v212 offset:16896
 v_cvt_pk_bf16_f32 v188, v168, v169
 v_cvt_pk_bf16_f32 v189, v170, v171
 v_mfma_f32_32x32x16_bf16 a[32:47], v[140:143], v[36:39], a[32:47]
 v_cvt_pk_bf16_f32 v190, v172, v173
 v_mfma_f32_32x32x16_bf16 a[48:63], v[144:147], v[36:39], a[48:63]
 v_cvt_pk_bf16_f32 v191, v174, v175
 v_mfma_f32_32x32x16_bf16 a[64:79], v[148:151], v[36:39], a[64:79]
 s_mov_b32 s35, 45056
 buffer_store_dwordx4 v[188:191], v231, s[60:63], s35 offen offset:3072
 s_mov_b32 s25, s24
 s_add_u32 s24, s24, 24576
 s_cmp_eq_u32 s24, 147456
 s_cselect_b32 s24, 0, s24
 v_add_u32 v212, s24, v237
 s_mov_b32 s43, 328640
 s_waitcnt vmcnt(28) lgkmcnt(0)
 s_barrier
 v_mfma_f32_32x32x16_bf16 a[0:15], v[64:67], v[40:43], a[0:15]
 ds_read_b64_tr_b16 v[112:113], v212 offset:0
 ds_read_b64_tr_b16 v[114:115], v212 offset:1280
 ds_read_b64_tr_b16 v[116:117], v212 offset:64
 s_add_u32 m0, s25, s42
 s_nop 0
 buffer_load_dwordx4 v232, s[48:51], s43 offen offset:0 lds
 v_accvgpr_read_b32 v160, a224
 v_accvgpr_read_b32 v161, a225
 v_mfma_f32_32x32x16_bf16 a[16:31], v[68:71], v[40:43], a[16:31]
 ds_read_b64_tr_b16 v[118:119], v212 offset:1344
 ds_read_b64_tr_b16 v[120:121], v212 offset:128
 ds_read_b64_tr_b16 v[122:123], v212 offset:1408
 v_accvgpr_read_b32 v162, a226
 v_mfma_f32_32x32x16_bf16 a[32:47], v[72:75], v[40:43], a[32:47]
 ds_read_b64_tr_b16 v[124:125], v212 offset:192
 ds_read_b64_tr_b16 v[126:127], v212 offset:1472
 ds_read_b64_tr_b16 v[128:129], v212 offset:256
 buffer_load_dwordx4 v233, s[48:51], s43 offen offset:1024 lds
 v_accvgpr_read_b32 v163, a227
 v_mfma_f32_32x32x16_bf16 a[48:63], v[76:79], v[40:43], a[48:63]
 ds_read_b64_tr_b16 v[130:131], v212 offset:1536
 ds_read_b64_tr_b16 v[132:133], v212 offset:5120
 ds_read_b64_tr_b16 v[134:135], v212 offset:6400
 v_accvgpr_read_b32 v164, a228
 v_accvgpr_read_b32 v165, a229
 v_mfma_f32_32x32x16_bf16 a[64:79], v[80:83], v[40:43], a[64:79]
 ds_read_b64_tr_b16 v[136:137], v212 offset:5184
 ds_read_b64_tr_b16 v[138:139], v212 offset:6464
 ds_read_b64_tr_b16 v[140:141], v212 offset:5248
 buffer_load_dwordx4 v234, s[48:51], s43 offen offset:2048 lds
 v_accvgpr_read_b32 v166, a230
 v_mfma_f32_32x32x16_bf16 a[0:15], v[84:87], v[44:47], a[0:15]
 ds_read_b64_tr_b16 v[142:143], v212 offset:6528
 ds_read_b64_tr_b16 v[144:145], v212 offset:5312
 ds_read_b64_tr_b16 v[146:147], v212 offset:6592
 v_accvgpr_read_b32 v167, a231
 v_mfma_f32_32x32x16_bf16 a[16:31], v[88:91], v[44:47], a[16:31]
 ds_read_b64_tr_b16 v[148:149], v212 offset:5376
 ds_read_b64_tr_b16 v[150:151], v212 offset:6656
 buffer_load_dwordx4 v235, s[48:51], s43 offen offset:3072 lds
 v_cvt_pk_bf16_f32 v176, v160, v161
 v_cvt_pk_bf16_f32 v177, v162, v163
 v_mfma_f32_32x32x16_bf16 a[32:47], v[92:95], v[44:47], a[32:47]
 v_cvt_pk_bf16_f32 v178, v164, v165
 v_mfma_f32_32x32x16_bf16 a[48:63], v[96:99], v[44:47], a[48:63]
 s_add_u32 m0, m0, 4096
 s_nop 0
 buffer_load_dwordx4 v236, s[48:51], s43 offen offset:0 lds
 v_cvt_pk_bf16_f32 v179, v166, v167
 v_mfma_f32_32x32x16_bf16 a[64:79], v[100:103], v[44:47], a[64:79]
 s_mov_b32 s35, 49152
 buffer_store_dwordx4 v[176:179], v231, s[60:63], s35 offen offset:0
 s_waitcnt lgkmcnt(0)
 v_mfma_f32_32x32x16_bf16 a[0:15], v[112:115], v[48:51], a[0:15]
 ds_read_b64_tr_b16 v[64:65], v212 offset:10240
 ds_read_b64_tr_b16 v[66:67], v212 offset:11520
 ds_read_b64_tr_b16 v[68:69], v212 offset:10304
 v_accvgpr_read_b32 v168, a232
 v_accvgpr_read_b32 v169, a233
 v_mfma_f32_32x32x16_bf16 a[16:31], v[116:119], v[48:51], a[16:31]
 ds_read_b64_tr_b16 v[70:71], v212 offset:11584
 ds_read_b64_tr_b16 v[72:73], v212 offset:10368
 ds_read_b64_tr_b16 v[74:75], v212 offset:11648
 v_accvgpr_read_b32 v170, a234
 v_mfma_f32_32x32x16_bf16 a[32:47], v[120:123], v[48:51], a[32:47]
 ds_read_b64_tr_b16 v[76:77], v212 offset:10432
 ds_read_b64_tr_b16 v[78:79], v212 offset:11712
 ds_read_b64_tr_b16 v[80:81], v212 offset:10496
 v_accvgpr_read_b32 v171, a235
 v_mfma_f32_32x32x16_bf16 a[48:63], v[124:127], v[48:51], a[48:63]
 ds_read_b64_tr_b16 v[82:83], v212 offset:11776
 ds_read_b64_tr_b16 v[84:85], v212 offset:15360
 ds_read_b64_tr_b16 v[86:87], v212 offset:16640
 v_accvgpr_read_b32 v172, a236
 v_accvgpr_read_b32 v173, a237
 v_mfma_f32_32x32x16_bf16 a[64:79], v[128:131], v[48:51], a[64:79]
 ds_read_b64_tr_b16 v[88:89], v212 offset:15424
 ds_read_b64_tr_b16 v[90:91], v212 offset:16704
 ds_read_b64_tr_b16 v[92:93], v212 offset:15488
 v_accvgpr_read_b32 v174, a238
 v_mfma_f32_32x32x16_bf16 a[0:15], v[132:135], v[52:55], a[0:15]
 ds_read_b64_tr_b16 v[94:95], v212 offset:16768
 ds_read_b64_tr_b16 v[96:97], v212 offset:15552
 ds_read_b64_tr_b16 v[98:99], v212 offset:16832
 v_accvgpr_read_b32 v175, a239
 v_mfma_f32_32x32x16_bf16 a[16:31], v[136:139], v[52:55], a[16:31]
 ds_read_b64_tr_b16 v[100:101], v212 offset:15616
 ds_read_b64_tr_b16 v[102:103], v212 offset:16896
 v_cvt_pk_bf16_f32 v180, v168, v169
 v_cvt_pk_bf16_f32 v181, v170, v171
 v_mfma_f32_32x32x16_bf16 a[32:47], v[140:143], v[52:55], a[32:47]
 v_cvt_pk_bf16_f32 v182, v172, v173
 v_mfma_f32_32x32x16_bf16 a[48:63], v[144:147], v[52:55], a[48:63]
 v_cvt_pk_bf16_f32 v183, v174, v175
 v_mfma_f32_32x32x16_bf16 a[64:79], v[148:151], v[52:55], a[64:79]
 s_mov_b32 s35, 49152
 buffer_store_dwordx4 v[180:183], v231, s[60:63], s35 offen offset:1024
 s_mov_b32 s25, s24
 s_add_u32 s24, s24, 24576
 s_cmp_eq_u32 s24, 147456
 s_cselect_b32 s24, 0, s24
 v_add_u32 v212, s24, v237
 s_mov_b32 s43, 410560
 s_waitcnt vmcnt(30) lgkmcnt(0)
 s_barrier
 v_mfma_f32_32x32x16_bf16 a[0:15], v[64:67], v[56:59], a[0:15]
 ds_read_b64_tr_b16 v[112:113], v212 offset:0
 ds_read_b64_tr_b16 v[114:115], v212 offset:1280
 ds_read_b64_tr_b16 v[116:117], v212 offset:64
 s_add_u32 m0, s25, s42
 s_nop 0
 buffer_load_dwordx4 v232, s[48:51], s43 offen offset:0 lds
 v_mfma_f32_32x32x16_bf16 a[16:31], v[68:71], v[56:59], a[16:31]
 ds_read_b64_tr_b16 v[118:119], v212 offset:1344
 ds_read_b64_tr_b16 v[120:121], v212 offset:128
 ds_read_b64_tr_b16 v[122:123], v212 offset:1408
 v_mfma_f32_32x32x16_bf16 a[32:47], v[72:75], v[56:59], a[32:47]
 ds_read_b64_tr_b16 v[124:125], v212 offset:192
 ds_read_b64_tr_b16 v[126:127], v212 offset:1472
 ds_read_b64_tr_b16 v[128:129], v212 offset:256
 buffer_load_dwordx4 v233, s[48:51], s43 offen offset:1024 lds
 v_mfma_f32_32x32x16_bf16 a[48:63], v[76:79], v[56:59], a[48:63]
 ds_read_b64_tr_b16 v[130:131], v212 offset:1536
 ds_read_b64_tr_b16 v[132:133], v212 offset:5120
 ds_read_b64_tr_b16 v[134:135], v212 offset:6400
 v_mfma_f32_32x32x16_bf16 a[64:79], v[80:83], v[56:59], a[64:79]
 ds_read_b64_tr_b16 v[136:137], v212 offset:5184
 ds_read_b64_tr_b16 v[138:139], v212 offset:6464
 ds_read_b64_tr_b16 v[140:141], v212 offset:5248
 buffer_load_dwordx4 v234, s[48:51], s43 offen offset:2048 lds
 v_mfma_f32_32x32x16_bf16 a[0:15], v[84:87], v[60:63], a[0:15]
 ds_read_b64_tr_b16 v[142:143], v212 offset:6528
 ds_read_b64_tr_b16 v[144:145], v212 offset:5312
 ds_read_b64_tr_b16 v[146:147], v212 offset:6592
 v_mfma_f32_32x32x16_bf16 a[16:31], v[88:91], v[60:63], a[16:31]
 ds_read_b64_tr_b16 v[148:149], v212 offset:5376
 ds_read_b64_tr_b16 v[150:151], v212 offset:6656
 buffer_load_dwordx4 v235, s[48:51], s43 offen offset:3072 lds
 v_mfma_f32_32x32x16_bf16 a[32:47], v[92:95], v[60:63], a[32:47]
 v_mfma_f32_32x32x16_bf16 a[48:63], v[96:99], v[60:63], a[48:63]
 s_add_u32 m0, m0, 4096
 s_nop 0
 buffer_load_dwordx4 v236, s[48:51], s43 offen offset:0 lds
 v_mfma_f32_32x32x16_bf16 a[64:79], v[100:103], v[60:63], a[64:79]
 s_waitcnt lgkmcnt(0)
 v_mfma_f32_32x32x16_bf16 a[160:175], v[112:115], a[80:83], 0
 ds_read_b64_tr_b16 v[64:65], v212 offset:10240
 ds_read_b64_tr_b16 v[66:67], v212 offset:11520
 ds_read_b64_tr_b16 v[68:69], v212 offset:10304
 v_mfma_f32_32x32x16_bf16 a[176:191], v[116:119], a[80:83], 0
 ds_read_b64_tr_b16 v[70:71], v212 offset:11584
 ds_read_b64_tr_b16 v[72:73], v212 offset:10368
 ds_read_b64_tr_b16 v[74:75], v212 offset:11648
 v_mfma_f32_32x32x16_bf16 a[192:207], v[120:123], a[80:83], 0
 ds_read_b64_tr_b16 v[76:77], v212 offset:10432
 ds_read_b64_tr_b16 v[78:79], v212 offset:11712
 ds_read_b64_tr_b16 v[80:81], v212 offset:10496
 v_mfma_f32_32x32x16_bf16 a[208:223], v[124:127], a[80:83], 0
 ds_read_b64_tr_b16 v[82:83], v212 offset:11776
 ds_read_b64_tr_b16 v[84:85], v212 offset:15360
 ds_read_b64_tr_b16 v[86:87], v212 offset:16640
 v_mfma_f32_32x32x16_bf16 a[224:239], v[128:131], a[80:83], 0
 ds_read_b64_tr_b16 v[88:89], v212 offset:15424
 ds_read_b64_tr_b16 v[90:91], v212 offset:16704
 ds_read_b64_tr_b16 v[92:93], v212 offset:15488
 v_mfma_f32_32x32x16_bf16 a[160:175], v[132:135], a[84:87], a[160:175]
 ds_read_b64_tr_b16 v[94:95], v212 offset:16768
 ds_read_b64_tr_b16 v[96:97], v212 offset:15552
 ds_read_b64_tr_b16 v[98:99], v212 offset:16832
 v_mfma_f32_32x32x16_bf16 a[176:191], v[136:139], a[84:87], a[176:191]
 ds_read_b64_tr_b16 v[100:101], v212 offset:15616
 ds_read_b64_tr_b16 v[102:103], v212 offset:16896
 v_mfma_f32_32x32x16_bf16 a[192:207], v[140:143], a[84:87], a[192:207]
 v_mfma_f32_32x32x16_bf16 a[208:223], v[144:147], a[84:87], a[208:223]
 v_mfma_f32_32x32x16_bf16 a[224:239], v[148:151], a[84:87], a[224:239]
 s_mov_b32 s25, s24
 s_add_u32 s24, s24, 24576
 s_cmp_eq_u32 s24, 147456
 s_cselect_b32 s24, 0, s24
 v_add_u32 v212, s24, v237
 s_waitcnt vmcnt(28) lgkmcnt(0)
 s_barrier
 v_mfma_f32_32x32x16_bf16 a[160:175], v[64:67], a[88:91], a[160:175]
 ds_read_b64_tr_b16 v[112:113], v212 offset:0
 ds_read_b64_tr_b16 v[114:115], v212 offset:1280
 ds_read_b64_tr_b16 v[116:117], v212 offset:64
 v_accvgpr_read_b32 v160, a0
 v_accvgpr_read_b32 v161, a1
 v_mfma_f32_32x32x16_bf16 a[176:191], v[68:71], a[88:91], a[176:191]
 ds_read_b64_tr_b16 v[118:119], v212 offset:1344
 ds_read_b64_tr_b16 v[120:121], v212 offset:128
 ds_read_b64_tr_b16 v[122:123], v212 offset:1408
 v_accvgpr_read_b32 v162, a2
 v_mfma_f32_32x32x16_bf16 a[192:207], v[72:75], a[88:91], a[192:207]
 ds_read_b64_tr_b16 v[124:125], v212 offset:192
 ds_read_b64_tr_b16 v[126:127], v212 offset:1472
 ds_read_b64_tr_b16 v[128:129], v212 offset:256
 v_accvgpr_read_b32 v163, a3
 v_mfma_f32_32x32x16_bf16 a[208:223], v[76:79], a[88:91], a[208:223]
 ds_read_b64_tr_b16 v[130:131], v212 offset:1536
 ds_read_b64_tr_b16 v[132:133], v212 offset:5120
 ds_read_b64_tr_b16 v[134:135], v212 offset:6400
 v_accvgpr_read_b32 v164, a4
 v_accvgpr_read_b32 v165, a5
 v_mfma_f32_32x32x16_bf16 a[224:239], v[80:83], a[88:91], a[224:239]
 ds_read_b64_tr_b16 v[136:137], v212 offset:5184
 ds_read_b64_tr_b16 v[138:139], v212 offset:6464
 ds_read_b64_tr_b16 v[140:141], v212 offset:5248
 v_accvgpr_read_b32 v166, a6
 v_mfma_f32_32x32x16_bf16 a[160:175], v[84:87], a[92:95], a[160:175]
 ds_read_b64_tr_b16 v[142:143], v212 offset:6528
 ds_read_b64_tr_b16 v[144:145], v212 offset:5312
 ds_read_b64_tr_b16 v[146:147], v212 offset:6592
 v_accvgpr_read_b32 v167, a7
 v_mfma_f32_32x32x16_bf16 a[176:191], v[88:91], a[92:95], a[176:191]
 ds_read_b64_tr_b16 v[148:149], v212 offset:5376
 ds_read_b64_tr_b16 v[150:151], v212 offset:6656
 v_cvt_pk_bf16_f32 v176, v160, v161
 v_cvt_pk_bf16_f32 v177, v162, v163
 v_mfma_f32_32x32x16_bf16 a[192:207], v[92:95], a[92:95], a[192:207]
 v_cvt_pk_bf16_f32 v178, v164, v165
 v_mfma_f32_32x32x16_bf16 a[208:223], v[96:99], a[92:95], a[208:223]
 v_cvt_pk_bf16_f32 v179, v166, v167
 v_mfma_f32_32x32x16_bf16 a[224:239], v[100:103], a[92:95], a[224:239]
 s_mov_b32 s35, 81920
 buffer_store_dwordx4 v[176:179], v231, s[60:63], s35 offen offset:0
 s_waitcnt lgkmcnt(0)
 v_mfma_f32_32x32x16_bf16 a[160:175], v[112:115], a[96:99], a[160:175]
 ds_read_b64_tr_b16 v[64:65], v212 offset:10240
 ds_read_b64_tr_b16 v[66:67], v212 offset:11520
 ds_read_b64_tr_b16 v[68:69], v212 offset:10304
 v_accvgpr_read_b32 v168, a8
 v_accvgpr_read_b32 v169, a9
 v_mfma_f32_32x32x16_bf16 a[176:191], v[116:119], a[96:99], a[176:191]
 ds_read_b64_tr_b16 v[70:71], v212 offset:11584
 ds_read_b64_tr_b16 v[72:73], v212 offset:10368
 ds_read_b64_tr_b16 v[74:75], v212 offset:11648
 v_accvgpr_read_b32 v170, a10
 v_mfma_f32_32x32x16_bf16 a[192:207], v[120:123], a[96:99], a[192:207]
 ds_read_b64_tr_b16 v[76:77], v212 offset:10432
 ds_read_b64_tr_b16 v[78:79], v212 offset:11712
 ds_read_b64_tr_b16 v[80:81], v212 offset:10496
 v_accvgpr_read_b32 v171, a11
 v_mfma_f32_32x32x16_bf16 a[208:223], v[124:127], a[96:99], a[208:223]
 ds_read_b64_tr_b16 v[82:83], v212 offset:11776
 ds_read_b64_tr_b16 v[84:85], v212 offset:15360
 ds_read_b64_tr_b16 v[86:87], v212 offset:16640
 v_accvgpr_read_b32 v172, a12
 v_accvgpr_read_b32 v173, a13
 v_mfma_f32_32x32x16_bf16 a[224:239], v[128:131], a[96:99], a[224:239]
 ds_read_b64_tr_b16 v[88:89], v212 offset:15424
 ds_read_b64_tr_b16 v[90:91], v212 offset:16704
 ds_read_b64_tr_b16 v[92:93], v212 offset:15488
 v_accvgpr_read_b32 v174, a14
 v_mfma_f32_32x32x16_bf16 a[160:175], v[132:135], a[100:103], a[160:175]
 ds_read_b64_tr_b16 v[94:95], v212 offset:16768
 ds_read_b64_tr_b16 v[96:97], v212 offset:15552
 ds_read_b64_tr_b16 v[98:99], v212 offset:16832
 v_accvgpr_read_b32 v175, a15
 v_mfma_f32_32x32x16_bf16 a[176:191], v[136:139], a[100:103], a[176:191]
 ds_read_b64_tr_b16 v[100:101], v212 offset:15616
 ds_read_b64_tr_b16 v[102:103], v212 offset:16896
 v_cvt_pk_bf16_f32 v180, v168, v169
 v_cvt_pk_bf16_f32 v181, v170, v171
 v_mfma_f32_32x32x16_bf16 a[192:207], v[140:143], a[100:103], a[192:207]
 v_cvt_pk_bf16_f32 v182, v172, v173
 v_mfma_f32_32x32x16_bf16 a[208:223], v[144:147], a[100:103], a[208:223]
 v_cvt_pk_bf16_f32 v183, v174, v175
 v_mfma_f32_32x32x16_bf16 a[224:239], v[148:151], a[100:103], a[224:239]
 s_mov_b32 s35, 81920
 buffer_store_dwordx4 v[180:183], v231, s[60:63], s35 offen offset:1024
 s_mov_b32 s25, s24
 s_add_u32 s24, s24, 24576
 s_cmp_eq_u32 s24, 147456
 s_cselect_b32 s24, 0, s24
 v_add_u32 v212, s24, v237
 s_waitcnt vmcnt(23) lgkmcnt(0)
 s_barrier
 v_mfma_f32_32x32x16_bf16 a[160:175], v[64:67], a[104:107], a[160:175]
 ds_read_b64_tr_b16 v[112:113], v212 offset:0
 ds_read_b64_tr_b16 v[114:115], v212 offset:1280
 ds_read_b64_tr_b16 v[116:117], v212 offset:64
 v_accvgpr_read_b32 v160, a16
 v_accvgpr_read_b32 v161, a17
 v_mfma_f32_32x32x16_bf16 a[176:191], v[68:71], a[104:107], a[176:191]
 ds_read_b64_tr_b16 v[118:119], v212 offset:1344
 ds_read_b64_tr_b16 v[120:121], v212 offset:128
 ds_read_b64_tr_b16 v[122:123], v212 offset:1408
 v_accvgpr_read_b32 v162, a18
 v_mfma_f32_32x32x16_bf16 a[192:207], v[72:75], a[104:107], a[192:207]
 ds_read_b64_tr_b16 v[124:125], v212 offset:192
 ds_read_b64_tr_b16 v[126:127], v212 offset:1472
 ds_read_b64_tr_b16 v[128:129], v212 offset:256
 v_accvgpr_read_b32 v163, a19
 v_mfma_f32_32x32x16_bf16 a[208:223], v[76:79], a[104:107], a[208:223]
 ds_read_b64_tr_b16 v[130:131], v212 offset:1536
 ds_read_b64_tr_b16 v[132:133], v212 offset:5120
 ds_read_b64_tr_b16 v[134:135], v212 offset:6400
 v_accvgpr_read_b32 v164, a20
 v_accvgpr_read_b32 v165, a21
 v_mfma_f32_32x32x16_bf16 a[224:239], v[80:83], a[104:107], a[224:239]
 ds_read_b64_tr_b16 v[136:137], v212 offset:5184
 ds_read_b64_tr_b16 v[138:139], v212 offset:6464
 ds_read_b64_tr_b16 v[140:141], v212 offset:5248
 v_accvgpr_read_b32 v166, a22
 v_mfma_f32_32x32x16_bf16 a[160:175], v[84:87], a[108:111], a[160:175]
 ds_read_b64_tr_b16 v[142:143], v212 offset:6528
 ds_read_b64_tr_b16 v[144:145], v212 offset:5312
 ds_read_b64_tr_b16 v[146:147], v212 offset:6592
 v_accvgpr_read_b32 v167, a23
 v_mfma_f32_32x32x16_bf16 a[176:191], v[88:91], a[108:111], a[176:191]
 ds_read_b64_tr_b16 v[148:149], v212 offset:5376
 ds_read_b64_tr_b16 v[150:151], v212 offset:6656
 v_cvt_pk_bf16_f32 v184, v160, v161
 v_cvt_pk_bf16_f32 v185, v162, v163
 v_mfma_f32_32x32x16_bf16 a[192:207], v[92:95], a[108:111], a[192:207]
 v_cvt_pk_bf16_f32 v186, v164, v165
 v_mfma_f32_32x32x16_bf16 a[208:223], v[96:99], a[108:111], a[208:223]
 v_cvt_pk_bf16_f32 v187, v166, v167
 v_mfma_f32_32x32x16_bf16 a[224:239], v[100:103], a[108:111], a[224:239]
 s_mov_b32 s35, 81920
 buffer_store_dwordx4 v[184:187], v231, s[60:63], s35 offen offset:2048
 s_waitcnt lgkmcnt(0)
 v_mfma_f32_32x32x16_bf16 a[160:175], v[112:115], a[112:115], a[160:175]
 ds_read_b64_tr_b16 v[64:65], v212 offset:10240
 ds_read_b64_tr_b16 v[66:67], v212 offset:11520
 ds_read_b64_tr_b16 v[68:69], v212 offset:10304
 v_accvgpr_read_b32 v168, a24
 v_accvgpr_read_b32 v169, a25
 v_mfma_f32_32x32x16_bf16 a[176:191], v[116:119], a[112:115], a[176:191]
 ds_read_b64_tr_b16 v[70:71], v212 offset:11584
 ds_read_b64_tr_b16 v[72:73], v212 offset:10368
 ds_read_b64_tr_b16 v[74:75], v212 offset:11648
 v_accvgpr_read_b32 v170, a26
 v_mfma_f32_32x32x16_bf16 a[192:207], v[120:123], a[112:115], a[192:207]
 ds_read_b64_tr_b16 v[76:77], v212 offset:10432
 ds_read_b64_tr_b16 v[78:79], v212 offset:11712
 ds_read_b64_tr_b16 v[80:81], v212 offset:10496
 v_accvgpr_read_b32 v171, a27
 v_mfma_f32_32x32x16_bf16 a[208:223], v[124:127], a[112:115], a[208:223]
 ds_read_b64_tr_b16 v[82:83], v212 offset:11776
 ds_read_b64_tr_b16 v[84:85], v212 offset:15360
 ds_read_b64_tr_b16 v[86:87], v212 offset:16640
 v_accvgpr_read_b32 v172, a28
 v_accvgpr_read_b32 v173, a29
 v_mfma_f32_32x32x16_bf16 a[224:239], v[128:131], a[112:115], a[224:239]
 ds_read_b64_tr_b16 v[88:89], v212 offset:15424
 ds_read_b64_tr_b16 v[90:91], v212 offset:16704
 ds_read_b64_tr_b16 v[92:93], v212 offset:15488
 v_accvgpr_read_b32 v174, a30
 v_mfma_f32_32x32x16_bf16 a[160:175], v[132:135], a[116:119], a[160:175]
 ds_read_b64_tr_b16 v[94:95], v212 offset:16768
 ds_read_b64_tr_b16 v[96:97], v212 offset:15552
 ds_read_b64_tr_b16 v[98:99], v212 offset:16832
 v_accvgpr_read_b32 v175, a31
 v_mfma_f32_32x32x16_bf16 a[176:191], v[136:139], a[116:119], a[176:191]
 ds_read_b64_tr_b16 v[100:101], v212 offset:15616
 ds_read_b64_tr_b16 v[102:103], v212 offset:16896
 v_cvt_pk_bf16_f32 v188, v168, v169
 v_cvt_pk_bf16_f32 v189, v170, v171
 v_mfma_f32_32x32x16_bf16 a[192:207], v[140:143], a[116:119], a[192:207]
 v_cvt_pk_bf16_f32 v190, v172, v173
 v_mfma_f32_32x32x16_bf16 a[208:223], v[144:147], a[116:119], a[208:223]
 v_cvt_pk_bf16_f32 v191, v174, v175
 v_mfma_f32_32x32x16_bf16 a[224:239], v[148:151], a[116:119], a[224:239]
 s_mov_b32 s35, 81920
 buffer_store_dwordx4 v[188:191], v231, s[60:63], s35 offen offset:3072
 s_mov_b32 s25, s24
 s_add_u32 s24, s24, 24576
 s_cmp_eq_u32 s24, 147456
 s_cselect_b32 s24, 0, s24
 v_add_u32 v212, s24, v237
 s_waitcnt vmcnt(18) lgkmcnt(0)
 s_barrier
 v_mfma_f32_32x32x16_bf16 a[160:175], v[64:67], a[120:123], a[160:175]
 ds_read_b64_tr_b16 v[112:113], v212 offset:0
 ds_read_b64_tr_b16 v[114:115], v212 offset:1280
 ds_read_b64_tr_b16 v[116:117], v212 offset:64
 v_accvgpr_read_b32 v160, a32
 v_accvgpr_read_b32 v161, a33
 v_mfma_f32_32x32x16_bf16 a[176:191], v[68:71], a[120:123], a[176:191]
 ds_read_b64_tr_b16 v[118:119], v212 offset:1344
 ds_read_b64_tr_b16 v[120:121], v212 offset:128
 ds_read_b64_tr_b16 v[122:123], v212 offset:1408
 v_accvgpr_read_b32 v162, a34
 v_mfma_f32_32x32x16_bf16 a[192:207], v[72:75], a[120:123], a[192:207]
 ds_read_b64_tr_b16 v[124:125], v212 offset:192
 ds_read_b64_tr_b16 v[126:127], v212 offset:1472
 ds_read_b64_tr_b16 v[128:129], v212 offset:256
 v_accvgpr_read_b32 v163, a35
 v_mfma_f32_32x32x16_bf16 a[208:223], v[76:79], a[120:123], a[208:223]
 ds_read_b64_tr_b16 v[130:131], v212 offset:1536
 ds_read_b64_tr_b16 v[132:133], v212 offset:5120
 ds_read_b64_tr_b16 v[134:135], v212 offset:6400
 v_accvgpr_read_b32 v164, a36
 v_accvgpr_read_b32 v165, a37
 v_mfma_f32_32x32x16_bf16 a[224:239], v[80:83], a[120:123], a[224:239]
 ds_read_b64_tr_b16 v[136:137], v212 offset:5184
 ds_read_b64_tr_b16 v[138:139], v212 offset:6464
 ds_read_b64_tr_b16 v[140:141], v212 offset:5248
 v_accvgpr_read_b32 v166, a38
 v_mfma_f32_32x32x16_bf16 a[160:175], v[84:87], a[124:127], a[160:175]
 ds_read_b64_tr_b16 v[142:143], v212 offset:6528
 ds_read_b64_tr_b16 v[144:145], v212 offset:5312
 ds_read_b64_tr_b16 v[146:147], v212 offset:6592
 v_accvgpr_read_b32 v167, a39
 v_mfma_f32_32x32x16_bf16 a[176:191], v[88:91], a[124:127], a[176:191]
 ds_read_b64_tr_b16 v[148:149], v212 offset:5376
 ds_read_b64_tr_b16 v[150:151], v212 offset:6656
 v_cvt_pk_bf16_f32 v176, v160, v161
 v_cvt_pk_bf16_f32 v177, v162, v163
 v_mfma_f32_32x32x16_bf16 a[192:207], v[92:95], a[124:127], a[192:207]
 v_cvt_pk_bf16_f32 v178, v164, v165
 v_mfma_f32_32x32x16_bf16 a[208:223], v[96:99], a[124:127], a[208:223]
 v_cvt_pk_bf16_f32 v179, v166, v167
 v_mfma_f32_32x32x16_bf16 a[224:239], v[100:103], a[124:127], a[224:239]
 s_mov_b32 s35, 86016
 buffer_store_dwordx4 v[176:179], v231, s[60:63], s35 offen offset:0
 s_waitcnt lgkmcnt(0)
 v_mfma_f32_32x32x16_bf16 a[160:175], v[112:115], v[16:19], a[160:175]
 ds_read_b64_tr_b16 v[64:65], v212 offset:10240
 ds_read_b64_tr_b16 v[66:67], v212 offset:11520
 ds_read_b64_tr_b16 v[68:69], v212 offset:10304
 v_accvgpr_read_b32 v168, a40
 v_accvgpr_read_b32 v169, a41
 v_mfma_f32_32x32x16_bf16 a[176:191], v[116:119], v[16:19], a[176:191]
 ds_read_b64_tr_b16 v[70:71], v212 offset:11584
 ds_read_b64_tr_b16 v[72:73], v212 offset:10368
 ds_read_b64_tr_b16 v[74:75], v212 offset:11648
 v_accvgpr_read_b32 v170, a42
 v_mfma_f32_32x32x16_bf16 a[192:207], v[120:123], v[16:19], a[192:207]
 ds_read_b64_tr_b16 v[76:77], v212 offset:10432
 ds_read_b64_tr_b16 v[78:79], v212 offset:11712
 ds_read_b64_tr_b16 v[80:81], v212 offset:10496
 v_accvgpr_read_b32 v171, a43
 v_mfma_f32_32x32x16_bf16 a[208:223], v[124:127], v[16:19], a[208:223]
 ds_read_b64_tr_b16 v[82:83], v212 offset:11776
 ds_read_b64_tr_b16 v[84:85], v212 offset:15360
 ds_read_b64_tr_b16 v[86:87], v212 offset:16640
 v_accvgpr_read_b32 v172, a44
 v_accvgpr_read_b32 v173, a45
 v_mfma_f32_32x32x16_bf16 a[224:239], v[128:131], v[16:19], a[224:239]
 ds_read_b64_tr_b16 v[88:89], v212 offset:15424
 ds_read_b64_tr_b16 v[90:91], v212 offset:16704
 ds_read_b64_tr_b16 v[92:93], v212 offset:15488
 v_accvgpr_read_b32 v174, a46
 v_mfma_f32_32x32x16_bf16 a[160:175], v[132:135], v[20:23], a[160:175]
 ds_read_b64_tr_b16 v[94:95], v212 offset:16768
 ds_read_b64_tr_b16 v[96:97], v212 offset:15552
 ds_read_b64_tr_b16 v[98:99], v212 offset:16832
 v_accvgpr_read_b32 v175, a47
 v_mfma_f32_32x32x16_bf16 a[176:191], v[136:139], v[20:23], a[176:191]
 ds_read_b64_tr_b16 v[100:101], v212 offset:15616
 ds_read_b64_tr_b16 v[102:103], v212 offset:16896
 v_cvt_pk_bf16_f32 v180, v168, v169
 v_cvt_pk_bf16_f32 v181, v170, v171
 v_mfma_f32_32x32x16_bf16 a[192:207], v[140:143], v[20:23], a[192:207]
 v_cvt_pk_bf16_f32 v182, v172, v173
 v_mfma_f32_32x32x16_bf16 a[208:223], v[144:147], v[20:23], a[208:223]
 v_cvt_pk_bf16_f32 v183, v174, v175
 v_mfma_f32_32x32x16_bf16 a[224:239], v[148:151], v[20:23], a[224:239]
 s_mov_b32 s35, 86016
 buffer_store_dwordx4 v[180:183], v231, s[60:63], s35 offen offset:1024
 s_mov_b32 s25, s24
 s_add_u32 s24, s24, 24576
 s_cmp_eq_u32 s24, 147456
 s_cselect_b32 s24, 0, s24
 v_add_u32 v212, s24, v237
 s_waitcnt vmcnt(13) lgkmcnt(0)
 s_barrier
 v_mfma_f32_32x32x16_bf16 a[160:175], v[64:67], v[24:27], a[160:175]
 ds_read_b64_tr_b16 v[112:113], v212 offset:0
 ds_read_b64_tr_b16 v[114:115], v212 offset:1280
 ds_read_b64_tr_b16 v[116:117], v212 offset:64
 v_accvgpr_read_b32 v160, a48
 v_accvgpr_read_b32 v161, a49
 v_mfma_f32_32x32x16_bf16 a[176:191], v[68:71], v[24:27], a[176:191]
 ds_read_b64_tr_b16 v[118:119], v212 offset:1344
 ds_read_b64_tr_b16 v[120:121], v212 offset:128
 ds_read_b64_tr_b16 v[122:123], v212 offset:1408
 v_accvgpr_read_b32 v162, a50
 v_mfma_f32_32x32x16_bf16 a[192:207], v[72:75], v[24:27], a[192:207]
 ds_read_b64_tr_b16 v[124:125], v212 offset:192
 ds_read_b64_tr_b16 v[126:127], v212 offset:1472
 ds_read_b64_tr_b16 v[128:129], v212 offset:256
 v_accvgpr_read_b32 v163, a51
 v_mfma_f32_32x32x16_bf16 a[208:223], v[76:79], v[24:27], a[208:223]
 ds_read_b64_tr_b16 v[130:131], v212 offset:1536
 ds_read_b64_tr_b16 v[132:133], v212 offset:5120
 ds_read_b64_tr_b16 v[134:135], v212 offset:6400
 v_accvgpr_read_b32 v164, a52
 v_accvgpr_read_b32 v165, a53
 v_mfma_f32_32x32x16_bf16 a[224:239], v[80:83], v[24:27], a[224:239]
 ds_read_b64_tr_b16 v[136:137], v212 offset:5184
 ds_read_b64_tr_b16 v[138:139], v212 offset:6464
 ds_read_b64_tr_b16 v[140:141], v212 offset:5248
 v_accvgpr_read_b32 v166, a54
 v_mfma_f32_32x32x16_bf16 a[160:175], v[84:87], v[28:31], a[160:175]
 ds_read_b64_tr_b16 v[142:143], v212 offset:6528
 ds_read_b64_tr_b16 v[144:145], v212 offset:5312
 ds_read_b64_tr_b16 v[146:147], v212 offset:6592
 v_accvgpr_read_b32 v167, a55
 v_mfma_f32_32x32x16_bf16 a[176:191], v[88:91], v[28:31], a[176:191]
 ds_read_b64_tr_b16 v[148:149], v212 offset:5376
 ds_read_b64_tr_b16 v[150:151], v212 offset:6656
 v_cvt_pk_bf16_f32 v184, v160, v161
 v_cvt_pk_bf16_f32 v185, v162, v163
 v_mfma_f32_32x32x16_bf16 a[192:207], v[92:95], v[28:31], a[192:207]
 v_cvt_pk_bf16_f32 v186, v164, v165
 v_mfma_f32_32x32x16_bf16 a[208:223], v[96:99], v[28:31], a[208:223]
 v_cvt_pk_bf16_f32 v187, v166, v167
 v_mfma_f32_32x32x16_bf16 a[224:239], v[100:103], v[28:31], a[224:239]
 s_mov_b32 s35, 86016
 buffer_store_dwordx4 v[184:187], v231, s[60:63], s35 offen offset:2048
 s_waitcnt lgkmcnt(0)
 v_mfma_f32_32x32x16_bf16 a[160:175], v[112:115], v[32:35], a[160:175]
 ds_read_b64_tr_b16 v[64:65], v212 offset:10240
 ds_read_b64_tr_b16 v[66:67], v212 offset:11520
 ds_read_b64_tr_b16 v[68:69], v212 offset:10304
 v_accvgpr_read_b32 v168, a56
 v_accvgpr_read_b32 v169, a57
 v_mfma_f32_32x32x16_bf16 a[176:191], v[116:119], v[32:35], a[176:191]
 ds_read_b64_tr_b16 v[70:71], v212 offset:11584
 ds_read_b64_tr_b16 v[72:73], v212 offset:10368
 ds_read_b64_tr_b16 v[74:75], v212 offset:11648
 v_accvgpr_read_b32 v170, a58
 v_mfma_f32_32x32x16_bf16 a[192:207], v[120:123], v[32:35], a[192:207]
 ds_read_b64_tr_b16 v[76:77], v212 offset:10432
 ds_read_b64_tr_b16 v[78:79], v212 offset:11712
 ds_read_b64_tr_b16 v[80:81], v212 offset:10496
 v_accvgpr_read_b32 v171, a59
 v_mfma_f32_32x32x16_bf16 a[208:223], v[124:127], v[32:35], a[208:223]
 ds_read_b64_tr_b16 v[82:83], v212 offset:11776
 ds_read_b64_tr_b16 v[84:85], v212 offset:15360
 ds_read_b64_tr_b16 v[86:87], v212 offset:16640
 v_accvgpr_read_b32 v172, a60
 v_accvgpr_read_b32 v173, a61
 v_mfma_f32_32x32x16_bf16 a[224:239], v[128:131], v[32:35], a[224:239]
 ds_read_b64_tr_b16 v[88:89], v212 offset:15424
 ds_read_b64_tr_b16 v[90:91], v212 offset:16704
 ds_read_b64_tr_b16 v[92:93], v212 offset:15488
 v_accvgpr_read_b32 v174, a62
 v_mfma_f32_32x32x16_bf16 a[160:175], v[132:135], v[36:39], a[160:175]
 ds_read_b64_tr_b16 v[94:95], v212 offset:16768
 ds_read_b64_tr_b16 v[96:97], v212 offset:15552
 ds_read_b64_tr_b16 v[98:99], v212 offset:16832
 v_accvgpr_read_b32 v175, a63
 v_mfma_f32_32x32x16_bf16 a[176:191], v[136:139], v[36:39], a[176:191]
 ds_read_b64_tr_b16 v[100:101], v212 offset:15616
 ds_read_b64_tr_b16 v[102:103], v212 offset:16896
 v_cvt_pk_bf16_f32 v188, v168, v169
 v_cvt_pk_bf16_f32 v189, v170, v171
 v_mfma_f32_32x32x16_bf16 a[192:207], v[140:143], v[36:39], a[192:207]
 v_cvt_pk_bf16_f32 v190, v172, v173
 v_mfma_f32_32x32x16_bf16 a[208:223], v[144:147], v[36:39], a[208:223]
 v_cvt_pk_bf16_f32 v191, v174, v175
 v_mfma_f32_32x32x16_bf16 a[224:239], v[148:151], v[36:39], a[224:239]
 s_mov_b32 s35, 86016
 buffer_store_dwordx4 v[188:191], v231, s[60:63], s35 offen offset:3072
 s_mov_b32 s25, s24
 s_add_u32 s24, s24, 24576
 s_cmp_eq_u32 s24, 147456
 s_cselect_b32 s24, 0, s24
 v_add_u32 v212, s24, v237
 s_waitcnt vmcnt(8) lgkmcnt(0)
 s_barrier
 v_mfma_f32_32x32x16_bf16 a[160:175], v[64:67], v[40:43], a[160:175]
 ds_read_b64_tr_b16 v[112:113], v212 offset:0
 ds_read_b64_tr_b16 v[114:115], v212 offset:1280
 ds_read_b64_tr_b16 v[116:117], v212 offset:64
 v_accvgpr_read_b32 v160, a64
 v_accvgpr_read_b32 v161, a65
 v_mfma_f32_32x32x16_bf16 a[176:191], v[68:71], v[40:43], a[176:191]
 ds_read_b64_tr_b16 v[118:119], v212 offset:1344
 ds_read_b64_tr_b16 v[120:121], v212 offset:128
 ds_read_b64_tr_b16 v[122:123], v212 offset:1408
 v_accvgpr_read_b32 v162, a66
 v_mfma_f32_32x32x16_bf16 a[192:207], v[72:75], v[40:43], a[192:207]
 ds_read_b64_tr_b16 v[124:125], v212 offset:192
 ds_read_b64_tr_b16 v[126:127], v212 offset:1472
 ds_read_b64_tr_b16 v[128:129], v212 offset:256
 v_accvgpr_read_b32 v163, a67
 v_mfma_f32_32x32x16_bf16 a[208:223], v[76:79], v[40:43], a[208:223]
 ds_read_b64_tr_b16 v[130:131], v212 offset:1536
 ds_read_b64_tr_b16 v[132:133], v212 offset:5120
 ds_read_b64_tr_b16 v[134:135], v212 offset:6400
 v_accvgpr_read_b32 v164, a68
 v_accvgpr_read_b32 v165, a69
 v_mfma_f32_32x32x16_bf16 a[224:239], v[80:83], v[40:43], a[224:239]
 ds_read_b64_tr_b16 v[136:137], v212 offset:5184
 ds_read_b64_tr_b16 v[138:139], v212 offset:6464
 ds_read_b64_tr_b16 v[140:141], v212 offset:5248
 v_accvgpr_read_b32 v166, a70
 v_mfma_f32_32x32x16_bf16 a[160:175], v[84:87], v[44:47], a[160:175]
 ds_read_b64_tr_b16 v[142:143], v212 offset:6528
 ds_read_b64_tr_b16 v[144:145], v212 offset:5312
 ds_read_b64_tr_b16 v[146:147], v212 offset:6592
 v_accvgpr_read_b32 v167, a71
 v_mfma_f32_32x32x16_bf16 a[176:191], v[88:91], v[44:47], a[176:191]
 ds_read_b64_tr_b16 v[148:149], v212 offset:5376
 ds_read_b64_tr_b16 v[150:151], v212 offset:6656
 v_cvt_pk_bf16_f32 v176, v160, v161
 v_cvt_pk_bf16_f32 v177, v162, v163
 v_mfma_f32_32x32x16_bf16 a[192:207], v[92:95], v[44:47], a[192:207]
 v_cvt_pk_bf16_f32 v178, v164, v165
 v_mfma_f32_32x32x16_bf16 a[208:223], v[96:99], v[44:47], a[208:223]
 v_cvt_pk_bf16_f32 v179, v166, v167
 v_mfma_f32_32x32x16_bf16 a[224:239], v[100:103], v[44:47], a[224:239]
 s_mov_b32 s35, 90112
 buffer_store_dwordx4 v[176:179], v231, s[60:63], s35 offen offset:0
 s_waitcnt lgkmcnt(0)
 v_mfma_f32_32x32x16_bf16 a[160:175], v[112:115], v[48:51], a[160:175]
 ds_read_b64_tr_b16 v[64:65], v212 offset:10240
 ds_read_b64_tr_b16 v[66:67], v212 offset:11520
 ds_read_b64_tr_b16 v[68:69], v212 offset:10304
 v_accvgpr_read_b32 v168, a72
 v_accvgpr_read_b32 v169, a73
 v_mfma_f32_32x32x16_bf16 a[176:191], v[116:119], v[48:51], a[176:191]
 ds_read_b64_tr_b16 v[70:71], v212 offset:11584
 ds_read_b64_tr_b16 v[72:73], v212 offset:10368
 ds_read_b64_tr_b16 v[74:75], v212 offset:11648
 v_accvgpr_read_b32 v170, a74
 v_mfma_f32_32x32x16_bf16 a[192:207], v[120:123], v[48:51], a[192:207]
 ds_read_b64_tr_b16 v[76:77], v212 offset:10432
 ds_read_b64_tr_b16 v[78:79], v212 offset:11712
 ds_read_b64_tr_b16 v[80:81], v212 offset:10496
 v_accvgpr_read_b32 v171, a75
 v_mfma_f32_32x32x16_bf16 a[208:223], v[124:127], v[48:51], a[208:223]
 ds_read_b64_tr_b16 v[82:83], v212 offset:11776
 ds_read_b64_tr_b16 v[84:85], v212 offset:15360
 ds_read_b64_tr_b16 v[86:87], v212 offset:16640
 v_accvgpr_read_b32 v172, a76
 v_accvgpr_read_b32 v173, a77
 v_mfma_f32_32x32x16_bf16 a[224:239], v[128:131], v[48:51], a[224:239]
 ds_read_b64_tr_b16 v[88:89], v212 offset:15424
 ds_read_b64_tr_b16 v[90:91], v212 offset:16704
 ds_read_b64_tr_b16 v[92:93], v212 offset:15488
 v_accvgpr_read_b32 v174, a78
 v_mfma_f32_32x32x16_bf16 a[160:175], v[132:135], v[52:55], a[160:175]
 ds_read_b64_tr_b16 v[94:95], v212 offset:16768
 ds_read_b64_tr_b16 v[96:97], v212 offset:15552
 ds_read_b64_tr_b16 v[98:99], v212 offset:16832
 v_accvgpr_read_b32 v175, a79
 v_mfma_f32_32x32x16_bf16 a[176:191], v[136:139], v[52:55], a[176:191]
 ds_read_b64_tr_b16 v[100:101], v212 offset:15616
 ds_read_b64_tr_b16 v[102:103], v212 offset:16896
 v_cvt_pk_bf16_f32 v180, v168, v169
 v_cvt_pk_bf16_f32 v181, v170, v171
 v_mfma_f32_32x32x16_bf16 a[192:207], v[140:143], v[52:55], a[192:207]
 v_cvt_pk_bf16_f32 v182, v172, v173
 v_mfma_f32_32x32x16_bf16 a[208:223], v[144:147], v[52:55], a[208:223]
 v_cvt_pk_bf16_f32 v183, v174, v175
 v_mfma_f32_32x32x16_bf16 a[224:239], v[148:151], v[52:55], a[224:239]
 s_mov_b32 s35, 90112
 buffer_store_dwordx4 v[180:183], v231, s[60:63], s35 offen offset:1024
 s_mov_b32 s25, s24
 s_add_u32 s24, s24, 24576
 s_cmp_eq_u32 s24, 147456
 s_cselect_b32 s24, 0, s24
 s_waitcnt lgkmcnt(0)
 v_mfma_f32_32x32x16_bf16 a[160:175], v[64:67], v[56:59], a[160:175]
 v_mfma_f32_32x32x16_bf16 a[176:191], v[68:71], v[56:59], a[176:191]
 v_mfma_f32_32x32x16_bf16 a[192:207], v[72:75], v[56:59], a[192:207]
 v_mfma_f32_32x32x16_bf16 a[208:223], v[76:79], v[56:59], a[208:223]
 v_mfma_f32_32x32x16_bf16 a[224:239], v[80:83], v[56:59], a[224:239]
 v_mfma_f32_32x32x16_bf16 a[160:175], v[84:87], v[60:63], a[160:175]
 v_mfma_f32_32x32x16_bf16 a[176:191], v[88:91], v[60:63], a[176:191]
 v_mfma_f32_32x32x16_bf16 a[192:207], v[92:95], v[60:63], a[192:207]
 v_mfma_f32_32x32x16_bf16 a[208:223], v[96:99], v[60:63], a[208:223]
 v_mfma_f32_32x32x16_bf16 a[224:239], v[100:103], v[60:63], a[224:239]
 s_nop 7
 s_nop 7
 v_accvgpr_read_b32 v160, a160
 v_accvgpr_read_b32 v161, a161
 v_accvgpr_read_b32 v162, a162
 v_accvgpr_read_b32 v163, a163
 v_accvgpr_read_b32 v164, a164
 v_accvgpr_read_b32 v165, a165
 v_accvgpr_read_b32 v166, a166
 v_accvgpr_read_b32 v167, a167
 v_cvt_pk_bf16_f32 v176, v160, v161
 v_cvt_pk_bf16_f32 v177, v162, v163
 v_cvt_pk_bf16_f32 v178, v164, v165
 v_cvt_pk_bf16_f32 v179, v166, v167
 s_mov_b32 s35, 122880
 buffer_store_dwordx4 v[176:179], v231, s[60:63], s35 offen offset:0
 v_accvgpr_read_b32 v168, a168
 v_accvgpr_read_b32 v169, a169
 v_accvgpr_read_b32 v170, a170
 v_accvgpr_read_b32 v171, a171
 v_accvgpr_read_b32 v172, a172
 v_accvgpr_read_b32 v173, a173
 v_accvgpr_read_b32 v174, a174
 v_accvgpr_read_b32 v175, a175
 v_cvt_pk_bf16_f32 v180, v168, v169
 v_cvt_pk_bf16_f32 v181, v170, v171
 v_cvt_pk_bf16_f32 v182, v172, v173
 v_cvt_pk_bf16_f32 v183, v174, v175
 s_mov_b32 s35, 122880
 buffer_store_dwordx4 v[180:183], v231, s[60:63], s35 offen offset:1024
 v_accvgpr_read_b32 v160, a176
 v_accvgpr_read_b32 v161, a177
 v_accvgpr_read_b32 v162, a178
 v_accvgpr_read_b32 v163, a179
 v_accvgpr_read_b32 v164, a180
 v_accvgpr_read_b32 v165, a181
 v_accvgpr_read_b32 v166, a182
 v_accvgpr_read_b32 v167, a183
 v_cvt_pk_bf16_f32 v184, v160, v161
 v_cvt_pk_bf16_f32 v185, v162, v163
 v_cvt_pk_bf16_f32 v186, v164, v165
 v_cvt_pk_bf16_f32 v187, v166, v167
 s_mov_b32 s35, 122880
 buffer_store_dwordx4 v[184:187], v231, s[60:63], s35 offen offset:2048
 v_accvgpr_read_b32 v168, a184
 v_accvgpr_read_b32 v169, a185
 v_accvgpr_read_b32 v170, a186
 v_accvgpr_read_b32 v171, a187
 v_accvgpr_read_b32 v172, a188
 v_accvgpr_read_b32 v173, a189
 v_accvgpr_read_b32 v174, a190
 v_accvgpr_read_b32 v175, a191
 v_cvt_pk_bf16_f32 v188, v168, v169
 v_cvt_pk_bf16_f32 v189, v170, v171
 v_cvt_pk_bf16_f32 v190, v172, v173
 v_cvt_pk_bf16_f32 v191, v174, v175
 s_mov_b32 s35, 122880
 buffer_store_dwordx4 v[188:191], v231, s[60:63], s35 offen offset:3072
 v_accvgpr_read_b32 v160, a192
 v_accvgpr_read_b32 v161, a193
 v_accvgpr_read_b32 v162, a194
 v_accvgpr_read_b32 v163, a195
 v_accvgpr_read_b32 v164, a196
 v_accvgpr_read_b32 v165, a197
 v_accvgpr_read_b32 v166, a198
 v_accvgpr_read_b32 v167, a199
 v_cvt_pk_bf16_f32 v176, v160, v161
 v_cvt_pk_bf16_f32 v177, v162, v163
 v_cvt_pk_bf16_f32 v178, v164, v165
 v_cvt_pk_bf16_f32 v179, v166, v167
 s_mov_b32 s35, 126976
 buffer_store_dwordx4 v[176:179], v231, s[60:63], s35 offen offset:0
 v_accvgpr_read_b32 v168, a200
 v_accvgpr_read_b32 v169, a201
 v_accvgpr_read_b32 v170, a202
 v_accvgpr_read_b32 v171, a203
 v_accvgpr_read_b32 v172, a204
 v_accvgpr_read_b32 v173, a205
 v_accvgpr_read_b32 v174, a206
 v_accvgpr_read_b32 v175, a207
 v_cvt_pk_bf16_f32 v180, v168, v169
 v_cvt_pk_bf16_f32 v181, v170, v171
 v_cvt_pk_bf16_f32 v182, v172, v173
 v_cvt_pk_bf16_f32 v183, v174, v175
 s_mov_b32 s35, 126976
 buffer_store_dwordx4 v[180:183], v231, s[60:63], s35 offen offset:1024
 v_accvgpr_read_b32 v160, a208
 v_accvgpr_read_b32 v161, a209
 v_accvgpr_read_b32 v162, a210
 v_accvgpr_read_b32 v163, a211
 v_accvgpr_read_b32 v164, a212
 v_accvgpr_read_b32 v165, a213
 v_accvgpr_read_b32 v166, a214
 v_accvgpr_read_b32 v167, a215
 v_cvt_pk_bf16_f32 v184, v160, v161
 v_cvt_pk_bf16_f32 v185, v162, v163
 v_cvt_pk_bf16_f32 v186, v164, v165
 v_cvt_pk_bf16_f32 v187, v166, v167
 s_mov_b32 s35, 126976
 buffer_store_dwordx4 v[184:187], v231, s[60:63], s35 offen offset:2048
 v_accvgpr_read_b32 v168, a216
 v_accvgpr_read_b32 v169, a217
 v_accvgpr_read_b32 v170, a218
 v_accvgpr_read_b32 v171, a219
 v_accvgpr_read_b32 v172, a220
 v_accvgpr_read_b32 v173, a221
 v_accvgpr_read_b32 v174, a222
 v_accvgpr_read_b32 v175, a223
 v_cvt_pk_bf16_f32 v188, v168, v169
 v_cvt_pk_bf16_f32 v189, v170, v171
 v_cvt_pk_bf16_f32 v190, v172, v173
 v_cvt_pk_bf16_f32 v191, v174, v175
 s_mov_b32 s35, 126976
 buffer_store_dwordx4 v[188:191], v231, s[60:63], s35 offen offset:3072
 v_accvgpr_read_b32 v160, a224
 v_accvgpr_read_b32 v161, a225
 v_accvgpr_read_b32 v162, a226
 v_accvgpr_read_b32 v163, a227
 v_accvgpr_read_b32 v164, a228
 v_accvgpr_read_b32 v165, a229
 v_accvgpr_read_b32 v166, a230
 v_accvgpr_read_b32 v167, a231
 v_cvt_pk_bf16_f32 v176, v160, v161
 v_cvt_pk_bf16_f32 v177, v162, v163
 v_cvt_pk_bf16_f32 v178, v164, v165
 v_cvt_pk_bf16_f32 v179, v166, v167
 s_mov_b32 s35, 131072
 buffer_store_dwordx4 v[176:179], v231, s[60:63], s35 offen offset:0
 v_accvgpr_read_b32 v168, a232
 v_accvgpr_read_b32 v169, a233
 v_accvgpr_read_b32 v170, a234
 v_accvgpr_read_b32 v171, a235
 v_accvgpr_read_b32 v172, a236
 v_accvgpr_read_b32 v173, a237
 v_accvgpr_read_b32 v174, a238
 v_accvgpr_read_b32 v175, a239
 v_cvt_pk_bf16_f32 v180, v168, v169
 v_cvt_pk_bf16_f32 v181, v170, v171
 v_cvt_pk_bf16_f32 v182, v172, v173
 v_cvt_pk_bf16_f32 v183, v174, v175
 s_mov_b32 s35, 131072
 buffer_store_dwordx4 v[180:183], v231, s[60:63], s35 offen offset:1024
L_fin:
L_k1_end:
 s_endpgm
L_rescale:
 s_nop 15
 v_mov_b32 v229, v228
 s_nop 1
 v_permlane32_swap_b32 v229, v228
 s_nop 1
 v_max3_f32 v229, v229, v228, v223
 v_sub_f32 v230, v223, v229
 v_mul_f32 v230, s32, v230
 v_exp_f32 v230, v230
 v_mov_b32 v223, v229
 v_mul_f32 v224, s32, v223
 v_add_f32 v225, s36, v223
 v_mul_f32 v226, v226, v230
 v_mul_f32 v227, v227, v230
 v_accvgpr_read_b32 v176, a160
 v_accvgpr_read_b32 v177, a161
 v_accvgpr_read_b32 v178, a162
 v_accvgpr_read_b32 v179, a163
 v_accvgpr_read_b32 v180, a164
 v_accvgpr_read_b32 v181, a165
 v_accvgpr_read_b32 v182, a166
 v_accvgpr_read_b32 v183, a167
 v_accvgpr_read_b32 v184, a168
 v_accvgpr_read_b32 v185, a169
 v_accvgpr_read_b32 v186, a170
 v_accvgpr_read_b32 v187, a171
 v_accvgpr_read_b32 v188, a172
 v_accvgpr_read_b32 v189, a173
 v_accvgpr_read_b32 v190, a174
 v_accvgpr_read_b32 v191, a175
 v_mul_f32 v176, v176, v230
 v_mul_f32 v177, v177, v230
 v_mul_f32 v178, v178, v230
 v_mul_f32 v179, v179, v230
 v_mul_f32 v180, v180, v230
 v_mul_f32 v181, v181, v230
 v_mul_f32 v182, v182, v230
 v_mul_f32 v183, v183, v230
 v_mul_f32 v184, v184, v230
 v_mul_f32 v185, v185, v230
 v_mul_f32 v186, v186, v230
 v_mul_f32 v187, v187, v230
 v_mul_f32 v188, v188, v230
 v_mul_f32 v189, v189, v230
 v_mul_f32 v190, v190, v230
 v_mul_f32 v191, v191, v230
 v_accvgpr_write_b32 a160, v176
 v_accvgpr_write_b32 a161, v177
 v_accvgpr_write_b32 a162, v178
 v_accvgpr_write_b32 a163, v179
 v_accvgpr_write_b32 a164, v180
 v_accvgpr_write_b32 a165, v181
 v_accvgpr_write_b32 a166, v182
 v_accvgpr_write_b32 a167, v183
 v_accvgpr_write_b32 a168, v184
 v_accvgpr_write_b32 a169, v185
 v_accvgpr_write_b32 a170, v186
 v_accvgpr_write_b32 a171, v187
 v_accvgpr_write_b32 a172, v188
 v_accvgpr_write_b32 a173, v189
 v_accvgpr_write_b32 a174, v190
 v_accvgpr_write_b32 a175, v191
 v_accvgpr_read_b32 v176, a176
 v_accvgpr_read_b32 v177, a177
 v_accvgpr_read_b32 v178, a178
 v_accvgpr_read_b32 v179, a179
 v_accvgpr_read_b32 v180, a180
 v_accvgpr_read_b32 v181, a181
 v_accvgpr_read_b32 v182, a182
 v_accvgpr_read_b32 v183, a183
 v_accvgpr_read_b32 v184, a184
 v_accvgpr_read_b32 v185, a185
 v_accvgpr_read_b32 v186, a186
 v_accvgpr_read_b32 v187, a187
 v_accvgpr_read_b32 v188, a188
 v_accvgpr_read_b32 v189, a189
 v_accvgpr_read_b32 v190, a190
 v_accvgpr_read_b32 v191, a191
 v_mul_f32 v176, v176, v230
 v_mul_f32 v177, v177, v230
 v_mul_f32 v178, v178, v230
 v_mul_f32 v179, v179, v230
 v_mul_f32 v180, v180, v230
 v_mul_f32 v181, v181, v230
 v_mul_f32 v182, v182, v230
 v_mul_f32 v183, v183, v230
 v_mul_f32 v184, v184, v230
 v_mul_f32 v185, v185, v230
 v_mul_f32 v186, v186, v230
 v_mul_f32 v187, v187, v230
 v_mul_f32 v188, v188, v230
 v_mul_f32 v189, v189, v230
 v_mul_f32 v190, v190, v230
 v_mul_f32 v191, v191, v230
 v_accvgpr_write_b32 a176, v176
 v_accvgpr_write_b32 a177, v177
 v_accvgpr_write_b32 a178, v178
 v_accvgpr_write_b32 a179, v179
 v_accvgpr_write_b32 a180, v180
 v_accvgpr_write_b32 a181, v181
 v_accvgpr_write_b32 a182, v182
 v_accvgpr_write_b32 a183, v183
 v_accvgpr_write_b32 a184, v184
 v_accvgpr_write_b32 a185, v185
 v_accvgpr_write_b32 a186, v186
 v_accvgpr_write_b32 a187, v187
 v_accvgpr_write_b32 a188, v188
 v_accvgpr_write_b32 a189, v189
 v_accvgpr_write_b32 a190, v190
 v_accvgpr_write_b32 a191, v191
 v_accvgpr_read_b32 v176, a192
 v_accvgpr_read_b32 v177, a193
 v_accvgpr_read_b32 v178, a194
 v_accvgpr_read_b32 v179, a195
 v_accvgpr_read_b32 v180, a196
 v_accvgpr_read_b32 v181, a197
 v_accvgpr_read_b32 v182, a198
 v_accvgpr_read_b32 v183, a199
 v_accvgpr_read_b32 v184, a200
 v_accvgpr_read_b32 v185, a201
 v_accvgpr_read_b32 v186, a202
 v_accvgpr_read_b32 v187, a203
 v_accvgpr_read_b32 v188, a204
 v_accvgpr_read_b32 v189, a205
 v_accvgpr_read_b32 v190, a206
 v_accvgpr_read_b32 v191, a207
 v_mul_f32 v176, v176, v230
 v_mul_f32 v177, v177, v230
 v_mul_f32 v178, v178, v230
 v_mul_f32 v179, v179, v230
 v_mul_f32 v180, v180, v230
 v_mul_f32 v181, v181, v230
 v_mul_f32 v182, v182, v230
 v_mul_f32 v183, v183, v230
 v_mul_f32 v184, v184, v230
 v_mul_f32 v185, v185, v230
 v_mul_f32 v186, v186, v230
 v_mul_f32 v187, v187, v230
 v_mul_f32 v188, v188, v230
 v_mul_f32 v189, v189, v230
 v_mul_f32 v190, v190, v230
 v_mul_f32 v191, v191, v230
 v_accvgpr_write_b32 a192, v176
 v_accvgpr_write_b32 a193, v177
 v_accvgpr_write_b32 a194, v178
 v_accvgpr_write_b32 a195, v179
 v_accvgpr_write_b32 a196, v180
 v_accvgpr_write_b32 a197, v181
 v_accvgpr_write_b32 a198, v182
 v_accvgpr_write_b32 a199, v183
 v_accvgpr_write_b32 a200, v184
 v_accvgpr_write_b32 a201, v185
 v_accvgpr_write_b32 a202, v186
 v_accvgpr_write_b32 a203, v187
 v_accvgpr_write_b32 a204, v188
 v_accvgpr_write_b32 a205, v189
 v_accvgpr_write_b32 a206, v190
 v_accvgpr_write_b32 a207, v191
 v_accvgpr_read_b32 v176, a208
 v_accvgpr_read_b32 v177, a209
 v_accvgpr_read_b32 v178, a210
 v_accvgpr_read_b32 v179, a211
 v_accvgpr_read_b32 v180, a212
 v_accvgpr_read_b32 v181, a213
 v_accvgpr_read_b32 v182, a214
 v_accvgpr_read_b32 v183, a215
 v_accvgpr_read_b32 v184, a216
 v_accvgpr_read_b32 v185, a217
 v_accvgpr_read_b32 v186, a218
 v_accvgpr_read_b32 v187, a219
 v_accvgpr_read_b32 v188, a220
 v_accvgpr_read_b32 v189, a221
 v_accvgpr_read_b32 v190, a222
 v_accvgpr_read_b32 v191, a223
 v_mul_f32 v176, v176, v230
 v_mul_f32 v177, v177, v230
 v_mul_f32 v178, v178, v230
 v_mul_f32 v179, v179, v230
 v_mul_f32 v180, v180, v230
 v_mul_f32 v181, v181, v230
 v_mul_f32 v182, v182, v230
 v_mul_f32 v183, v183, v230
 v_mul_f32 v184, v184, v230
 v_mul_f32 v185, v185, v230
 v_mul_f32 v186, v186, v230
 v_mul_f32 v187, v187, v230
 v_mul_f32 v188, v188, v230
 v_mul_f32 v189, v189, v230
 v_mul_f32 v190, v190, v230
 v_mul_f32 v191, v191, v230
 v_accvgpr_write_b32 a208, v176
 v_accvgpr_write_b32 a209, v177
 v_accvgpr_write_b32 a210, v178
 v_accvgpr_write_b32 a211, v179
 v_accvgpr_write_b32 a212, v180
 v_accvgpr_write_b32 a213, v181
 v_accvgpr_write_b32 a214, v182
 v_accvgpr_write_b32 a215, v183
 v_accvgpr_write_b32 a216, v184
 v_accvgpr_write_b32 a217, v185
 v_accvgpr_write_b32 a218, v186
 v_accvgpr_write_b32 a219, v187
 v_accvgpr_write_b32 a220, v188
 v_accvgpr_write_b32 a221, v189
 v_accvgpr_write_b32 a222, v190
 v_accvgpr_write_b32 a223, v191
 v_accvgpr_read_b32 v176, a224
 v_accvgpr_read_b32 v177, a225
 v_accvgpr_read_b32 v178, a226
 v_accvgpr_read_b32 v179, a227
 v_accvgpr_read_b32 v180, a228
 v_accvgpr_read_b32 v181, a229
 v_accvgpr_read_b32 v182, a230
 v_accvgpr_read_b32 v183, a231
 v_accvgpr_read_b32 v184, a232
 v_accvgpr_read_b32 v185, a233
 v_accvgpr_read_b32 v186, a234
 v_accvgpr_read_b32 v187, a235
 v_accvgpr_read_b32 v188, a236
 v_accvgpr_read_b32 v189, a237
 v_accvgpr_read_b32 v190, a238
 v_accvgpr_read_b32 v191, a239
 v_mul_f32 v176, v176, v230
 v_mul_f32 v177, v177, v230
 v_mul_f32 v178, v178, v230
 v_mul_f32 v179, v179, v230
 v_mul_f32 v180, v180, v230
 v_mul_f32 v181, v181, v230
 v_mul_f32 v182, v182, v230
 v_mul_f32 v183, v183, v230
 v_mul_f32 v184, v184, v230
 v_mul_f32 v185, v185, v230
 v_mul_f32 v186, v186, v230
 v_mul_f32 v187, v187, v230
 v_mul_f32 v188, v188, v230
 v_mul_f32 v189, v189, v230
 v_mul_f32 v190, v190, v230
 v_mul_f32 v191, v191, v230
 v_accvgpr_write_b32 a224, v176
 v_accvgpr_write_b32 a225, v177
 v_accvgpr_write_b32 a226, v178
 v_accvgpr_write_b32 a227, v179
 v_accvgpr_write_b32 a228, v180
 v_accvgpr_write_b32 a229, v181
 v_accvgpr_write_b32 a230, v182
 v_accvgpr_write_b32 a231, v183
 v_accvgpr_write_b32 a232, v184
 v_accvgpr_write_b32 a233, v185
 v_accvgpr_write_b32 a234, v186
 v_accvgpr_write_b32 a235, v187
 v_accvgpr_write_b32 a236, v188
 v_accvgpr_write_b32 a237, v189
 v_accvgpr_write_b32 a238, v190
 v_accvgpr_write_b32 a239, v191
 v_accvgpr_read_b32 v176, a240
 v_accvgpr_read_b32 v177, a241
 v_accvgpr_read_b32 v178, a242
 v_accvgpr_read_b32 v179, a243
 v_accvgpr_read_b32 v180, a244
 v_accvgpr_read_b32 v181, a245
 v_accvgpr_read_b32 v182, a246
 v_accvgpr_read_b32 v183, a247
 v_accvgpr_read_b32 v184, a248
 v_accvgpr_read_b32 v185, a249
 v_accvgpr_read_b32 v186, a250
 v_accvgpr_read_b32 v187, a251
 v_accvgpr_read_b32 v188, a252
 v_accvgpr_read_b32 v189, a253
 v_accvgpr_read_b32 v190, a254
 v_accvgpr_read_b32 v191, a255
 v_mul_f32 v176, v176, v230
 v_mul_f32 v177, v177, v230
 v_mul_f32 v178, v178, v230
 v_mul_f32 v179, v179, v230
 v_mul_f32 v180, v180, v230
 v_mul_f32 v181, v181, v230
 v_mul_f32 v182, v182, v230
 v_mul_f32 v183, v183, v230
 v_mul_f32 v184, v184, v230
 v_mul_f32 v185, v185, v230
 v_mul_f32 v186, v186, v230
 v_mul_f32 v187, v187, v230
 v_mul_f32 v188, v188, v230
 v_mul_f32 v189, v189, v230
 v_mul_f32 v190, v190, v230
 v_mul_f32 v191, v191, v230
 v_accvgpr_write_b32 a240, v176
 v_accvgpr_write_b32 a241, v177
 v_accvgpr_write_b32 a242, v178
 v_accvgpr_write_b32 a243, v179
 v_accvgpr_write_b32 a244, v180
 v_accvgpr_write_b32 a245, v181
 v_accvgpr_write_b32 a246, v182
 v_accvgpr_write_b32 a247, v183
 v_accvgpr_write_b32 a248, v184
 v_accvgpr_write_b32 a249, v185
 v_accvgpr_write_b32 a250, v186
 v_accvgpr_write_b32 a251, v187
 v_accvgpr_write_b32 a252, v188
 v_accvgpr_write_b32 a253, v189
 v_accvgpr_write_b32 a254, v190
 v_accvgpr_write_b32 a255, v191
 v_fma_f32 v176, v160, s32, -v224
 v_fma_f32 v177, v161, s32, -v224
 v_fma_f32 v178, v162, s32, -v224
 v_fma_f32 v179, v163, s32, -v224
 v_fma_f32 v180, v164, s32, -v224
 v_fma_f32 v181, v165, s32, -v224
 v_fma_f32 v182, v166, s32, -v224
 v_fma_f32 v183, v167, s32, -v224
 v_fma_f32 v184, v168, s32, -v224
 v_fma_f32 v185, v169, s32, -v224
 v_fma_f32 v186, v170, s32, -v224
 v_fma_f32 v187, v171, s32, -v224
 v_fma_f32 v188, v172, s32, -v224
 v_fma_f32 v189, v173, s32, -v224
 v_fma_f32 v190, v174, s32, -v224
 v_fma_f32 v191, v175, s32, -v224
 s_setpc_b64 s[30:31]
.p2align 6
L_sub0:
 s_waitcnt  lgkmcnt(0)
 s_barrier
 v_mfma_f32_32x32x16_bf16 v[160:175], v[64:67], v[16:19], 0
 ds_read_b64_tr_b16 v[112:113], v212 offset:0
 ds_read_b64_tr_b16 v[114:115], v212 offset:3072
 ds_read_b64_tr_b16 v[116:117], v213 offset:0
 v_exp_f32 v176, v176
 v_exp_f32 v177, v177
 v_exp_f32 v178, v178
 v_mfma_f32_32x32x16_bf16 v[160:175], v[68:71], v[20:23], v[160:175]
 ds_read_b64_tr_b16 v[118:119], v213 offset:3072
 ds_read_b64_tr_b16 v[120:121], v212 offset:128
 v_exp_f32 v179, v179
 v_add_f32 v226, v226, v176
 v_mfma_f32_32x32x16_bf16 v[160:175], v[72:75], v[24:27], v[160:175]
 ds_read_b64_tr_b16 v[122:123], v212 offset:3200
 ds_read_b64_tr_b16 v[124:125], v213 offset:128
 v_add_f32 v227, v227, v177
 v_cvt_pk_bf16_f32 v192, v176, v177
 v_exp_f32 v180, v180
 v_mfma_f32_32x32x16_bf16 v[160:175], v[76:79], v[28:31], v[160:175]
 ds_read_b64_tr_b16 v[126:127], v213 offset:3200
 ds_read_b64_tr_b16 v[128:129], v212 offset:256
 v_exp_f32 v181, v181
 v_add_f32 v226, v226, v178
 v_mfma_f32_32x32x16_bf16 v[160:175], v[80:83], v[32:35], v[160:175]
 ds_read_b64_tr_b16 v[130:131], v212 offset:3328
 ds_read_b64_tr_b16 v[132:133], v213 offset:256
 v_add_f32 v227, v227, v179
 v_cvt_pk_bf16_f32 v193, v178, v179
 v_exp_f32 v182, v182
 v_mfma_f32_32x32x16_bf16 v[160:175], v[84:87], v[36:39], v[160:175]
 ds_read_b64_tr_b16 v[134:135], v213 offset:3328
 ds_read_b64_tr_b16 v[136:137], v212 offset:6144
 ds_read_b64_tr_b16 v[138:139], v212 offset:9216
 v_exp_f32 v183, v183
 v_add_f32 v226, v226, v180
 v_mfma_f32_32x32x16_bf16 v[160:175], v[88:91], v[40:43], v[160:175]
 ds_read_b64_tr_b16 v[140:141], v213 offset:6144
 ds_read_b64_tr_b16 v[142:143], v213 offset:9216
 v_add_f32 v227, v227, v181
 v_cvt_pk_bf16_f32 v194, v180, v181
 v_exp_f32 v184, v184
 v_mfma_f32_32x32x16_bf16 v[160:175], v[92:95], v[44:47], v[160:175]
 ds_read_b64_tr_b16 v[144:145], v212 offset:6272
 ds_read_b64_tr_b16 v[146:147], v212 offset:9344
 v_exp_f32 v185, v185
 v_add_f32 v226, v226, v182
 v_mfma_f32_32x32x16_bf16 v[160:175], v[96:99], v[48:51], v[160:175]
 ds_read_b64_tr_b16 v[148:149], v213 offset:6272
 ds_read_b64_tr_b16 v[150:151], v213 offset:9344
 v_add_f32 v227, v227, v183
 v_cvt_pk_bf16_f32 v195, v182, v183
 v_exp_f32 v186, v186
 v_mfma_f32_32x32x16_bf16 v[160:175], v[100:103], v[52:55], v[160:175]
 ds_read_b64_tr_b16 v[152:153], v212 offset:6400
 ds_read_b64_tr_b16 v[154:155], v212 offset:9472
 v_exp_f32 v187, v187
 v_add_f32 v226, v226, v184
 v_mfma_f32_32x32x16_bf16 v[160:175], v[104:107], v[56:59], v[160:175]
 ds_read_b64_tr_b16 v[156:157], v213 offset:6400
 ds_read_b64_tr_b16 v[158:159], v213 offset:9472
 v_add_f32 v227, v227, v185
 v_cvt_pk_bf16_f32 v196, v184, v185
 v_exp_f32 v188, v188
 v_mfma_f32_32x32x16_bf16 v[160:175], v[108:111], v[60:63], v[160:175]
 v_exp_f32 v189, v189
 v_add_f32 v226, v226, v186
 v_add_u32 v208, s24, v200
 v_xor_b32 v209, 32, v208
 v_xor_b32 v210, 64, v208
 v_xor_b32 v211, 96, v208
 s_waitcnt lgkmcnt(6)
 v_mfma_f32_32x32x16_bf16 a[160:175], v[112:115], v[192:195], a[160:175]
 v_add_f32 v227, v227, v187
 v_cvt_pk_bf16_f32 v197, v186, v187
 v_exp_f32 v190, v190
 v_exp_f32 v191, v191
 ds_read_b128 v[64:67], v208 offset:12288
 ds_read_b128 v[68:71], v209 offset:12288
 s_add_u32 m0, s25, s40
 s_nop 0
 buffer_load_dwordx4 v217, s[12:15], s28 offen offset:0 nt lds
 v_mfma_f32_32x32x16_bf16 a[176:191], v[116:119], v[192:195], a[176:191]
 v_add_f32 v226, v226, v188
 v_add_f32 v227, v227, v189
 v_cvt_pk_bf16_f32 v198, v188, v189
 ds_read_b128 v[72:75], v210 offset:12288
 buffer_load_dwordx4 v218, s[12:15], s28 offen offset:1024 nt lds
 v_mfma_f32_32x32x16_bf16 a[192:207], v[120:123], v[192:195], a[192:207]
 v_add_f32 v226, v226, v190
 v_add_f32 v227, v227, v191
 v_cvt_pk_bf16_f32 v199, v190, v191
 ds_read_b128 v[76:79], v211 offset:12288
 ds_read_b128 v[80:83], v208 offset:12416
 v_mfma_f32_32x32x16_bf16 a[208:223], v[124:127], v[192:195], a[208:223]
 ds_read_b128 v[84:87], v209 offset:12416
 v_max3_f32 v228, v160, v161, v162
 v_max3_f32 v228, v228, v163, v164
 v_max3_f32 v228, v228, v165, v166
 buffer_load_dwordx4 v219, s[12:15], s28 offen offset:2048 nt lds
 s_add_u32 s28, s28, 12288
 v_mfma_f32_32x32x16_bf16 a[224:239], v[128:131], v[192:195], a[224:239]
 ds_read_b128 v[88:91], v210 offset:12416
 ds_read_b128 v[92:95], v211 offset:12416
 v_max3_f32 v228, v228, v167, v168
 v_max3_f32 v228, v228, v169, v170
 v_max3_f32 v228, v228, v171, v172
 v_mfma_f32_32x32x16_bf16 a[240:255], v[132:135], v[192:195], a[240:255]
 ds_read_b128 v[96:99], v208 offset:12544
 v_max3_f32 v228, v228, v173, v174
 v_max_f32 v228, v228, v175
 v_cmp_gt_f32 vcc, v228, v225
 s_add_u32 m0, s25, s41
 s_nop 0
 buffer_load_dwordx4 v214, s[8:11], s27 offen offset:0 nt lds
 s_waitcnt lgkmcnt(9)
 v_mfma_f32_32x32x16_bf16 a[160:175], v[136:139], v[196:199], a[160:175]
 ds_read_b128 v[100:103], v209 offset:12544
 ds_read_b128 v[104:107], v210 offset:12544
 v_fma_f32 v176, v160, s32, -v224
 v_fma_f32 v177, v161, s32, -v224
 v_fma_f32 v178, v162, s32, -v224
 v_fma_f32 v179, v163, s32, -v224
 v_mfma_f32_32x32x16_bf16 a[176:191], v[140:143], v[196:199], a[176:191]
 ds_read_b128 v[108:111], v211 offset:12544
 v_fma_f32 v180, v164, s32, -v224
 v_fma_f32 v181, v165, s32, -v224
 v_fma_f32 v182, v166, s32, -v224
 buffer_load_dwordx4 v215, s[8:11], s27 offen offset:1024 nt lds
 v_mfma_f32_32x32x16_bf16 a[192:207], v[144:147], v[196:199], a[192:207]
 v_fma_f32 v183, v167, s32, -v224
 v_fma_f32 v184, v168, s32, -v224
 v_fma_f32 v185, v169, s32, -v224
 v_mfma_f32_32x32x16_bf16 a[208:223], v[148:151], v[196:199], a[208:223]
 v_fma_f32 v186, v170, s32, -v224
 v_fma_f32 v187, v171, s32, -v224
 v_fma_f32 v188, v172, s32, -v224
 buffer_load_dwordx4 v216, s[8:11], s27 offen offset:2048 nt lds
 s_add_u32 s27, s27, 12288
 v_mfma_f32_32x32x16_bf16 a[224:239], v[152:155], v[196:199], a[224:239]
 v_fma_f32 v189, v173, s32, -v224
 v_fma_f32 v190, v174, s32, -v224
 v_fma_f32 v191, v175, s32, -v224
 v_mfma_f32_32x32x16_bf16 a[240:255], v[156:159], v[196:199], a[240:255]
 s_mov_b32 s25, s24
 s_add_u32 s24, s24, 24576
 s_cmp_eq_u32 s24, 147456
 s_cselect_b32 s24, 0, s24
 v_add_u32 v212, s24, v204
 v_xor_b32 v213, 64, v212
 s_cbranch_vccz L_skip2
 s_call_b64 s[30:31], L_rescale
L_skip2:
 s_setpc_b64 s[72:73]
.p2align 6
L_sub33:
 v_add_u32 v212, s24, v206
 v_xor_b32 v213, 64, v212
 s_waitcnt  lgkmcnt(0)
 s_barrier
 ds_read_b64_tr_b16 v[112:113], v212 offset:0
 ds_read_b64_tr_b16 v[114:115], v212 offset:512
 ds_read_b64_tr_b16 v[116:117], v213 offset:0
 ds_read_b64_tr_b16 v[118:119], v213 offset:512
 ds_read_b64_tr_b16 v[120:121], v212 offset:1024
 ds_read_b64_tr_b16 v[122:123], v212 offset:1536
 ds_read_b64_tr_b16 v[124:125], v213 offset:1024
 ds_read_b64_tr_b16 v[126:127], v213 offset:1536
 ds_read_b64_tr_b16 v[128:129], v212 offset:4096
 ds_read_b64_tr_b16 v[130:131], v212 offset:4608
 ds_read_b64_tr_b16 v[132:133], v213 offset:4096
 ds_read_b64_tr_b16 v[134:135], v213 offset:4608
 ds_read_b64_tr_b16 v[136:137], v212 offset:5120
 ds_read_b64_tr_b16 v[138:139], v212 offset:5632
 v_exp_f32 v176, v176
 v_exp_f32 v177, v177
 v_exp_f32 v178, v178
 v_exp_f32 v179, v179
 v_add_f32 v226, v226, v176
 v_add_f32 v227, v227, v177
 v_cvt_pk_bf16_f32 v192, v176, v177
 s_waitcnt lgkmcnt(6)
 v_mfma_f32_32x32x16_bf16 v[0:15], v[112:115], a[0:3], 0
 ds_read_b64_tr_b16 v[140:141], v213 offset:5120
 ds_read_b64_tr_b16 v[142:143], v213 offset:5632
 v_exp_f32 v180, v180
 v_exp_f32 v181, v181
 v_add_f32 v226, v226, v178
 v_mfma_f32_32x32x16_bf16 v[240:255], v[116:119], a[0:3], 0
 ds_read_b64_tr_b16 v[144:145], v212 offset:8192
 ds_read_b64_tr_b16 v[146:147], v212 offset:8704
 v_add_f32 v227, v227, v179
 v_cvt_pk_bf16_f32 v193, v178, v179
 v_mfma_f32_32x32x16_bf16 v[0:15], v[120:123], a[4:7], v[0:15]
 ds_read_b64_tr_b16 v[148:149], v213 offset:8192
 ds_read_b64_tr_b16 v[150:151], v213 offset:8704
 v_exp_f32 v182, v182
 v_exp_f32 v183, v183
 s_add_u32 m0, s25, s40
 s_nop 0
 buffer_load_dwordx4 v217, s[12:15], s28 offen offset:0 nt lds
 v_mfma_f32_32x32x16_bf16 v[240:255], v[124:127], a[4:7], v[240:255]
 ds_read_b64_tr_b16 v[152:153], v212 offset:9216
 ds_read_b64_tr_b16 v[154:155], v212 offset:9728
 v_add_f32 v226, v226, v180
 v_add_f32 v227, v227, v181
 s_waitcnt lgkmcnt(6)
 v_mfma_f32_32x32x16_bf16 v[0:15], v[128:131], a[8:11], v[0:15]
 ds_read_b64_tr_b16 v[156:157], v213 offset:9216
 ds_read_b64_tr_b16 v[158:159], v213 offset:9728
 v_cvt_pk_bf16_f32 v194, v180, v181
 v_exp_f32 v184, v184
 buffer_load_dwordx4 v218, s[12:15], s28 offen offset:1024 nt lds
 v_mfma_f32_32x32x16_bf16 v[240:255], v[132:135], a[8:11], v[240:255]
 ds_read_b64_tr_b16 v[160:161], v212 offset:12288
 ds_read_b64_tr_b16 v[162:163], v212 offset:12800
 v_exp_f32 v185, v185
 v_add_f32 v226, v226, v182
 v_add_f32 v227, v227, v183
 v_mfma_f32_32x32x16_bf16 v[0:15], v[136:139], a[12:15], v[0:15]
 ds_read_b64_tr_b16 v[164:165], v213 offset:12288
 ds_read_b64_tr_b16 v[166:167], v213 offset:12800
 v_cvt_pk_bf16_f32 v195, v182, v183
 v_exp_f32 v186, v186
 v_mfma_f32_32x32x16_bf16 v[240:255], v[140:143], a[12:15], v[240:255]
 ds_read_b64_tr_b16 v[168:169], v212 offset:13312
 ds_read_b64_tr_b16 v[170:171], v212 offset:13824
 v_exp_f32 v187, v187
 v_add_f32 v226, v226, v184
 buffer_load_dwordx4 v219, s[12:15], s28 offen offset:2048 nt lds
 s_add_u32 s28, s28, 12288
 s_waitcnt lgkmcnt(6)
 v_mfma_f32_32x32x16_bf16 v[0:15], v[144:147], a[16:19], v[0:15]
 ds_read_b64_tr_b16 v[172:173], v213 offset:13312
 ds_read_b64_tr_b16 v[174:175], v213 offset:13824
 v_add_f32 v227, v227, v185
 v_cvt_pk_bf16_f32 v196, v184, v185
 v_mfma_f32_32x32x16_bf16 v[240:255], v[148:151], a[16:19], v[240:255]
 ds_read_b64_tr_b16 v[112:113], v212 offset:16384
 ds_read_b64_tr_b16 v[114:115], v212 offset:16896
 v_exp_f32 v188, v188
 v_exp_f32 v189, v189
 v_mfma_f32_32x32x16_bf16 v[0:15], v[152:155], a[20:23], v[0:15]
 ds_read_b64_tr_b16 v[116:117], v213 offset:16384
 ds_read_b64_tr_b16 v[118:119], v213 offset:16896
 v_add_f32 v226, v226, v186
 v_add_f32 v227, v227, v187
 v_cvt_pk_bf16_f32 v197, v186, v187
 s_add_u32 m0, s25, s41
 s_nop 0
 buffer_load_dwordx4 v214, s[8:11], s27 offen offset:0 nt lds
 v_mfma_f32_32x32x16_bf16 v[240:255], v[156:159], a[20:23], v[240:255]
 ds_read_b64_tr_b16 v[120:121], v212 offset:17408
 ds_read_b64_tr_b16 v[122:123], v212 offset:17920
 v_exp_f32 v190, v190
 v_exp_f32 v191, v191
 s_waitcnt lgkmcnt(6)
 v_mfma_f32_32x32x16_bf16 v[0:15], v[160:163], a[24:27], v[0:15]
 ds_read_b64_tr_b16 v[124:125], v213 offset:17408
 ds_read_b64_tr_b16 v[126:127], v213 offset:17920
 v_add_f32 v226, v226, v188
 v_add_f32 v227, v227, v189
 buffer_load_dwordx4 v215, s[8:11], s27 offen offset:1024 nt lds
 v_mfma_f32_32x32x16_bf16 v[240:255], v[164:167], a[24:27], v[240:255]
 v_cvt_pk_bf16_f32 v198, v188, v189
 v_add_f32 v226, v226, v190
 v_mfma_f32_32x32x16_bf16 v[0:15], v[168:171], a[28:31], v[0:15]
 v_add_f32 v227, v227, v191
 v_cvt_pk_bf16_f32 v199, v190, v191
 v_mfma_f32_32x32x16_bf16 v[240:255], v[172:175], a[28:31], v[240:255]
 buffer_load_dwordx4 v216, s[8:11], s27 offen offset:2048 nt lds
 s_add_u32 s27, s27, 12288
 s_waitcnt lgkmcnt(0)
 v_mfma_f32_32x32x16_bf16 v[0:15], v[112:115], a[32:35], v[0:15]
 v_mfma_f32_32x32x16_bf16 v[240:255], v[116:119], a[32:35], v[240:255]
 v_mfma_f32_32x32x16_bf16 v[0:15], v[120:123], a[36:39], v[0:15]
 v_mfma_f32_32x32x16_bf16 v[240:255], v[124:127], a[36:39], v[240:255]
 s_mov_b32 s25, s24
 s_add_u32 s24, s24, 24576
 s_cmp_eq_u32 s24, 147456
 s_cselect_b32 s24, 0, s24
 v_add_u32 v212, s24, v204
 v_xor_b32 v213, 64, v212
 s_setpc_b64 s[72:73]
.p2align 6
L_sub36:
 s_waitcnt  lgkmcnt(0)
 s_barrier
 v_mfma_f32_32x32x16_bf16 v[160:175], v[64:67], v[16:19], 0
 ds_read_b64_tr_b16 v[112:113], v212 offset:0
 ds_read_b64_tr_b16 v[114:115], v212 offset:3072
 ds_read_b64_tr_b16 v[116:117], v213 offset:0
 v_mfma_f32_32x32x16_bf16 v[160:175], v[68:71], v[20:23], v[160:175]
 ds_read_b64_tr_b16 v[118:119], v213 offset:3072
 ds_read_b64_tr_b16 v[120:121], v212 offset:128
 v_mfma_f32_32x32x16_bf16 v[160:175], v[72:75], v[24:27], v[160:175]
 ds_read_b64_tr_b16 v[122:123], v212 offset:3200
 ds_read_b64_tr_b16 v[124:125], v213 offset:128
 v_mfma_f32_32x32x16_bf16 v[160:175], v[76:79], v[28:31], v[160:175]
 ds_read_b64_tr_b16 v[126:127], v213 offset:3200
 ds_read_b64_tr_b16 v[128:129], v212 offset:256
 v_mfma_f32_32x32x16_bf16 v[160:175], v[80:83], v[32:35], v[160:175]
 ds_read_b64_tr_b16 v[130:131], v212 offset:3328
 ds_read_b64_tr_b16 v[132:133], v213 offset:256
 v_mfma_f32_32x32x16_bf16 v[160:175], v[84:87], v[36:39], v[160:175]
 ds_read_b64_tr_b16 v[134:135], v213 offset:3328
 ds_read_b64_tr_b16 v[136:137], v212 offset:6144
 ds_read_b64_tr_b16 v[138:139], v212 offset:9216
 v_mfma_f32_32x32x16_bf16 v[160:175], v[88:91], v[40:43], v[160:175]
 ds_read_b64_tr_b16 v[140:141], v213 offset:6144
 ds_read_b64_tr_b16 v[142:143], v213 offset:9216
 v_mfma_f32_32x32x16_bf16 v[160:175], v[92:95], v[44:47], v[160:175]
 ds_read_b64_tr_b16 v[144:145], v212 offset:6272
 ds_read_b64_tr_b16 v[146:147], v212 offset:9344
 v_mfma_f32_32x32x16_bf16 v[160:175], v[96:99], v[48:51], v[160:175]
 ds_read_b64_tr_b16 v[148:149], v213 offset:6272
 ds_read_b64_tr_b16 v[150:151], v213 offset:9344
 v_mfma_f32_32x32x16_bf16 v[160:175], v[100:103], v[52:55], v[160:175]
 ds_read_b64_tr_b16 v[152:153], v212 offset:6400
 ds_read_b64_tr_b16 v[154:155], v212 offset:9472
 v_mfma_f32_32x32x16_bf16 v[160:175], v[104:107], v[56:59], v[160:175]
 ds_read_b64_tr_b16 v[156:157], v213 offset:6400
 ds_read_b64_tr_b16 v[158:159], v213 offset:9472
 v_mfma_f32_32x32x16_bf16 v[160:175], v[108:111], v[60:63], v[160:175]
 v_add_u32 v208, s24, v200
 v_xor_b32 v209, 32, v208
 v_xor_b32 v210, 64, v208
 v_xor_b32 v211, 96, v208
 s_waitcnt lgkmcnt(6)
 v_mfma_f32_32x32x16_bf16 a[160:175], v[112:115], v[192:195], a[160:175]
 ds_read_b128 v[64:67], v208 offset:12288
 ds_read_b128 v[68:71], v209 offset:12288
 s_add_u32 m0, s25, s42
 s_add_u32 s29, s29, 0
 buffer_load_dwordx4 v220, s[16:19], s29 offen offset:0 lds
 v_mfma_f32_32x32x16_bf16 a[176:191], v[116:119], v[192:195], a[176:191]
 ds_read_b128 v[72:75], v210 offset:12288
 v_mfma_f32_32x32x16_bf16 a[192:207], v[120:123], v[192:195], a[192:207]
 ds_read_b128 v[76:79], v211 offset:12288
 ds_read_b128 v[80:83], v208 offset:12416
 s_add_u32 s29, s29, 97280
 buffer_load_dwordx4 v220, s[16:19], s29 offen offset:1024 lds
 v_mfma_f32_32x32x16_bf16 a[208:223], v[124:127], v[192:195], a[208:223]
 ds_read_b128 v[84:87], v209 offset:12416
 v_max3_f32 v228, v160, v161, v162
 v_max3_f32 v228, v228, v163, v164
 v_max3_f32 v228, v228, v165, v166
 v_mfma_f32_32x32x16_bf16 a[224:239], v[128:131], v[192:195], a[224:239]
 ds_read_b128 v[88:91], v210 offset:12416
 ds_read_b128 v[92:95], v211 offset:12416
 v_max3_f32 v228, v228, v167, v168
 v_max3_f32 v228, v228, v169, v170
 v_max3_f32 v228, v228, v171, v172
 s_add_u32 s29, s29, 97280
 buffer_load_dwordx4 v220, s[16:19], s29 offen offset:2048 lds
 v_mfma_f32_32x32x16_bf16 a[240:255], v[132:135], v[192:195], a[240:255]
 ds_read_b128 v[96:99], v208 offset:12544
 v_max3_f32 v228, v228, v173, v174
 v_max_f32 v228, v228, v175
 v_cmp_gt_f32 vcc, v228, v225
 s_waitcnt lgkmcnt(9)
 v_mfma_f32_32x32x16_bf16 a[160:175], v[136:139], v[196:199], a[160:175]
 ds_read_b128 v[100:103], v209 offset:12544
 ds_read_b128 v[104:107], v210 offset:12544
 v_fma_f32 v176, v160, s32, -v224
 v_fma_f32 v177, v161, s32, -v224
 v_fma_f32 v178, v162, s32, -v224
 v_fma_f32 v179, v163, s32, -v224
 s_add_u32 s29, s29, 97280
 buffer_load_dwordx4 v220, s[16:19], s29 offen offset:3072 lds
 v_mfma_f32_32x32x16_bf16 a[176:191], v[140:143], v[196:199], a[176:191]
 ds_read_b128 v[108:111], v211 offset:12544
 v_fma_f32 v180, v164, s32, -v224
 v_fma_f32 v181, v165, s32, -v224
 v_fma_f32 v182, v166, s32, -v224
 v_mfma_f32_32x32x16_bf16 a[192:207], v[144:147], v[196:199], a[192:207]
 v_fma_f32 v183, v167, s32, -v224
 v_fma_f32 v184, v168, s32, -v224
 v_fma_f32 v185, v169, s32, -v224
 s_add_u32 m0, m0, 4096
 s_add_u32 s29, s29, 101376
 buffer_load_dwordx4 v220, s[16:19], s29 offen offset:0 lds
 v_mfma_f32_32x32x16_bf16 a[208:223], v[148:151], v[196:199], a[208:223]
 v_fma_f32 v186, v170, s32, -v224
 v_fma_f32 v187, v171, s32, -v224
 v_fma_f32 v188, v172, s32, -v224
 v_mfma_f32_32x32x16_bf16 a[224:239], v[152:155], v[196:199], a[224:239]
 v_fma_f32 v189, v173, s32, -v224
 v_fma_f32 v190, v174, s32, -v224
 v_fma_f32 v191, v175, s32, -v224
 v_mfma_f32_32x32x16_bf16 a[240:255], v[156:159], v[196:199], a[240:255]
 s_mov_b32 s25, s24
 s_add_u32 s24, s24, 24576
 s_cmp_eq_u32 s24, 147456
 s_cselect_b32 s24, 0, s24
 v_add_u32 v212, s24, v204
 v_xor_b32 v213, 64, v212
 s_cbranch_vccz L_skip3
 s_call_b64 s[30:31], L_rescale
L_skip3:
 s_setpc_b64 s[72:73]
.p2align 6
L_sub46:
 v_add_u32 v212, s24, v206
 v_xor_b32 v213, 64, v212
 s_waitcnt  lgkmcnt(0)
 s_barrier
 ds_read_b64_tr_b16 v[112:113], v212 offset:0
 ds_read_b64_tr_b16 v[114:115], v212 offset:512
 ds_read_b64_tr_b16 v[116:117], v213 offset:0
 ds_read_b64_tr_b16 v[118:119], v213 offset:512
 ds_read_b64_tr_b16 v[120:121], v212 offset:1024
 ds_read_b64_tr_b16 v[122:123], v212 offset:1536
 ds_read_b64_tr_b16 v[124:125], v213 offset:1024
 ds_read_b64_tr_b16 v[126:127], v213 offset:1536
 ds_read_b64_tr_b16 v[128:129], v212 offset:4096
 ds_read_b64_tr_b16 v[130:131], v212 offset:4608
 ds_read_b64_tr_b16 v[132:133], v213 offset:4096
 ds_read_b64_tr_b16 v[134:135], v213 offset:4608
 ds_read_b64_tr_b16 v[136:137], v212 offset:5120
 ds_read_b64_tr_b16 v[138:139], v212 offset:5632
 v_exp_f32 v176, v176
 v_exp_f32 v177, v177
 v_exp_f32 v178, v178
 v_exp_f32 v179, v179
 v_add_f32 v226, v226, v176
 v_add_f32 v227, v227, v177
 v_cvt_pk_bf16_f32 v192, v176, v177
 s_waitcnt lgkmcnt(6)
 v_mfma_f32_32x32x16_bf16 v[0:15], v[112:115], a[40:43], v[0:15]
 ds_read_b64_tr_b16 v[140:141], v213 offset:5120
 ds_read_b64_tr_b16 v[142:143], v213 offset:5632
 v_exp_f32 v180, v180
 v_exp_f32 v181, v181
 v_add_f32 v226, v226, v178
 v_mfma_f32_32x32x16_bf16 v[240:255], v[116:119], a[40:43], v[240:255]
 ds_read_b64_tr_b16 v[144:145], v212 offset:8192
 ds_read_b64_tr_b16 v[146:147], v212 offset:8704
 v_add_f32 v227, v227, v179
 v_cvt_pk_bf16_f32 v193, v178, v179
 v_mfma_f32_32x32x16_bf16 v[0:15], v[120:123], a[44:47], v[0:15]
 ds_read_b64_tr_b16 v[148:149], v213 offset:8192
 ds_read_b64_tr_b16 v[150:151], v213 offset:8704
 v_exp_f32 v182, v182
 v_exp_f32 v183, v183
 s_add_u32 m0, s25, s40
 s_nop 0
 buffer_load_dwordx4 v217, s[12:15], s28 offen offset:0 nt lds
 v_mfma_f32_32x32x16_bf16 v[240:255], v[124:127], a[44:47], v[240:255]
 ds_read_b64_tr_b16 v[152:153], v212 offset:9216
 ds_read_b64_tr_b16 v[154:155], v212 offset:9728
 v_add_f32 v226, v226, v180
 v_add_f32 v227, v227, v181
 s_waitcnt lgkmcnt(6)
 v_mfma_f32_32x32x16_bf16 v[0:15], v[128:131], a[48:51], v[0:15]
 ds_read_b64_tr_b16 v[156:157], v213 offset:9216
 ds_read_b64_tr_b16 v[158:159], v213 offset:9728
 v_cvt_pk_bf16_f32 v194, v180, v181
 v_exp_f32 v184, v184
 buffer_load_dwordx4 v218, s[12:15], s28 offen offset:1024 nt lds
 v_mfma_f32_32x32x16_bf16 v[240:255], v[132:135], a[48:51], v[240:255]
 ds_read_b64_tr_b16 v[160:161], v212 offset:12288
 ds_read_b64_tr_b16 v[162:163], v212 offset:12800
 v_exp_f32 v185, v185
 v_add_f32 v226, v226, v182
 v_add_f32 v227, v227, v183
 v_mfma_f32_32x32x16_bf16 v[0:15], v[136:139], a[52:55], v[0:15]
 ds_read_b64_tr_b16 v[164:165], v213 offset:12288
 ds_read_b64_tr_b16 v[166:167], v213 offset:12800
 v_cvt_pk_bf16_f32 v195, v182, v183
 v_exp_f32 v186, v186
 v_mfma_f32_32x32x16_bf16 v[240:255], v[140:143], a[52:55], v[240:255]
 ds_read_b64_tr_b16 v[168:169], v212 offset:13312
 ds_read_b64_tr_b16 v[170:171], v212 offset:13824
 v_exp_f32 v187, v187
 v_add_f32 v226, v226, v184
 buffer_load_dwordx4 v219, s[12:15], s28 offen offset:2048 nt lds
 s_add_u32 s28, s28, 12288
 s_waitcnt lgkmcnt(6)
 v_mfma_f32_32x32x16_bf16 v[0:15], v[144:147], a[56:59], v[0:15]
 ds_read_b64_tr_b16 v[172:173], v213 offset:13312
 ds_read_b64_tr_b16 v[174:175], v213 offset:13824
 v_add_f32 v227, v227, v185
 v_cvt_pk_bf16_f32 v196, v184, v185
 v_mfma_f32_32x32x16_bf16 v[240:255], v[148:151], a[56:59], v[240:255]
 ds_read_b64_tr_b16 v[112:113], v212 offset:16384
 ds_read_b64_tr_b16 v[114:115], v212 offset:16896
 v_exp_f32 v188, v188
 v_exp_f32 v189, v189
 v_mfma_f32_32x32x16_bf16 v[0:15], v[152:155], a[60:63], v[0:15]
 ds_read_b64_tr_b16 v[116:117], v213 offset:16384
 ds_read_b64_tr_b16 v[118:119], v213 offset:16896
 v_add_f32 v226, v226, v186
 v_add_f32 v227, v227, v187
 v_cvt_pk_bf16_f32 v197, v186, v187
 s_add_u32 m0, s25, s41
 s_nop 0
 buffer_load_dwordx4 v214, s[8:11], s27 offen offset:0 nt lds
 v_mfma_f32_32x32x16_bf16 v[240:255], v[156:159], a[60:63], v[240:255]
 ds_read_b64_tr_b16 v[120:121], v212 offset:17408
 ds_read_b64_tr_b16 v[122:123], v212 offset:17920
 v_exp_f32 v190, v190
 v_exp_f32 v191, v191
 s_waitcnt lgkmcnt(6)
 v_mfma_f32_32x32x16_bf16 v[0:15], v[160:163], a[64:67], v[0:15]
 ds_read_b64_tr_b16 v[124:125], v213 offset:17408
 ds_read_b64_tr_b16 v[126:127], v213 offset:17920
 v_add_f32 v226, v226, v188
 v_add_f32 v227, v227, v189
 buffer_load_dwordx4 v215, s[8:11], s27 offen offset:1024 nt lds
 v_mfma_f32_32x32x16_bf16 v[240:255], v[164:167], a[64:67], v[240:255]
 v_cvt_pk_bf16_f32 v198, v188, v189
 v_add_f32 v226, v226, v190
 v_mfma_f32_32x32x16_bf16 v[0:15], v[168:171], a[68:71], v[0:15]
 v_add_f32 v227, v227, v191
 v_cvt_pk_bf16_f32 v199, v190, v191
 v_mfma_f32_32x32x16_bf16 v[240:255], v[172:175], a[68:71], v[240:255]
 buffer_load_dwordx4 v216, s[8:11], s27 offen offset:2048 nt lds
 s_add_u32 s27, s27, 12288
 s_waitcnt lgkmcnt(0)
 v_mfma_f32_32x32x16_bf16 v[0:15], v[112:115], a[72:75], v[0:15]
 v_mfma_f32_32x32x16_bf16 v[240:255], v[116:119], a[72:75], v[240:255]
 v_mfma_f32_32x32x16_bf16 v[0:15], v[120:123], a[76:79], v[0:15]
 v_mfma_f32_32x32x16_bf16 v[240:255], v[124:127], a[76:79], v[240:255]
 s_mov_b32 s25, s24
 s_add_u32 s24, s24, 24576
 s_cmp_eq_u32 s24, 147456
 s_cselect_b32 s24, 0, s24
 v_add_u32 v212, s24, v204
 v_xor_b32 v213, 64, v212
 s_setpc_b64 s[72:73]
.p2align 6
L_sub49:
 v_add_u32 v212, s24, v206
 v_xor_b32 v213, 64, v212
 s_waitcnt  lgkmcnt(0)
 s_barrier
 ds_read_b64_tr_b16 v[112:113], v212 offset:0
 ds_read_b64_tr_b16 v[114:115], v212 offset:512
 ds_read_b64_tr_b16 v[116:117], v213 offset:0
 ds_read_b64_tr_b16 v[118:119], v213 offset:512
 ds_read_b64_tr_b16 v[120:121], v212 offset:1024
 ds_read_b64_tr_b16 v[122:123], v212 offset:1536
 ds_read_b64_tr_b16 v[124:125], v213 offset:1024
 ds_read_b64_tr_b16 v[126:127], v213 offset:1536
 ds_read_b64_tr_b16 v[128:129], v212 offset:4096
 ds_read_b64_tr_b16 v[130:131], v212 offset:4608
 ds_read_b64_tr_b16 v[132:133], v213 offset:4096
 ds_read_b64_tr_b16 v[134:135], v213 offset:4608
 ds_read_b64_tr_b16 v[136:137], v212 offset:5120
 ds_read_b64_tr_b16 v[138:139], v212 offset:5632
 v_exp_f32 v176, v176
 v_exp_f32 v177, v177
 v_exp_f32 v178, v178
 v_exp_f32 v179, v179
 v_add_f32 v226, v226, v176
 v_add_f32 v227, v227, v177
 v_cvt_pk_bf16_f32 v192, v176, v177
 s_waitcnt lgkmcnt(6)
 v_mfma_f32_32x32x16_bf16 v[0:15], v[112:115], a[80:83], v[0:15]
 ds_read_b64_tr_b16 v[140:141], v213 offset:5120
 ds_read_b64_tr_b16 v[142:143], v213 offset:5632
 v_exp_f32 v180, v180
 v_exp_f32 v181, v181
 v_add_f32 v226, v226, v178
 v_mfma_f32_32x32x16_bf16 v[240:255], v[116:119], a[80:83], v[240:255]
 ds_read_b64_tr_b16 v[144:145], v212 offset:8192
 ds_read_b64_tr_b16 v[146:147], v212 offset:8704
 v_add_f32 v227, v227, v179
 v_cvt_pk_bf16_f32 v193, v178, v179
 v_mfma_f32_32x32x16_bf16 v[0:15], v[120:123], a[84:87], v[0:15]
 ds_read_b64_tr_b16 v[148:149], v213 offset:8192
 ds_read_b64_tr_b16 v[150:151], v213 offset:8704
 v_exp_f32 v182, v182
 v_exp_f32 v183, v183
 s_add_u32 m0, s25, s40
 s_nop 0
 buffer_load_dwordx4 v217, s[12:15], s28 offen offset:0 nt lds
 v_mfma_f32_32x32x16_bf16 v[240:255], v[124:127], a[84:87], v[240:255]
 ds_read_b64_tr_b16 v[152:153], v212 offset:9216
 ds_read_b64_tr_b16 v[154:155], v212 offset:9728
 v_add_f32 v226, v226, v180
 v_add_f32 v227, v227, v181
 s_waitcnt lgkmcnt(6)
 v_mfma_f32_32x32x16_bf16 v[0:15], v[128:131], a[88:91], v[0:15]
 ds_read_b64_tr_b16 v[156:157], v213 offset:9216
 ds_read_b64_tr_b16 v[158:159], v213 offset:9728
 v_cvt_pk_bf16_f32 v194, v180, v181
 v_exp_f32 v184, v184
 buffer_load_dwordx4 v218, s[12:15], s28 offen offset:1024 nt lds
 v_mfma_f32_32x32x16_bf16 v[240:255], v[132:135], a[88:91], v[240:255]
 ds_read_b64_tr_b16 v[160:161], v212 offset:12288
 ds_read_b64_tr_b16 v[162:163], v212 offset:12800
 v_exp_f32 v185, v185
 v_add_f32 v226, v226, v182
 v_add_f32 v227, v227, v183
 v_mfma_f32_32x32x16_bf16 v[0:15], v[136:139], a[92:95], v[0:15]
 ds_read_b64_tr_b16 v[164:165], v213 offset:12288
 ds_read_b64_tr_b16 v[166:167], v213 offset:12800
 v_cvt_pk_bf16_f32 v195, v182, v183
 v_exp_f32 v186, v186
 v_mfma_f32_32x32x16_bf16 v[240:255], v[140:143], a[92:95], v[240:255]
 ds_read_b64_tr_b16 v[168:169], v212 offset:13312
 ds_read_b64_tr_b16 v[170:171], v212 offset:13824
 v_exp_f32 v187, v187
 v_add_f32 v226, v226, v184
 buffer_load_dwordx4 v219, s[12:15], s28 offen offset:2048 nt lds
 s_add_u32 s28, s28, 12288
 s_waitcnt lgkmcnt(6)
 v_mfma_f32_32x32x16_bf16 v[0:15], v[144:147], a[96:99], v[0:15]
 ds_read_b64_tr_b16 v[172:173], v213 offset:13312
 ds_read_b64_tr_b16 v[174:175], v213 offset:13824
 v_add_f32 v227, v227, v185
 v_cvt_pk_bf16_f32 v196, v184, v185
 v_mfma_f32_32x32x16_bf16 v[240:255], v[148:151], a[96:99], v[240:255]
 ds_read_b64_tr_b16 v[112:113], v212 offset:16384
 ds_read_b64_tr_b16 v[114:115], v212 offset:16896
 v_exp_f32 v188, v188
 v_exp_f32 v189, v189
 v_mfma_f32_32x32x16_bf16 v[0:15], v[152:155], a[100:103], v[0:15]
 ds_read_b64_tr_b16 v[116:117], v213 offset:16384
 ds_read_b64_tr_b16 v[118:119], v213 offset:16896
 v_add_f32 v226, v226, v186
 v_add_f32 v227, v227, v187
 v_cvt_pk_bf16_f32 v197, v186, v187
 s_add_u32 m0, s25, s41
 s_nop 0
 buffer_load_dwordx4 v214, s[8:11], s27 offen offset:0 nt lds
 v_mfma_f32_32x32x16_bf16 v[240:255], v[156:159], a[100:103], v[240:255]
 ds_read_b64_tr_b16 v[120:121], v212 offset:17408
 ds_read_b64_tr_b16 v[122:123], v212 offset:17920
 v_exp_f32 v190, v190
 v_exp_f32 v191, v191
 s_waitcnt lgkmcnt(6)
 v_mfma_f32_32x32x16_bf16 v[0:15], v[160:163], a[104:107], v[0:15]
 ds_read_b64_tr_b16 v[124:125], v213 offset:17408
 ds_read_b64_tr_b16 v[126:127], v213 offset:17920
 v_add_f32 v226, v226, v188
 v_add_f32 v227, v227, v189
 buffer_load_dwordx4 v215, s[8:11], s27 offen offset:1024 nt lds
 v_mfma_f32_32x32x16_bf16 v[240:255], v[164:167], a[104:107], v[240:255]
 v_cvt_pk_bf16_f32 v198, v188, v189
 v_add_f32 v226, v226, v190
 v_mfma_f32_32x32x16_bf16 v[0:15], v[168:171], a[108:111], v[0:15]
 v_add_f32 v227, v227, v191
 v_cvt_pk_bf16_f32 v199, v190, v191
 v_mfma_f32_32x32x16_bf16 v[240:255], v[172:175], a[108:111], v[240:255]
 buffer_load_dwordx4 v216, s[8:11], s27 offen offset:2048 nt lds
 s_add_u32 s27, s27, 12288
 s_waitcnt lgkmcnt(0)
 v_mfma_f32_32x32x16_bf16 v[0:15], v[112:115], a[112:115], v[0:15]
 v_mfma_f32_32x32x16_bf16 v[240:255], v[116:119], a[112:115], v[240:255]
 v_mfma_f32_32x32x16_bf16 v[0:15], v[120:123], a[116:119], v[0:15]
 v_mfma_f32_32x32x16_bf16 v[240:255], v[124:127], a[116:119], v[240:255]
 s_mov_b32 s25, s24
 s_add_u32 s24, s24, 24576
 s_cmp_eq_u32 s24, 147456
 s_cselect_b32 s24, 0, s24
 v_add_u32 v212, s24, v204
 v_xor_b32 v213, 64, v212
 s_setpc_b64 s[72:73]
.p2align 6
L_sub52:
 v_add_u32 v212, s24, v206
 v_xor_b32 v213, 64, v212
 s_waitcnt  lgkmcnt(0)
 s_barrier
 ds_read_b64_tr_b16 v[112:113], v212 offset:0
 ds_read_b64_tr_b16 v[114:115], v212 offset:512
 ds_read_b64_tr_b16 v[116:117], v213 offset:0
 ds_read_b64_tr_b16 v[118:119], v213 offset:512
 ds_read_b64_tr_b16 v[120:121], v212 offset:1024
 ds_read_b64_tr_b16 v[122:123], v212 offset:1536
 ds_read_b64_tr_b16 v[124:125], v213 offset:1024
 ds_read_b64_tr_b16 v[126:127], v213 offset:1536
 ds_read_b64_tr_b16 v[128:129], v212 offset:4096
 ds_read_b64_tr_b16 v[130:131], v212 offset:4608
 ds_read_b64_tr_b16 v[132:133], v213 offset:4096
 ds_read_b64_tr_b16 v[134:135], v213 offset:4608
 ds_read_b64_tr_b16 v[136:137], v212 offset:5120
 ds_read_b64_tr_b16 v[138:139], v212 offset:5632
 v_exp_f32 v176, v176
 v_exp_f32 v177, v177
 v_exp_f32 v178, v178
 v_exp_f32 v179, v179
 v_add_f32 v226, v226, v176
 v_add_f32 v227, v227, v177
 v_cvt_pk_bf16_f32 v192, v176, v177
 s_waitcnt lgkmcnt(6)
 v_mfma_f32_32x32x16_bf16 v[0:15], v[112:115], a[120:123], v[0:15]
 ds_read_b64_tr_b16 v[140:141], v213 offset:5120
 ds_read_b64_tr_b16 v[142:143], v213 offset:5632
 v_exp_f32 v180, v180
 v_exp_f32 v181, v181
 v_add_f32 v226, v226, v178
 v_mfma_f32_32x32x16_bf16 v[240:255], v[116:119], a[120:123], v[240:255]
 ds_read_b64_tr_b16 v[144:145], v212 offset:8192
 ds_read_b64_tr_b16 v[146:147], v212 offset:8704
 v_add_f32 v227, v227, v179
 v_cvt_pk_bf16_f32 v193, v178, v179
 v_mfma_f32_32x32x16_bf16 v[0:15], v[120:123], a[124:127], v[0:15]
 ds_read_b64_tr_b16 v[148:149], v213 offset:8192
 ds_read_b64_tr_b16 v[150:151], v213 offset:8704
 v_exp_f32 v182, v182
 v_exp_f32 v183, v183
 s_add_u32 m0, s25, s40
 s_nop 0
 buffer_load_dwordx4 v217, s[12:15], s28 offen offset:0 nt lds
 v_mfma_f32_32x32x16_bf16 v[240:255], v[124:127], a[124:127], v[240:255]
 ds_read_b64_tr_b16 v[152:153], v212 offset:9216
 ds_read_b64_tr_b16 v[154:155], v212 offset:9728
 v_add_f32 v226, v226, v180
 v_add_f32 v227, v227, v181
 s_waitcnt lgkmcnt(6)
 v_mfma_f32_32x32x16_bf16 v[0:15], v[128:131], a[128:131], v[0:15]
 ds_read_b64_tr_b16 v[156:157], v213 offset:9216
 ds_read_b64_tr_b16 v[158:159], v213 offset:9728
 v_cvt_pk_bf16_f32 v194, v180, v181
 v_exp_f32 v184, v184
 buffer_load_dwordx4 v218, s[12:15], s28 offen offset:1024 nt lds
 v_mfma_f32_32x32x16_bf16 v[240:255], v[132:135], a[128:131], v[240:255]
 ds_read_b64_tr_b16 v[160:161], v212 offset:12288
 ds_read_b64_tr_b16 v[162:163], v212 offset:12800
 v_exp_f32 v185, v185
 v_add_f32 v226, v226, v182
 v_add_f32 v227, v227, v183
 v_mfma_f32_32x32x16_bf16 v[0:15], v[136:139], a[132:135], v[0:15]
 ds_read_b64_tr_b16 v[164:165], v213 offset:12288
 ds_read_b64_tr_b16 v[166:167], v213 offset:12800
 v_cvt_pk_bf16_f32 v195, v182, v183
 v_exp_f32 v186, v186
 v_mfma_f32_32x32x16_bf16 v[240:255], v[140:143], a[132:135], v[240:255]
 ds_read_b64_tr_b16 v[168:169], v212 offset:13312
 ds_read_b64_tr_b16 v[170:171], v212 offset:13824
 v_exp_f32 v187, v187
 v_add_f32 v226, v226, v184
 buffer_load_dwordx4 v219, s[12:15], s28 offen offset:2048 nt lds
 s_add_u32 s28, s28, 12288
 s_waitcnt lgkmcnt(6)
 v_mfma_f32_32x32x16_bf16 v[0:15], v[144:147], a[136:139], v[0:15]
 ds_read_b64_tr_b16 v[172:173], v213 offset:13312
 ds_read_b64_tr_b16 v[174:175], v213 offset:13824
 v_add_f32 v227, v227, v185
 v_cvt_pk_bf16_f32 v196, v184, v185
 v_mfma_f32_32x32x16_bf16 v[240:255], v[148:151], a[136:139], v[240:255]
 ds_read_b64_tr_b16 v[112:113], v212 offset:16384
 ds_read_b64_tr_b16 v[114:115], v212 offset:16896
 v_exp_f32 v188, v188
 v_exp_f32 v189, v189
 v_mfma_f32_32x32x16_bf16 v[0:15], v[152:155], a[140:143], v[0:15]
 ds_read_b64_tr_b16 v[116:117], v213 offset:16384
 ds_read_b64_tr_b16 v[118:119], v213 offset:16896
 v_add_f32 v226, v226, v186
 v_add_f32 v227, v227, v187
 v_cvt_pk_bf16_f32 v197, v186, v187
 s_add_u32 m0, s25, s41
 s_nop 0
 buffer_load_dwordx4 v214, s[8:11], s27 offen offset:0 nt lds
 v_mfma_f32_32x32x16_bf16 v[240:255], v[156:159], a[140:143], v[240:255]
 ds_read_b64_tr_b16 v[120:121], v212 offset:17408
 ds_read_b64_tr_b16 v[122:123], v212 offset:17920
 v_exp_f32 v190, v190
 v_exp_f32 v191, v191
 s_waitcnt lgkmcnt(6)
 v_mfma_f32_32x32x16_bf16 v[0:15], v[160:163], a[144:147], v[0:15]
 ds_read_b64_tr_b16 v[124:125], v213 offset:17408
 ds_read_b64_tr_b16 v[126:127], v213 offset:17920
 v_add_f32 v226, v226, v188
 v_add_f32 v227, v227, v189
 buffer_load_dwordx4 v215, s[8:11], s27 offen offset:1024 nt lds
 v_mfma_f32_32x32x16_bf16 v[240:255], v[164:167], a[144:147], v[240:255]
 v_cvt_pk_bf16_f32 v198, v188, v189
 v_add_f32 v226, v226, v190
 v_mfma_f32_32x32x16_bf16 v[0:15], v[168:171], a[148:151], v[0:15]
 v_add_f32 v227, v227, v191
 v_cvt_pk_bf16_f32 v199, v190, v191
 v_mfma_f32_32x32x16_bf16 v[240:255], v[172:175], a[148:151], v[240:255]
 buffer_load_dwordx4 v216, s[8:11], s27 offen offset:2048 nt lds
 s_add_u32 s27, s27, 12288
 s_waitcnt lgkmcnt(0)
 v_mfma_f32_32x32x16_bf16 v[0:15], v[112:115], a[152:155], v[0:15]
 v_mfma_f32_32x32x16_bf16 v[240:255], v[116:119], a[152:155], v[240:255]
 v_mfma_f32_32x32x16_bf16 v[0:15], v[120:123], a[156:159], v[0:15]
 v_mfma_f32_32x32x16_bf16 v[240:255], v[124:127], a[156:159], v[240:255]
 s_mov_b32 s25, s24
 s_add_u32 s24, s24, 24576
 s_cmp_eq_u32 s24, 147456
 s_cselect_b32 s24, 0, s24
 v_add_u32 v212, s24, v204
 v_xor_b32 v213, 64, v212
 s_setpc_b64 s[72:73]
.p2align 6
L_sub55:
 s_waitcnt  lgkmcnt(0)
 s_barrier
 v_mfma_f32_32x32x16_bf16 v[160:175], v[64:67], v[16:19], 0
 ds_read_b64_tr_b16 v[112:113], v212 offset:0
 ds_read_b64_tr_b16 v[114:115], v212 offset:3072
 ds_read_b64_tr_b16 v[116:117], v213 offset:0
 v_mfma_f32_32x32x16_bf16 v[160:175], v[68:71], v[20:23], v[160:175]
 ds_read_b64_tr_b16 v[118:119], v213 offset:3072
 ds_read_b64_tr_b16 v[120:121], v212 offset:128
 v_mfma_f32_32x32x16_bf16 v[160:175], v[72:75], v[24:27], v[160:175]
 ds_read_b64_tr_b16 v[122:123], v212 offset:3200
 ds_read_b64_tr_b16 v[124:125], v213 offset:128
 v_mfma_f32_32x32x16_bf16 v[160:175], v[76:79], v[28:31], v[160:175]
 ds_read_b64_tr_b16 v[126:127], v213 offset:3200
 ds_read_b64_tr_b16 v[128:129], v212 offset:256
 v_mfma_f32_32x32x16_bf16 v[160:175], v[80:83], v[32:35], v[160:175]
 ds_read_b64_tr_b16 v[130:131], v212 offset:3328
 ds_read_b64_tr_b16 v[132:133], v213 offset:256
 v_mfma_f32_32x32x16_bf16 v[160:175], v[84:87], v[36:39], v[160:175]
 ds_read_b64_tr_b16 v[134:135], v213 offset:3328
 ds_read_b64_tr_b16 v[136:137], v212 offset:6144
 ds_read_b64_tr_b16 v[138:139], v212 offset:9216
 v_mfma_f32_32x32x16_bf16 v[160:175], v[88:91], v[40:43], v[160:175]
 ds_read_b64_tr_b16 v[140:141], v213 offset:6144
 ds_read_b64_tr_b16 v[142:143], v213 offset:9216
 v_mfma_f32_32x32x16_bf16 v[160:175], v[92:95], v[44:47], v[160:175]
 ds_read_b64_tr_b16 v[144:145], v212 offset:6272
 ds_read_b64_tr_b16 v[146:147], v212 offset:9344
 v_mfma_f32_32x32x16_bf16 v[160:175], v[96:99], v[48:51], v[160:175]
 ds_read_b64_tr_b16 v[148:149], v213 offset:6272
 ds_read_b64_tr_b16 v[150:151], v213 offset:9344
 v_mfma_f32_32x32x16_bf16 v[160:175], v[100:103], v[52:55], v[160:175]
 ds_read_b64_tr_b16 v[152:153], v212 offset:6400
 ds_read_b64_tr_b16 v[154:155], v212 offset:9472
 v_mfma_f32_32x32x16_bf16 v[160:175], v[104:107], v[56:59], v[160:175]
 ds_read_b64_tr_b16 v[156:157], v213 offset:6400
 ds_read_b64_tr_b16 v[158:159], v213 offset:9472
 v_mfma_f32_32x32x16_bf16 v[160:175], v[108:111], v[60:63], v[160:175]
 v_add_u32 v208, s24, v200
 v_xor_b32 v209, 32, v208
 v_xor_b32 v210, 64, v208
 v_xor_b32 v211, 96, v208
 s_waitcnt lgkmcnt(6)
 v_mfma_f32_32x32x16_bf16 a[160:175], v[112:115], v[192:195], a[160:175]
 ds_read_b128 v[64:67], v208 offset:12288
 ds_read_b128 v[68:71], v209 offset:12288
 s_add_u32 m0, s25, s40
 s_nop 0
 buffer_load_dwordx4 v217, s[12:15], s28 offen offset:0 nt lds
 v_mfma_f32_32x32x16_bf16 a[176:191], v[116:119], v[192:195], a[176:191]
 ds_read_b128 v[72:75], v210 offset:12288
 buffer_load_dwordx4 v218, s[12:15], s28 offen offset:1024 nt lds
 v_mfma_f32_32x32x16_bf16 a[192:207], v[120:123], v[192:195], a[192:207]
 ds_read_b128 v[76:79], v211 offset:12288
 ds_read_b128 v[80:83], v208 offset:12416
 v_mfma_f32_32x32x16_bf16 a[208:223], v[124:127], v[192:195], a[208:223]
 ds_read_b128 v[84:87], v209 offset:12416
 v_max3_f32 v228, v160, v161, v162
 v_max3_f32 v228, v228, v163, v164
 v_max3_f32 v228, v228, v165, v166
 buffer_load_dwordx4 v219, s[12:15], s28 offen offset:2048 nt lds
 s_add_u32 s28, s28, 12288
 v_mfma_f32_32x32x16_bf16 a[224:239], v[128:131], v[192:195], a[224:239]
 ds_read_b128 v[88:91], v210 offset:12416
 ds_read_b128 v[92:95], v211 offset:12416
 v_max3_f32 v228, v228, v167, v168
 v_max3_f32 v228, v228, v169, v170
 v_max3_f32 v228, v228, v171, v172
 v_mfma_f32_32x32x16_bf16 a[240:255], v[132:135], v[192:195], a[240:255]
 ds_read_b128 v[96:99], v208 offset:12544
 v_max3_f32 v228, v228, v173, v174
 v_max_f32 v228, v228, v175
 v_cmp_gt_f32 vcc, v228, v225
 s_add_u32 m0, s25, s41
 s_nop 0
 buffer_load_dwordx4 v214, s[8:11], s27 offen offset:0 nt lds
 s_waitcnt lgkmcnt(9)
 v_mfma_f32_32x32x16_bf16 a[160:175], v[136:139], v[196:199], a[160:175]
 ds_read_b128 v[100:103], v209 offset:12544
 ds_read_b128 v[104:107], v210 offset:12544
 v_fma_f32 v176, v160, s32, -v224
 v_fma_f32 v177, v161, s32, -v224
 v_fma_f32 v178, v162, s32, -v224
 v_fma_f32 v179, v163, s32, -v224
 v_mfma_f32_32x32x16_bf16 a[176:191], v[140:143], v[196:199], a[176:191]
 ds_read_b128 v[108:111], v211 offset:12544
 v_fma_f32 v180, v164, s32, -v224
 v_fma_f32 v181, v165, s32, -v224
 v_fma_f32 v182, v166, s32, -v224
 buffer_load_dwordx4 v215, s[8:11], s27 offen offset:1024 nt lds
 v_mfma_f32_32x32x16_bf16 a[192:207], v[144:147], v[196:199], a[192:207]
 v_fma_f32 v183, v167, s32, -v224
 v_fma_f32 v184, v168, s32, -v224
 v_fma_f32 v185, v169, s32, -v224
 v_mfma_f32_32x32x16_bf16 a[208:223], v[148:151], v[196:199], a[208:223]
 v_fma_f32 v186, v170, s32, -v224
 v_fma_f32 v187, v171, s32, -v224
 v_fma_f32 v188, v172, s32, -v224
 buffer_load_dwordx4 v216, s[8:11], s27 offen offset:2048 nt lds
 s_add_u32 s27, s27, 12288
 v_mfma_f32_32x32x16_bf16 a[224:239], v[152:155], v[196:199], a[224:239]
 v_fma_f32 v189, v173, s32, -v224
 v_fma_f32 v190, v174, s32, -v224
 v_fma_f32 v191, v175, s32, -v224
 v_mfma_f32_32x32x16_bf16 a[240:255], v[156:159], v[196:199], a[240:255]
 s_mov_b32 s25, s24
 s_add_u32 s24, s24, 24576
 s_cmp_eq_u32 s24, 147456
 s_cselect_b32 s24, 0, s24
 v_add_u32 v212, s24, v204
 v_xor_b32 v213, 64, v212
 s_cbranch_vccz L_skip23
 s_call_b64 s[30:31], L_rescale
L_skip23:
 s_setpc_b64 s[72:73]
.p2align 6
L_sub60:
 s_waitcnt  lgkmcnt(0)
 s_barrier
 v_mfma_f32_32x32x16_bf16 v[160:175], v[64:67], v[16:19], 0
 ds_read_b64_tr_b16 v[112:113], v212 offset:0
 ds_read_b64_tr_b16 v[114:115], v212 offset:3072
 ds_read_b64_tr_b16 v[116:117], v213 offset:0
 v_exp_f32 v176, v176
 v_exp_f32 v177, v177
 v_exp_f32 v178, v178
 v_mfma_f32_32x32x16_bf16 v[160:175], v[68:71], v[20:23], v[160:175]
 ds_read_b64_tr_b16 v[118:119], v213 offset:3072
 ds_read_b64_tr_b16 v[120:121], v212 offset:128
 v_exp_f32 v179, v179
 v_add_f32 v226, v226, v176
 v_mfma_f32_32x32x16_bf16 v[160:175], v[72:75], v[24:27], v[160:175]
 ds_read_b64_tr_b16 v[122:123], v212 offset:3200
 ds_read_b64_tr_b16 v[124:125], v213 offset:128
 v_add_f32 v227, v227, v177
 v_cvt_pk_bf16_f32 v192, v176, v177
 v_exp_f32 v180, v180
 v_mfma_f32_32x32x16_bf16 v[160:175], v[76:79], v[28:31], v[160:175]
 ds_read_b64_tr_b16 v[126:127], v213 offset:3200
 ds_read_b64_tr_b16 v[128:129], v212 offset:256
 v_exp_f32 v181, v181
 v_add_f32 v226, v226, v178
 v_mfma_f32_32x32x16_bf16 v[160:175], v[80:83], v[32:35], v[160:175]
 ds_read_b64_tr_b16 v[130:131], v212 offset:3328
 ds_read_b64_tr_b16 v[132:133], v213 offset:256
 v_add_f32 v227, v227, v179
 v_cvt_pk_bf16_f32 v193, v178, v179
 v_exp_f32 v182, v182
 v_mfma_f32_32x32x16_bf16 v[160:175], v[84:87], v[36:39], v[160:175]
 ds_read_b64_tr_b16 v[134:135], v213 offset:3328
 ds_read_b64_tr_b16 v[136:137], v212 offset:6144
 ds_read_b64_tr_b16 v[138:139], v212 offset:9216
 v_exp_f32 v183, v183
 v_add_f32 v226, v226, v180
 v_mfma_f32_32x32x16_bf16 v[160:175], v[88:91], v[40:43], v[160:175]
 ds_read_b64_tr_b16 v[140:141], v213 offset:6144
 ds_read_b64_tr_b16 v[142:143], v213 offset:9216
 v_add_f32 v227, v227, v181
 v_cvt_pk_bf16_f32 v194, v180, v181
 v_exp_f32 v184, v184
 v_mfma_f32_32x32x16_bf16 v[160:175], v[92:95], v[44:47], v[160:175]
 ds_read_b64_tr_b16 v[144:145], v212 offset:6272
 ds_read_b64_tr_b16 v[146:147], v212 offset:9344
 v_exp_f32 v185, v185
 v_add_f32 v226, v226, v182
 v_mfma_f32_32x32x16_bf16 v[160:175], v[96:99], v[48:51], v[160:175]
 ds_read_b64_tr_b16 v[148:149], v213 offset:6272
 ds_read_b64_tr_b16 v[150:151], v213 offset:9344
 v_add_f32 v227, v227, v183
 v_cvt_pk_bf16_f32 v195, v182, v183
 v_exp_f32 v186, v186
 v_mfma_f32_32x32x16_bf16 v[160:175], v[100:103], v[52:55], v[160:175]
 ds_read_b64_tr_b16 v[152:153], v212 offset:6400
 ds_read_b64_tr_b16 v[154:155], v212 offset:9472
 v_exp_f32 v187, v187
 v_add_f32 v226, v226, v184
 v_mfma_f32_32x32x16_bf16 v[160:175], v[104:107], v[56:59], v[160:175]
 ds_read_b64_tr_b16 v[156:157], v213 offset:6400
 ds_read_b64_tr_b16 v[158:159], v213 offset:9472
 v_add_f32 v227, v227, v185
 v_cvt_pk_bf16_f32 v196, v184, v185
 v_exp_f32 v188, v188
 v_mfma_f32_32x32x16_bf16 v[160:175], v[108:111], v[60:63], v[160:175]
 v_exp_f32 v189, v189
 v_add_f32 v226, v226, v186
 v_add_u32 v208, s24, v200
 v_xor_b32 v209, 32, v208
 v_xor_b32 v210, 64, v208
 v_xor_b32 v211, 96, v208
 s_waitcnt lgkmcnt(6)
 v_mfma_f32_32x32x16_bf16 a[160:175], v[112:115], v[192:195], a[160:175]
 v_add_f32 v227, v227, v187
 v_cvt_pk_bf16_f32 v197, v186, v187
 v_exp_f32 v190, v190
 v_exp_f32 v191, v191
 ds_read_b128 v[64:67], v208 offset:12288
 ds_read_b128 v[68:71], v209 offset:12288
 s_add_u32 m0, s25, s40
 s_nop 0
 buffer_load_dwordx4 v217, s[12:15], s28 offen offset:0 nt lds
 v_mfma_f32_32x32x16_bf16 a[176:191], v[116:119], v[192:195], a[176:191]
 v_add_f32 v226, v226, v188
 v_add_f32 v227, v227, v189
 v_cvt_pk_bf16_f32 v198, v188, v189
 ds_read_b128 v[72:75], v210 offset:12288
 buffer_load_dwordx4 v218, s[12:15], s28 offen offset:1024 nt lds
 v_mfma_f32_32x32x16_bf16 a[192:207], v[120:123], v[192:195], a[192:207]
 v_add_f32 v226, v226, v190
 v_add_f32 v227, v227, v191
 v_cvt_pk_bf16_f32 v199, v190, v191
 ds_read_b128 v[76:79], v211 offset:12288
 ds_read_b128 v[80:83], v208 offset:12416
 v_mfma_f32_32x32x16_bf16 a[208:223], v[124:127], v[192:195], a[208:223]
 ds_read_b128 v[84:87], v209 offset:12416
 v_max3_f32 v228, v160, v161, v162
 v_max3_f32 v228, v228, v163, v164
 v_max3_f32 v228, v228, v165, v166
 buffer_load_dwordx4 v219, s[12:15], s28 offen offset:2048 nt lds
 s_add_u32 s28, s28, 12288
 v_mfma_f32_32x32x16_bf16 a[224:239], v[128:131], v[192:195], a[224:239]
 ds_read_b128 v[88:91], v210 offset:12416
 ds_read_b128 v[92:95], v211 offset:12416
 v_max3_f32 v228, v228, v167, v168
 v_max3_f32 v228, v228, v169, v170
 v_max3_f32 v228, v228, v171, v172
 v_mfma_f32_32x32x16_bf16 a[240:255], v[132:135], v[192:195], a[240:255]
 ds_read_b128 v[96:99], v208 offset:12544
 v_max3_f32 v228, v228, v173, v174
 v_max_f32 v228, v228, v175
 v_cmp_gt_f32 vcc, v228, v225
 s_add_u32 m0, s25, s41
 s_nop 0
 buffer_load_dwordx4 v217, s[12:15], s28 offen offset:0 nt lds
 s_waitcnt lgkmcnt(9)
 v_mfma_f32_32x32x16_bf16 a[160:175], v[136:139], v[196:199], a[160:175]
 ds_read_b128 v[100:103], v209 offset:12544
 ds_read_b128 v[104:107], v210 offset:12544
 v_fma_f32 v176, v160, s32, -v224
 v_fma_f32 v177, v161, s32, -v224
 v_fma_f32 v178, v162, s32, -v224
 v_fma_f32 v179, v163, s32, -v224
 v_mfma_f32_32x32x16_bf16 a[176:191], v[140:143], v[196:199], a[176:191]
 ds_read_b128 v[108:111], v211 offset:12544
 v_fma_f32 v180, v164, s32, -v224
 v_fma_f32 v181, v165, s32, -v224
 v_fma_f32 v182, v166, s32, -v224
 buffer_load_dwordx4 v218, s[12:15], s28 offen offset:1024 nt lds
 v_mfma_f32_32x32x16_bf16 a[192:207], v[144:147], v[196:199], a[192:207]
 v_fma_f32 v183, v167, s32, -v224
 v_fma_f32 v184, v168, s32, -v224
 v_fma_f32 v185, v169, s32, -v224
 v_mfma_f32_32x32x16_bf16 a[208:223], v[148:151], v[196:199], a[208:223]
 v_fma_f32 v186, v170, s32, -v224
 v_fma_f32 v187, v171, s32, -v224
 v_fma_f32 v188, v172, s32, -v224
 buffer_load_dwordx4 v219, s[12:15], s28 offen offset:2048 nt lds
 s_add_u32 s28, s28, 12288
 v_mfma_f32_32x32x16_bf16 a[224:239], v[152:155], v[196:199], a[224:239]
 v_fma_f32 v189, v173, s32, -v224
 v_fma_f32 v190, v174, s32, -v224
 v_fma_f32 v191, v175, s32, -v224
 v_mfma_f32_32x32x16_bf16 a[240:255], v[156:159], v[196:199], a[240:255]
 s_mov_b32 s25, s24
 s_add_u32 s24, s24, 24576
 s_cmp_eq_u32 s24, 147456
 s_cselect_b32 s24, 0, s24
 v_add_u32 v212, s24, v204
 v_xor_b32 v213, 64, v212
 s_cbranch_vccz L_skip26
 s_call_b64 s[30:31], L_rescale
L_skip26:
 s_setpc_b64 s[72:73]
.p2align 6
L_sub62:
 s_waitcnt  lgkmcnt(0)
 s_barrier
 v_mfma_f32_32x32x16_bf16 v[160:175], v[64:67], v[16:19], 0
 ds_read_b64_tr_b16 v[112:113], v212 offset:0
 ds_read_b64_tr_b16 v[114:115], v212 offset:3072
 ds_read_b64_tr_b16 v[116:117], v213 offset:0
 v_exp_f32 v176, v176
 v_exp_f32 v177, v177
 v_exp_f32 v178, v178
 v_mfma_f32_32x32x16_bf16 v[160:175], v[68:71], v[20:23], v[160:175]
 ds_read_b64_tr_b16 v[118:119], v213 offset:3072
 ds_read_b64_tr_b16 v[120:121], v212 offset:128
 v_exp_f32 v179, v179
 v_add_f32 v226, v226, v176
 v_mfma_f32_32x32x16_bf16 v[160:175], v[72:75], v[24:27], v[160:175]
 ds_read_b64_tr_b16 v[122:123], v212 offset:3200
 ds_read_b64_tr_b16 v[124:125], v213 offset:128
 v_add_f32 v227, v227, v177
 v_cvt_pk_bf16_f32 v192, v176, v177
 v_exp_f32 v180, v180
 v_mfma_f32_32x32x16_bf16 v[160:175], v[76:79], v[28:31], v[160:175]
 ds_read_b64_tr_b16 v[126:127], v213 offset:3200
 ds_read_b64_tr_b16 v[128:129], v212 offset:256
 v_exp_f32 v181, v181
 v_add_f32 v226, v226, v178
 v_mfma_f32_32x32x16_bf16 v[160:175], v[80:83], v[32:35], v[160:175]
 ds_read_b64_tr_b16 v[130:131], v212 offset:3328
 ds_read_b64_tr_b16 v[132:133], v213 offset:256
 v_add_f32 v227, v227, v179
 v_cvt_pk_bf16_f32 v193, v178, v179
 v_exp_f32 v182, v182
 v_mfma_f32_32x32x16_bf16 v[160:175], v[84:87], v[36:39], v[160:175]
 ds_read_b64_tr_b16 v[134:135], v213 offset:3328
 ds_read_b64_tr_b16 v[136:137], v212 offset:6144
 ds_read_b64_tr_b16 v[138:139], v212 offset:9216
 v_exp_f32 v183, v183
 v_add_f32 v226, v226, v180
 v_mfma_f32_32x32x16_bf16 v[160:175], v[88:91], v[40:43], v[160:175]
 ds_read_b64_tr_b16 v[140:141], v213 offset:6144
 ds_read_b64_tr_b16 v[142:143], v213 offset:9216
 v_add_f32 v227, v227, v181
 v_cvt_pk_bf16_f32 v194, v180, v181
 v_exp_f32 v184, v184
 v_mfma_f32_32x32x16_bf16 v[160:175], v[92:95], v[44:47], v[160:175]
 ds_read_b64_tr_b16 v[144:145], v212 offset:6272
 ds_read_b64_tr_b16 v[146:147], v212 offset:9344
 v_exp_f32 v185, v185
 v_add_f32 v226, v226, v182
 v_mfma_f32_32x32x16_bf16 v[160:175], v[96:99], v[48:51], v[160:175]
 ds_read_b64_tr_b16 v[148:149], v213 offset:6272
 ds_read_b64_tr_b16 v[150:151], v213 offset:9344
 v_add_f32 v227, v227, v183
 v_cvt_pk_bf16_f32 v195, v182, v183
 v_exp_f32 v186, v186
 v_mfma_f32_32x32x16_bf16 v[160:175], v[100:103], v[52:55], v[160:175]
 ds_read_b64_tr_b16 v[152:153], v212 offset:6400
 ds_read_b64_tr_b16 v[154:155], v212 offset:9472
 v_exp_f32 v187, v187
 v_add_f32 v226, v226, v184
 v_mfma_f32_32x32x16_bf16 v[160:175], v[104:107], v[56:59], v[160:175]
 ds_read_b64_tr_b16 v[156:157], v213 offset:6400
 ds_read_b64_tr_b16 v[158:159], v213 offset:9472
 v_add_f32 v227, v227, v185
 v_cvt_pk_bf16_f32 v196, v184, v185
 v_exp_f32 v188, v188
 v_mfma_f32_32x32x16_bf16 v[160:175], v[108:111], v[60:63], v[160:175]
 v_exp_f32 v189, v189
 v_add_f32 v226, v226, v186
 v_add_u32 v208, s24, v200
 v_xor_b32 v209, 32, v208
 v_xor_b32 v210, 64, v208
 v_xor_b32 v211, 96, v208
 s_waitcnt lgkmcnt(6)
 v_mfma_f32_32x32x16_bf16 a[160:175], v[112:115], v[192:195], a[160:175]
 v_add_f32 v227, v227, v187
 v_cvt_pk_bf16_f32 v197, v186, v187
 v_exp_f32 v190, v190
 v_exp_f32 v191, v191
 ds_read_b128 v[64:67], v208 offset:12288
 ds_read_b128 v[68:71], v209 offset:12288
 s_add_u32 m0, s25, s42
 s_nop 0
 buffer_load_dwordx4 v232, s[48:51], s43 offen offset:0 lds
 v_mfma_f32_32x32x16_bf16 a[176:191], v[116:119], v[192:195], a[176:191]
 v_add_f32 v226, v226, v188
 v_add_f32 v227, v227, v189
 v_cvt_pk_bf16_f32 v198, v188, v189
 ds_read_b128 v[72:75], v210 offset:12288
 v_mfma_f32_32x32x16_bf16 a[192:207], v[120:123], v[192:195], a[192:207]
 v_add_f32 v226, v226, v190
 v_add_f32 v227, v227, v191
 v_cvt_pk_bf16_f32 v199, v190, v191
 ds_read_b128 v[76:79], v211 offset:12288
 ds_read_b128 v[80:83], v208 offset:12416
 buffer_load_dwordx4 v233, s[48:51], s43 offen offset:1024 lds
 v_mfma_f32_32x32x16_bf16 a[208:223], v[124:127], v[192:195], a[208:223]
 ds_read_b128 v[84:87], v209 offset:12416
 v_max3_f32 v228, v160, v161, v162
 v_max3_f32 v228, v228, v163, v164
 v_max3_f32 v228, v228, v165, v166
 v_mfma_f32_32x32x16_bf16 a[224:239], v[128:131], v[192:195], a[224:239]
 ds_read_b128 v[88:91], v210 offset:12416
 ds_read_b128 v[92:95], v211 offset:12416
 v_max3_f32 v228, v228, v167, v168
 v_max3_f32 v228, v228, v169, v170
 v_max3_f32 v228, v228, v171, v172
 buffer_load_dwordx4 v234, s[48:51], s43 offen offset:2048 lds
 v_mfma_f32_32x32x16_bf16 a[240:255], v[132:135], v[192:195], a[240:255]
 ds_read_b128 v[96:99], v208 offset:12544
 v_max3_f32 v228, v228, v173, v174
 v_max_f32 v228, v228, v175
 v_cmp_gt_f32 vcc, v228, v225
 s_waitcnt lgkmcnt(9)
 v_mfma_f32_32x32x16_bf16 a[160:175], v[136:139], v[196:199], a[160:175]
 ds_read_b128 v[100:103], v209 offset:12544
 ds_read_b128 v[104:107], v210 offset:12544
 v_fma_f32 v176, v160, s32, -v224
 v_fma_f32 v177, v161, s32, -v224
 v_fma_f32 v178, v162, s32, -v224
 v_fma_f32 v179, v163, s32, -v224
 buffer_load_dwordx4 v235, s[48:51], s43 offen offset:3072 lds
 v_mfma_f32_32x32x16_bf16 a[176:191], v[140:143], v[196:199], a[176:191]
 ds_read_b128 v[108:111], v211 offset:12544
 v_fma_f32 v180, v164, s32, -v224
 v_fma_f32 v181, v165, s32, -v224
 v_fma_f32 v182, v166, s32, -v224
 v_mfma_f32_32x32x16_bf16 a[192:207], v[144:147], v[196:199], a[192:207]
 v_fma_f32 v183, v167, s32, -v224
 v_fma_f32 v184, v168, s32, -v224
 v_fma_f32 v185, v169, s32, -v224
 s_add_u32 m0, m0, 4096
 s_nop 0
 buffer_load_dwordx4 v236, s[48:51], s43 offen offset:0 lds
 v_mfma_f32_32x32x16_bf16 a[208:223], v[148:151], v[196:199], a[208:223]
 v_fma_f32 v186, v170, s32, -v224
 v_fma_f32 v187, v171, s32, -v224
 v_fma_f32 v188, v172, s32, -v224
 v_mfma_f32_32x32x16_bf16 a[224:239], v[152:155], v[196:199], a[224:239]
 v_fma_f32 v189, v173, s32, -v224
 v_fma_f32 v190, v174, s32, -v224
 v_fma_f32 v191, v175, s32, -v224
 v_mfma_f32_32x32x16_bf16 a[240:255], v[156:159], v[196:199], a[240:255]
 s_mov_b32 s25, s24
 s_add_u32 s24, s24, 24576
 s_cmp_eq_u32 s24, 147456
 s_cselect_b32 s24, 0, s24
 v_add_u32 v212, s24, v204
 v_xor_b32 v213, 64, v212
 s_cbranch_vccz L_skip37
 s_call_b64 s[30:31], L_rescale
L_skip37:
 s_setpc_b64 s[72:73]
.globl mha_reduce_kernel
.p2align 8
.type mha_reduce_kernel,@function
mha_reduce_kernel:
 s_cmp_ge_u32 s2, 640
 s_cbranch_scc1 L_k3_end
 s_load_dwordx2 s[40:41], s[0:1], 80
 s_load_dwordx2 s[44:45], s[0:1], 96
 v_lshrrev_b32 v1, 6, v0
 v_and_b32 v2, 63, v0
 s_nop 0
 v_readfirstlane_b32 s7, v1
 s_lshl_b32 s3, s2, 2
 s_nop 2
 s_add_u32 s3, s3, s7
 s_waitcnt lgkmcnt(0)
 s_add_u32 s8, s44, 0
 s_addc_u32 s9, s45, 0
 s_mov_b32 s10, 41943040
 s_mov_b32 s11, 0x20000
 s_mov_b32 s12, s40
 s_mov_b32 s13, s41
 s_mov_b32 s14, 2621440
 s_mov_b32 s15, 0x20000
 v_lshlrev_b32 v3, 4, v2
 s_lshl_b32 s16, s3, 10
 buffer_load_dwordx4 v[24:27], v3, s[8:11], s16 offen nt
 s_add_u32 s16, s16, 2621440
 buffer_load_dwordx4 v[28:31], v3, s[8:11], s16 offen nt
 s_add_u32 s16, s16, 2621440
 buffer_load_dwordx4 v[32:35], v3, s[8:11], s16 offen nt
 s_add_u32 s16, s16, 2621440
 buffer_load_dwordx4 v[36:39], v3, s[8:11], s16 offen nt
 s_add_u32 s16, s16, 2621440
 buffer_load_dwordx4 v[40:43], v3, s[8:11], s16 offen nt
 s_add_u32 s16, s16, 2621440
 buffer_load_dwordx4 v[44:47], v3, s[8:11], s16 offen nt
 s_add_u32 s16, s16, 2621440
 buffer_load_dwordx4 v[48:51], v3, s[8:11], s16 offen nt
 s_add_u32 s16, s16, 2621440
 buffer_load_dwordx4 v[52:55], v3, s[8:11], s16 offen nt
 s_add_u32 s16, s16, 2621440
 buffer_load_dwordx4 v[56:59], v3, s[8:11], s16 offen nt
 s_add_u32 s16, s16, 2621440
 buffer_load_dwordx4 v[60:63], v3, s[8:11], s16 offen nt
 s_add_u32 s16, s16, 2621440
 buffer_load_dwordx4 v[64:67], v3, s[8:11], s16 offen nt
 s_add_u32 s16, s16, 2621440
 buffer_load_dwordx4 v[68:71], v3, s[8:11], s16 offen nt
 s_add_u32 s16, s16, 2621440
 buffer_load_dwordx4 v[72:75], v3, s[8:11], s16 offen nt
 s_add_u32 s16, s16, 2621440
 buffer_load_dwordx4 v[76:79], v3, s[8:11], s16 offen nt
 s_add_u32 s16, s16, 2621440
 buffer_load_dwordx4 v[80:83], v3, s[8:11], s16 offen nt
 s_add_u32 s16, s16, 2621440
 buffer_load_dwordx4 v[84:87], v3, s[8:11], s16 offen nt
 s_add_u32 s16, s16, 2621440
 s_mul_i32 s4, s3, 52429
 s_lshr_b32 s4, s4, 19
 s_mul_i32 s5, s4, 10
 s_sub_u32 s5, s3, s5
 s_and_b32 s6, s4, 3
 s_lshr_b32 s4, s4, 2
 s_and_b32 s17, s4, 3
 s_lshr_b32 s4, s4, 2
 s_and_b32 s18, s4, 7
 s_lshr_b32 s4, s4, 3
 s_lshl_b32 s18, s18, 2
 s_add_u32 s18, s18, s6
 s_mul_i32 s18, s18, 81920
 s_mul_i32 s4, s4, 1280
 s_mul_i32 s17, s17, 320
 s_lshl_b32 s5, s5, 5
 s_add_u32 s18, s18, s4
 s_add_u32 s18, s18, s17
 s_add_u32 s18, s18, s5
 v_and_b32 v4, 31, v2
 v_mul_u32_u24 v4, 2560, v4
 v_lshrrev_b32 v5, 5, v2
 v_lshl_add_u32 v4, v5, 4, v4
 s_mov_b32 s19, 0xffff0000
 s_waitcnt vmcnt(15)
 v_lshlrev_b32 v8, 16, v24
 v_and_b32 v9, s19, v24
 v_lshlrev_b32 v10, 16, v25
 v_and_b32 v11, s19, v25
 v_lshlrev_b32 v12, 16, v26
 v_and_b32 v13, s19, v26
 v_lshlrev_b32 v14, 16, v27
 v_and_b32 v15, s19, v27
 s_waitcnt vmcnt(14)
 v_lshlrev_b32 v16, 16, v28
 v_and_b32 v17, s19, v28
 v_lshlrev_b32 v18, 16, v29
 v_and_b32 v19, s19, v29
 v_lshlrev_b32 v20, 16, v30
 v_and_b32 v21, s19, v30
 v_lshlrev_b32 v22, 16, v31
 v_and_b32 v23, s19, v31
 v_add_f32 v8, v8, v16
 v_add_f32 v9, v9, v17
 v_add_f32 v10, v10, v18
 v_add_f32 v11, v11, v19
 v_add_f32 v12, v12, v20
 v_add_f32 v13, v13, v21
 v_add_f32 v14, v14, v22
 v_add_f32 v15, v15, v23
 s_waitcnt vmcnt(13)
 v_lshlrev_b32 v16, 16, v32
 v_and_b32 v17, s19, v32
 v_lshlrev_b32 v18, 16, v33
 v_and_b32 v19, s19, v33
 v_lshlrev_b32 v20, 16, v34
 v_and_b32 v21, s19, v34
 v_lshlrev_b32 v22, 16, v35
 v_and_b32 v23, s19, v35
 v_add_f32 v8, v8, v16
 v_add_f32 v9, v9, v17
 v_add_f32 v10, v10, v18
 v_add_f32 v11, v11, v19
 v_add_f32 v12, v12, v20
 v_add_f32 v13, v13, v21
 v_add_f32 v14, v14, v22
 v_add_f32 v15, v15, v23
 s_waitcnt vmcnt(12)
 v_lshlrev_b32 v16, 16, v36
 v_and_b32 v17, s19, v36
 v_lshlrev_b32 v18, 16, v37
 v_and_b32 v19, s19, v37
 v_lshlrev_b32 v20, 16, v38
 v_and_b32 v21, s19, v38
 v_lshlrev_b32 v22, 16, v39
 v_and_b32 v23, s19, v39
 v_add_f32 v8, v8, v16
 v_add_f32 v9, v9, v17
 v_add_f32 v10, v10, v18
 v_add_f32 v11, v11, v19
 v_add_f32 v12, v12, v20
 v_add_f32 v13, v13, v21
 v_add_f32 v14, v14, v22
 v_add_f32 v15, v15, v23
 s_waitcnt vmcnt(11)
 v_lshlrev_b32 v16, 16, v40
 v_and_b32 v17, s19, v40
 v_lshlrev_b32 v18, 16, v41
 v_and_b32 v19, s19, v41
 v_lshlrev_b32 v20, 16, v42
 v_and_b32 v21, s19, v42
 v_lshlrev_b32 v22, 16, v43
 v_and_b32 v23, s19, v43
 v_add_f32 v8, v8, v16
 v_add_f32 v9, v9, v17
 v_add_f32 v10, v10, v18
 v_add_f32 v11, v11, v19
 v_add_f32 v12, v12, v20
 v_add_f32 v13, v13, v21
 v_add_f32 v14, v14, v22
 v_add_f32 v15, v15, v23
 s_waitcnt vmcnt(10)
 v_lshlrev_b32 v16, 16, v44
 v_and_b32 v17, s19, v44
 v_lshlrev_b32 v18, 16, v45
 v_and_b32 v19, s19, v45
 v_lshlrev_b32 v20, 16, v46
 v_and_b32 v21, s19, v46
 v_lshlrev_b32 v22, 16, v47
 v_and_b32 v23, s19, v47
 v_add_f32 v8, v8, v16
 v_add_f32 v9, v9, v17
 v_add_f32 v10, v10, v18
 v_add_f32 v11, v11, v19
 v_add_f32 v12, v12, v20
 v_add_f32 v13, v13, v21
 v_add_f32 v14, v14, v22
 v_add_f32 v15, v15, v23
 s_waitcnt vmcnt(9)
 v_lshlrev_b32 v16, 16, v48
 v_and_b32 v17, s19, v48
 v_lshlrev_b32 v18, 16, v49
 v_and_b32 v19, s19, v49
 v_lshlrev_b32 v20, 16, v50
 v_and_b32 v21, s19, v50
 v_lshlrev_b32 v22, 16, v51
 v_and_b32 v23, s19, v51
 v_add_f32 v8, v8, v16
 v_add_f32 v9, v9, v17
 v_add_f32 v10, v10, v18
 v_add_f32 v11, v11, v19
 v_add_f32 v12, v12, v20
 v_add_f32 v13, v13, v21
 v_add_f32 v14, v14, v22
 v_add_f32 v15, v15, v23
 s_waitcnt vmcnt(8)
 v_lshlrev_b32 v16, 16, v52
 v_and_b32 v17, s19, v52
 v_lshlrev_b32 v18, 16, v53
 v_and_b32 v19, s19, v53
 v_lshlrev_b32 v20, 16, v54
 v_and_b32 v21, s19, v54
 v_lshlrev_b32 v22, 16, v55
 v_and_b32 v23, s19, v55
 v_add_f32 v8, v8, v16
 v_add_f32 v9, v9, v17
 v_add_f32 v10, v10, v18
 v_add_f32 v11, v11, v19
 v_add_f32 v12, v12, v20
 v_add_f32 v13, v13, v21
 v_add_f32 v14, v14, v22
 v_add_f32 v15, v15, v23
 s_waitcnt vmcnt(7)
 v_lshlrev_b32 v16, 16, v56
 v_and_b32 v17, s19, v56
 v_lshlrev_b32 v18, 16, v57
 v_and_b32 v19, s19, v57
 v_lshlrev_b32 v20, 16, v58
 v_and_b32 v21, s19, v58
 v_lshlrev_b32 v22, 16, v59
 v_and_b32 v23, s19, v59
 v_add_f32 v8, v8, v16
 v_add_f32 v9, v9, v17
 v_add_f32 v10, v10, v18
 v_add_f32 v11, v11, v19
 v_add_f32 v12, v12, v20
 v_add_f32 v13, v13, v21
 v_add_f32 v14, v14, v22
 v_add_f32 v15, v15, v23
 s_waitcnt vmcnt(6)
 v_lshlrev_b32 v16, 16, v60
 v_and_b32 v17, s19, v60
 v_lshlrev_b32 v18, 16, v61
 v_and_b32 v19, s19, v61
 v_lshlrev_b32 v20, 16, v62
 v_and_b32 v21, s19, v62
 v_lshlrev_b32 v22, 16, v63
 v_and_b32 v23, s19, v63
 v_add_f32 v8, v8, v16
 v_add_f32 v9, v9, v17
 v_add_f32 v10, v10, v18
 v_add_f32 v11, v11, v19
 v_add_f32 v12, v12, v20
 v_add_f32 v13, v13, v21
 v_add_f32 v14, v14, v22
 v_add_f32 v15, v15, v23
 s_waitcnt vmcnt(5)
 v_lshlrev_b32 v16, 16, v64
 v_and_b32 v17, s19, v64
 v_lshlrev_b32 v18, 16, v65
 v_and_b32 v19, s19, v65
 v_lshlrev_b32 v20, 16, v66
 v_and_b32 v21, s19, v66
 v_lshlrev_b32 v22, 16, v67
 v_and_b32 v23, s19, v67
 v_add_f32 v8, v8, v16
 v_add_f32 v9, v9, v17
 v_add_f32 v10, v10, v18
 v_add_f32 v11, v11, v19
 v_add_f32 v12, v12, v20
 v_add_f32 v13, v13, v21
 v_add_f32 v14, v14, v22
 v_add_f32 v15, v15, v23
 s_waitcnt vmcnt(4)
 v_lshlrev_b32 v16, 16, v68
 v_and_b32 v17, s19, v68
 v_lshlrev_b32 v18, 16, v69
 v_and_b32 v19, s19, v69
 v_lshlrev_b32 v20, 16, v70
 v_and_b32 v21, s19, v70
 v_lshlrev_b32 v22, 16, v71
 v_and_b32 v23, s19, v71
 v_add_f32 v8, v8, v16
 v_add_f32 v9, v9, v17
 v_add_f32 v10, v10, v18
 v_add_f32 v11, v11, v19
 v_add_f32 v12, v12, v20
 v_add_f32 v13, v13, v21
 v_add_f32 v14, v14, v22
 v_add_f32 v15, v15, v23
 s_waitcnt vmcnt(3)
 v_lshlrev_b32 v16, 16, v72
 v_and_b32 v17, s19, v72
 v_lshlrev_b32 v18, 16, v73
 v_and_b32 v19, s19, v73
 v_lshlrev_b32 v20, 16, v74
 v_and_b32 v21, s19, v74
 v_lshlrev_b32 v22, 16, v75
 v_and_b32 v23, s19, v75
 v_add_f32 v8, v8, v16
 v_add_f32 v9, v9, v17
 v_add_f32 v10, v10, v18
 v_add_f32 v11, v11, v19
 v_add_f32 v12, v12, v20
 v_add_f32 v13, v13, v21
 v_add_f32 v14, v14, v22
 v_add_f32 v15, v15, v23
 s_waitcnt vmcnt(2)
 v_lshlrev_b32 v16, 16, v76
 v_and_b32 v17, s19, v76
 v_lshlrev_b32 v18, 16, v77
 v_and_b32 v19, s19, v77
 v_lshlrev_b32 v20, 16, v78
 v_and_b32 v21, s19, v78
 v_lshlrev_b32 v22, 16, v79
 v_and_b32 v23, s19, v79
 v_add_f32 v8, v8, v16
 v_add_f32 v9, v9, v17
 v_add_f32 v10, v10, v18
 v_add_f32 v11, v11, v19
 v_add_f32 v12, v12, v20
 v_add_f32 v13, v13, v21
 v_add_f32 v14, v14, v22
 v_add_f32 v15, v15, v23
 s_waitcnt vmcnt(1)
 v_lshlrev_b32 v16, 16, v80
 v_and_b32 v17, s19, v80
 v_lshlrev_b32 v18, 16, v81
 v_and_b32 v19, s19, v81
 v_lshlrev_b32 v20, 16, v82
 v_and_b32 v21, s19, v82
 v_lshlrev_b32 v22, 16, v83
 v_and_b32 v23, s19, v83
 v_add_f32 v8, v8, v16
 v_add_f32 v9, v9, v17
 v_add_f32 v10, v10, v18
 v_add_f32 v11, v11, v19
 v_add_f32 v12, v12, v20
 v_add_f32 v13, v13, v21
 v_add_f32 v14, v14, v22
 v_add_f32 v15, v15, v23
 s_waitcnt vmcnt(0)
 v_lshlrev_b32 v16, 16, v84
 v_and_b32 v17, s19, v84
 v_lshlrev_b32 v18, 16, v85
 v_and_b32 v19, s19, v85
 v_lshlrev_b32 v20, 16, v86
 v_and_b32 v21, s19, v86
 v_lshlrev_b32 v22, 16, v87
 v_and_b32 v23, s19, v87
 v_add_f32 v8, v8, v16
 v_add_f32 v9, v9, v17
 v_add_f32 v10, v10, v18
 v_add_f32 v11, v11, v19
 v_add_f32 v12, v12, v20
 v_add_f32 v13, v13, v21
 v_add_f32 v14, v14, v22
 v_add_f32 v15, v15, v23
 v_cvt_pk_bf16_f32 v40, v8, v9
 v_cvt_pk_bf16_f32 v41, v10, v11
 v_cvt_pk_bf16_f32 v42, v12, v13
 v_cvt_pk_bf16_f32 v43, v14, v15
 buffer_store_dwordx4 v[40:43], v4, s[12:15], s18 offen
L_k3_end:
 s_endpgm
.section .rodata,"a"
.p2align 6
.amdhsa_kernel mha_attn_kernel
  .amdhsa_next_free_vgpr 512
  .amdhsa_next_free_sgpr 102
  .amdhsa_accum_offset 256
  .amdhsa_group_segment_fixed_size 0
  .amdhsa_kernarg_size 104
  .amdhsa_user_sgpr_count 2
  .amdhsa_user_sgpr_kernarg_segment_ptr 1
  .amdhsa_system_sgpr_workgroup_id_x 1
.end_amdhsa_kernel
.p2align 6
.amdhsa_kernel mha_reduce_kernel
  .amdhsa_next_free_vgpr 88
  .amdhsa_next_free_sgpr 102
  .amdhsa_accum_offset 88
  .amdhsa_group_segment_fixed_size 0
  .amdhsa_kernarg_size 104
  .amdhsa_user_sgpr_count 2
  .amdhsa_user_sgpr_kernarg_segment_ptr 1
  .amdhsa_system_sgpr_workgroup_id_x 1
.end_amdhsa_kernel
```
